```python
import torch

def _softmax(x, axis=-1):
    return torch.softmax(x, dim=axis)
def _gelu(x):
    return torch.nn.functional.gelu(x, approximate="tanh")
def _silu(x):
    return torch.nn.functional.silu(x)
def _sigmoid(x):
    return torch.sigmoid(x)
def _layernorm(x, axis=-1, eps=1e-5):
    m = x.mean(dim=axis, keepdim=True)
    v = x.var(dim=axis, keepdim=True, unbiased=False)
    return (x - m) / torch.sqrt(v + eps)
def _scatter_add(tgt, idx, src, axis=0):
    return tgt.clone().index_add_(axis, idx, src)
def _segment_sum(src, seg, n):
    out = torch.zeros((n,) + src.shape[1:], dtype=src.dtype)
    return out.index_add_(0, seg, src)
def _pad(x, pw):
    flat = tuple(v for pair in reversed(pw) for v in pair)
    return torch.nn.functional.pad(x, flat)

kernel_name = 'recurrent_scan__softmax_full_mha__dense_activation_squared_relu__prompt'

def setup_inputs():

    _w = (lambda a: (lambda t: t.to(torch.bfloat16) if t.is_floating_point() else t)(torch.as_tensor(a)))
    def _A_setup():
        B, S, D = 1, 2048, 640
        return {
            "x": _w((lambda *s: torch.randn(*s, dtype=torch.bfloat16) * 0.05)(B, S, D)),
            "wqkv": _w((lambda *s: torch.randn(*s, dtype=torch.bfloat16) * 0.05)(D, 3 * D)),
            "wo": _w((lambda *s: torch.randn(*s, dtype=torch.bfloat16) * 0.05)(D, D)),
        }
    _A_in = _A_setup()

    def _B_setup():
        B, S, D, F = 1, 2048, 640, 1536
        return {
            "x": _w((lambda *s: torch.randn(*s, dtype=torch.bfloat16) * 0.05)(B, S, D)),
            "w1": _w((lambda *s: torch.randn(*s, dtype=torch.bfloat16) * 0.05)(D, F)),
            "b1": _w((lambda *s: torch.randn(*s, dtype=torch.bfloat16) * 0.8)(F)),
            "w2": _w((lambda *s: torch.randn(*s, dtype=torch.bfloat16) * 0.05)(F, D)),
            "b2": _w((lambda *s: torch.randn(*s, dtype=torch.bfloat16) * 3.2)(D)),
        }
    _B_in = _B_setup()

    return {
        "A_x": _A_in["x"],
        "A_wqkv": _A_in["wqkv"],
        "A_wo": _A_in["wo"],
        "B_x": _B_in["x"],
        "B_w1": _B_in["w1"],
        "B_b1": _B_in["b1"],
        "B_w2": _B_in["w2"],
        "B_b2": _B_in["b2"],
    }

def reference(A_x, A_wqkv, A_wo, B_x, B_w1, B_b1, B_w2, B_b2):
    def _A_ref(x, wqkv, wo):
        B, S, D = x.shape
        H = 32; Dh = D // H
        qkv = (lambda x, *d: x.permute(*d))((x @ wqkv).reshape(B, S, 3, H, Dh), 2, 0, 3, 1, 4)
        q, k, v = qkv[0], qkv[1], qkv[2]
        scale = Dh ** -0.5
        scores = torch.einsum("bhqd,bhkd->bhqk", q, k) * scale
        p = _softmax(scores, axis=-1)
        o = torch.einsum("bhqk,bhkd->bhqd", p, v)
        return (lambda x, *d: x.permute(*d))(o, 0, 2, 1, 3).reshape(B, S, D) @ wo

    def _B_ref(x, w1, b1, w2, b2):
        h = torch.einsum("bsd,df->bsf", x, w1) + b1
        zero = torch.zeros_like(h)
        r = torch.where(h > zero, h, zero)
        h = r * r
        out = torch.einsum("bsf,fd->bsd", h, w2) + b2
        return out

    x = A_x
    xn = _layernorm(x, axis=-1)
    s = _A_ref(xn, A_wqkv, A_wo)
    g = _silu(_B_ref(xn, B_w1, B_b1, B_w2, B_b2))
    return x + s * g
```

```asm
; @launch grid=(256,1,1) block=(512,1,1) lds=163840
.amdgcn_target "amdgcn-amd-amdhsa--gfx950"
.text
.globl recurrent_scan__softmax_full_mha__dense_activation_squared_relu__prompt_kernel
.p2align 8
.type recurrent_scan__softmax_full_mha__dense_activation_squared_relu__prompt_kernel,@function
recurrent_scan__softmax_full_mha__dense_activation_squared_relu__prompt_kernel:
    s_cmp_ge_u32 s2, 256
    s_cbranch_scc1 L_exit
    s_load_dwordx4 s[4:7], s[0:1], 0
    s_load_dwordx4 s[92:95], s[0:1], 32
    s_load_dwordx2 s[12:13], s[0:1], 80
    s_load_dwordx2 s[88:89], s[0:1], 16
    s_load_dwordx2 s[86:87], s[0:1], 48
    s_load_dwordx4 s[8:11], s[0:1], 56
    s_load_dwordx2 s[84:85], s[0:1], 72
    v_lshrrev_b32 v2, 6, v0
    v_and_b32 v1, 63, v0
    v_readfirstlane_b32 s20, v2
    s_and_b32 s14, s2, 7
    s_lshr_b32 s15, s2, 3
    s_and_b32 s91, s14, 1
    s_lshl_b32 s91, s91, 3
    s_and_b32 s3, s15, 7
    s_add_u32 s82, s91, s3
    s_lshr_b32 s21, s14, 1
    s_lshl_b32 s21, s21, 2
    s_lshr_b32 s3, s15, 3
    s_add_u32 s21, s21, s3
    s_and_b32 s23, s20, 3
    s_lshr_b32 s22, s20, 2
    s_lshl_b32 s91, s82, 2
    s_add_u32 s91, s91, s23
    v_and_b32 v2, 31, v1
    v_lshrrev_b32 v3, 5, v1
    v_lshlrev_b32 v0, 4, v1
    s_lshl_b32 s43, s23, 12
    s_and_b32 s42, s15, 7
    s_mul_i32 s3, s3, 1
    s_add_u32 s42, s42, s3
    s_and_b32 s42, s42, 1
    s_mul_i32 s42, s42, 20
    s_lshr_b32 s42, s42, 2
    s_cmp_eq_u32 s22, 0
    s_cbranch_scc1 L_g0
    v_lshrrev_b32 v188, 3, v1
    v_mul_u32_u24 v188, 1280, v188
    v_and_b32 v189, 7, v1
    v_lshrrev_b32 v190, 4, v1
    v_xor_b32 v189, v189, v190
    v_lshl_add_u32 v168, v189, 4, v188
    v_xor_b32 v169, 64, v168
    v_add_u32 v169, 9216, v169
    v_add_u32 v170, 18432, v168
    v_add_u32 v171, 18432, v169
    s_mul_i32 s83, s91, 40960
    s_waitcnt lgkmcnt(0)
    s_mov_b32 s24, s4
    s_and_b32 s25, s5, 0xffff
    s_mov_b32 s26, 2621440
    s_mov_b32 s27, 0x20000
    s_mov_b32 s32, s6
    s_and_b32 s33, s7, 0xffff
    s_mov_b32 s34, 2457600
    s_mov_b32 s35, 0x20000
    s_cmp_eq_u32 s21, 15
    s_cselect_b32 s34, 0, s34
    s_lshl_b32 s3, s42, 7
    s_add_u32 s0, s83, s3
    s_add_u32 s40, s83, 1280
    s_add_u32 m0, s43, 16384
    s_add_u32 s0, s0, 0
    s_cmp_ge_u32 s0, s40
    s_cselect_b32 s3, 1280, 0
    s_sub_u32 s0, s0, s3
    buffer_load_dwordx4 v168, s[24:27], s0 offen offset:0 lds
    buffer_load_dwordx4 v169, s[24:27], s0 offen offset:1024 lds
    buffer_load_dwordx4 v170, s[24:27], s0 offen offset:2048 lds
    buffer_load_dwordx4 v171, s[24:27], s0 offen offset:3072 lds
    s_add_u32 m0, s43, 0
    s_add_u32 s0, s0, 128
    s_cmp_ge_u32 s0, s40
    s_cselect_b32 s3, 1280, 0
    s_sub_u32 s0, s0, s3
    buffer_load_dwordx4 v168, s[24:27], s0 offen offset:0 lds
    buffer_load_dwordx4 v169, s[24:27], s0 offen offset:1024 lds
    buffer_load_dwordx4 v170, s[24:27], s0 offen offset:2048 lds
    buffer_load_dwordx4 v171, s[24:27], s0 offen offset:3072 lds
    s_branch L_g1
L_g0:
    v_lshrrev_b32 v98, 4, v1
    v_mul_u32_u24 v96, 3840, v98
    v_and_b32 v97, 15, v1
    v_lshlrev_b32 v98, 2, v98
    v_xor_b32 v97, v97, v98
    v_lshl_add_u32 v88, v97, 4, v96
    v_add_u32 v89, 14336, v88
    v_add_u32 v90, 28672, v88
    v_add_u32 v91, 43008, v88
    s_mul_i32 s83, s23, 61440
    s_lshl_b32 s3, s21, 8
    s_add_u32 s83, s83, s3
    s_add_u32 s41, s83, 2457600
    s_mul_i32 s3, s42, 245760
    s_add_u32 s83, s83, s3
    s_waitcnt lgkmcnt(0)
    s_mov_b32 s24, s4
    s_and_b32 s25, s5, 0xffff
    s_mov_b32 s26, 2621440
    s_mov_b32 s27, 0x20000
    s_mov_b32 s32, s6
    s_and_b32 s33, s7, 0xffff
    s_mov_b32 s34, 2457600
    s_mov_b32 s35, 0x20000
    s_cmp_eq_u32 s21, 15
    s_cselect_b32 s34, 0, s34
    s_mov_b32 s1, s83
    s_mov_b32 s0, s41
    s_add_u32 m0, s43, 81920
    s_add_u32 s1, s1, 0
    s_cmp_ge_u32 s1, s0
    s_cselect_b32 s3, 2457600, 0
    s_sub_u32 s1, s1, s3
    buffer_load_dwordx4 v88, s[32:35], s1 offen offset:0 lds
    buffer_load_dwordx4 v89, s[32:35], s1 offen offset:1024 lds
    buffer_load_dwordx4 v90, s[32:35], s1 offen offset:2048 lds
    buffer_load_dwordx4 v91, s[32:35], s1 offen offset:3072 lds
    s_getpc_b64 s[80:81]
L_pf_pc:
    s_lshl_b32 s3, s15, 2
    s_add_u32 s3, s3, s23
    s_lshl_b32 s3, s3, 9
    v_and_b32 v96, 3, v1
    v_lshl_add_u32 v96, v96, 7, s3
    v_min_u32 v96, L_code_end-L_pf_pc-8, v96
    v_mov_b32 v99, s81
    v_add_co_u32 v98, vcc, s80, v96
    s_nop 1
    v_addc_co_u32 v99, vcc, 0, v99, vcc
    global_load_dword v255, v[98:99], off
    v_bfe_u32 v96, v1, 2, 2
    v_lshl_add_u32 v97, v3, 3, v96
    s_lshl_b32 s3, s23, 4
    v_add_u32 v97, s3, v97
    v_bfe_u32 v98, v1, 4, 1
    v_lshlrev_b32 v98, 5, v98
    v_and_b32 v99, 3, v1
    v_lshl_add_u32 v98, v99, 3, v98
    v_lshl_add_u32 v72, v97, 8, v98
    v_lshl_add_u32 v72, v96, 6, v72
    v_add_u32 v72, 65536, v72
    v_xor_b32 v73, 64, v72
    v_xor_b32 v74, 128, v72
    v_xor_b32 v75, 192, v72
    v_xor_b32 v76, 4096, v72
    v_xor_b32 v77, 4160, v72
    v_xor_b32 v78, 4224, v72
    v_xor_b32 v79, 4288, v72
    v_xor_b32 v80, 8192, v72
    v_xor_b32 v81, 8256, v72
    v_xor_b32 v82, 8320, v72
    v_xor_b32 v83, 8384, v72
    v_xor_b32 v84, 12288, v72
    v_xor_b32 v85, 12352, v72
    v_xor_b32 v86, 12416, v72
    v_xor_b32 v87, 12480, v72
    v_bfe_u32 v108, v1, 1, 3
    v_xor_b32 v108, v108, v3
    s_lshl_b32 s3, s23, 1
    v_xor_b32 v108, s3, v108
    v_lshlrev_b32 v108, 4, v108
    v_lshl_add_u32 v108, v2, 7, v108
    v_add_u32 v108, s43, v108
    v_xor_b32 v109, 32, v108
    v_xor_b32 v110, 64, v108
    v_xor_b32 v111, 96, v108
    v_mov_b32 v248, 0x3f803f80
    v_mov_b32 v249, 0x3f803f80
    s_add_u32 m0, s43, 65536
    s_add_u32 s1, s1, 245760
    s_cmp_ge_u32 s1, s0
    s_cselect_b32 s3, 2457600, 0
    s_sub_u32 s1, s1, s3
    buffer_load_dwordx4 v88, s[32:35], s1 offen offset:0 lds
    buffer_load_dwordx4 v89, s[32:35], s1 offen offset:1024 lds
    buffer_load_dwordx4 v90, s[32:35], s1 offen offset:2048 lds
    buffer_load_dwordx4 v91, s[32:35], s1 offen offset:3072 lds
    s_mov_b32 s28, s12
    s_and_b32 s29, s13, 0xffff
    s_mov_b32 s30, 22618368
    s_mov_b32 s31, 0x20000
    s_mov_b32 s36, s92
    s_and_b32 s37, s93, 0xffff
    s_mov_b32 s38, 1966080
    s_mov_b32 s39, 0x20000
    s_lshl_b32 s6, s21, 4
    s_add_u32 s6, s6, s82
    s_lshl_b32 s80, s6, 1
    s_add_u32 s80, s80, s23
    s_lshl_b32 s6, s6, 7
    s_add_u32 s6, s6, 22454272
    s_lshl_b32 s3, s82, 1
    s_add_u32 s3, s3, s23
    s_add_u32 s3, s3, 510
    s_cmp_eq_u32 s21, 15
    s_cselect_b32 s3, s3, 1023
    s_cmp_lt_u32 s23, 2
    s_cselect_b32 s80, s80, s3
    s_and_b32 s81, s80, 3
    s_lshr_b32 s80, s80, 2
    s_mul_i32 s92, s23, 5120
    s_add_u32 s92, s92, 131072
    s_lshl_b32 s93, s80, 4
    s_sub_u32 s94, s80, 96
    s_mul_i32 s94, s94, 20
    s_cmp_lt_u32 s80, 96
    s_cselect_b32 s93, s93, s94
    s_cselect_b32 s86, s86, s88
    s_cselect_b32 s87, s87, s89
    s_mov_b32 s88, 819200
    s_cselect_b32 s88, 1966080, s88
    s_sub_u32 s94, s80, 128
    s_mul_i32 s94, s94, 80
    s_add_u32 s94, s94, 16
    s_cmp_lt_u32 s80, 128
    s_cselect_b32 s93, s93, s94
    s_cselect_b32 s94, 0, 46080
    s_cselect_b32 s95, 0, 15360
    s_mul_i32 s93, s93, 1280
    s_mul_i32 s3, s81, 320
    s_add_u32 s93, s93, s3
    s_cmp_lt_u32 s80, 136
    s_cselect_b32 s93, s93, 0x7ff00000
    v_add_u32 v96, 0, v1
    v_mul_u32_u24 v97, 3277, v96
    v_lshrrev_b32 v97, 16, v97
    v_mul_u32_u24 v98, 960, v97
    v_lshl_add_u32 v96, v96, 4, v98
    v_bfe_u32 v98, v97, 2, 1
    v_mad_u32_u24 v96, v98, s94, v96
    v_lshrrev_b32 v98, 3, v97
    v_mad_u32_u24 v100, v98, s95, v96
    v_add_u32 v96, 64, v1
    v_mul_u32_u24 v97, 3277, v96
    v_lshrrev_b32 v97, 16, v97
    v_mul_u32_u24 v98, 960, v97
    v_lshl_add_u32 v96, v96, 4, v98
    v_bfe_u32 v98, v97, 2, 1
    v_mad_u32_u24 v96, v98, s94, v96
    v_lshrrev_b32 v98, 3, v97
    v_mad_u32_u24 v101, v98, s95, v96
    v_add_u32 v96, 128, v1
    v_mul_u32_u24 v97, 3277, v96
    v_lshrrev_b32 v97, 16, v97
    v_mul_u32_u24 v98, 960, v97
    v_lshl_add_u32 v96, v96, 4, v98
    v_bfe_u32 v98, v97, 2, 1
    v_mad_u32_u24 v96, v98, s94, v96
    v_lshrrev_b32 v98, 3, v97
    v_mad_u32_u24 v102, v98, s95, v96
    v_add_u32 v96, 192, v1
    v_mul_u32_u24 v97, 3277, v96
    v_lshrrev_b32 v97, 16, v97
    v_mul_u32_u24 v98, 960, v97
    v_lshl_add_u32 v96, v96, 4, v98
    v_bfe_u32 v98, v97, 2, 1
    v_mad_u32_u24 v96, v98, s94, v96
    v_lshrrev_b32 v98, 3, v97
    v_mad_u32_u24 v103, v98, s95, v96
    v_add_u32 v96, 256, v1
    v_mul_u32_u24 v97, 3277, v96
    v_lshrrev_b32 v97, 16, v97
    v_mul_u32_u24 v98, 960, v97
    v_lshl_add_u32 v96, v96, 4, v98
    v_bfe_u32 v98, v97, 2, 1
    v_mad_u32_u24 v96, v98, s94, v96
    v_lshrrev_b32 v98, 3, v97
    v_mad_u32_u24 v104, v98, s95, v96
    v_add_u32 v96, 0, v1
    v_mul_u32_u24 v97, 5462, v96
    v_lshrrev_b32 v97, 16, v97
    v_mul_u32_u24 v97, 2880, v97
    v_add_u32 v250, v97, v0
    v_add_u32 v96, 64, v1
    v_mul_u32_u24 v97, 5462, v96
    v_lshrrev_b32 v97, 16, v97
    v_mul_u32_u24 v97, 2880, v97
    v_add_u32 v251, v97, v0
    v_add_u32 v96, 128, v1
    v_mul_u32_u24 v97, 5462, v96
    v_lshrrev_b32 v97, 16, v97
    v_mul_u32_u24 v97, 2880, v97
    v_add_u32 v252, v97, v0
    s_mul_i32 s96, s23, 49152
    s_mul_i32 s3, s21, 192
    s_add_u32 s96, s96, s3
    s_add_u32 s97, s96, 1966080
    s_mul_i32 s3, s42, 196608
    s_add_u32 s96, s96, s3
    s_mul_i32 s45, s23, 3072
    v_add_u32 v253, 155648, v0
    s_lshl_b32 s3, s23, 2
    v_add_u32 v95, s3, v253
    v_mov_b32 v9, 0
    v_mov_b32 v11, 0
    v_mov_b32 v13, 0
    v_mov_b32 v15, 0
    v_mov_b32 v254, 163328
    ds_write_b32 v254, v9
    ds_write_b32 v254, v9 offset:4
    ds_write_b32 v254, v9 offset:8
    ds_write_b32 v254, v9 offset:12
    ds_write_b32 v254, v9 offset:16
    s_add_u32 m0, s43, 114688
    s_add_u32 s1, s1, 245760
    s_cmp_ge_u32 s1, s0
    s_cselect_b32 s3, 2457600, 0
    s_sub_u32 s1, s1, s3
    buffer_load_dwordx4 v88, s[32:35], s1 offen offset:0 lds
    buffer_load_dwordx4 v89, s[32:35], s1 offen offset:1024 lds
    buffer_load_dwordx4 v90, s[32:35], s1 offen offset:2048 lds
    buffer_load_dwordx4 v91, s[32:35], s1 offen offset:3072 lds
    v_lshrrev_b32 v105, 4, v1
    v_lshlrev_b32 v105, 8, v105
    v_bfe_u32 v96, v1, 1, 3
    v_add_u32 v105, v105, v96
    s_and_b32 s3, s15, 7
    s_lshl_b32 s3, s3, 3
    v_add_u32 v105, s3, v105
    s_lshl_b32 s3, s23, 6
    v_add_u32 v105, s3, v105
    v_mul_u32_u24 v105, 3072, v105
    v_and_b32 v96, 1, v1
    v_lshl_add_u32 v105, v96, 7, v105
    s_mul_i32 s3, s21, 192
    v_add_u32 v105, s3, v105
    s_cmp_lg_u32 s2, 255
    s_cbranch_scc1 L_noep
    s_cmp_lg_u32 s23, 0
    s_cbranch_scc1 L_noep
    s_mov_b32 s3, 22618112
    s_mov_b64 exec, 1
    buffer_load_dword v98, v9, s[28:31], s3 offen sc1
    v_mov_b32 v99, 1
    s_waitcnt vmcnt(0)
    v_add_u32 v98, 1, v98
    global_store_dwordx2 v9, v[98:99], s[84:85] sc1
    buffer_store_dword v98, v9, s[28:31], s3 offen sc1
    s_mov_b64 exec, -1
L_noep:
    s_cmp_ge_u32 s21, 10
    s_cbranch_scc1 L_g0V
    s_setprio 0
    s_waitcnt vmcnt(9)
    s_waitcnt lgkmcnt(0)
    s_barrier
    ds_read_b128 v[40:43], v108 offset:16384
    ds_read_b128 v[44:47], v109 offset:16384
    ds_read_b128 v[48:51], v110 offset:16384
    ds_read_b128 v[52:55], v111 offset:16384
    ds_read_b64_tr_b16 v[120:121], v72 offset:16384
    ds_read_b64_tr_b16 v[122:123], v72 offset:17408
    ds_read_b64_tr_b16 v[124:125], v73 offset:16384
    ds_read_b64_tr_b16 v[126:127], v73 offset:17408
    ds_read_b64_tr_b16 v[128:129], v74 offset:16384
    ds_read_b64_tr_b16 v[130:131], v74 offset:17408
    ds_read_b64_tr_b16 v[132:133], v75 offset:16384
    ds_read_b64_tr_b16 v[134:135], v75 offset:17408
    ds_read_b64_tr_b16 v[136:137], v76 offset:16384
    ds_read_b64_tr_b16 v[138:139], v76 offset:17408
    ds_read_b64_tr_b16 v[140:141], v77 offset:16384
    ds_read_b64_tr_b16 v[142:143], v77 offset:17408
    ds_read_b64_tr_b16 v[144:145], v78 offset:16384
    ds_read_b64_tr_b16 v[146:147], v78 offset:17408
    ds_read_b64_tr_b16 v[148:149], v79 offset:16384
    ds_read_b64_tr_b16 v[150:151], v79 offset:17408
    s_waitcnt lgkmcnt(8)
    v_mfma_f32_32x32x16_bf16 v[168:183], v[120:123], v[40:43], 0
    ds_read_b64_tr_b16 v[152:153], v80 offset:16384
    ds_read_b64_tr_b16 v[154:155], v80 offset:17408
    v_mfma_f32_32x32x16_bf16 v[184:199], v[124:127], v[40:43], 0
    ds_read_b64_tr_b16 v[156:157], v81 offset:16384
    ds_read_b64_tr_b16 v[158:159], v81 offset:17408
    v_mfma_f32_32x32x16_bf16 v[200:215], v[128:131], v[40:43], 0
    ds_read_b64_tr_b16 v[160:161], v82 offset:16384
    ds_read_b64_tr_b16 v[162:163], v82 offset:17408
    v_mfma_f32_32x32x16_bf16 v[216:231], v[132:135], v[40:43], 0
    ds_read_b64_tr_b16 v[164:165], v83 offset:16384
    ds_read_b64_tr_b16 v[166:167], v83 offset:17408
    s_waitcnt lgkmcnt(8)
    v_mfma_f32_32x32x16_bf16 v[168:183], v[136:139], v[44:47], v[168:183]
    ds_read_b64_tr_b16 v[120:121], v84 offset:16384
    ds_read_b64_tr_b16 v[122:123], v84 offset:17408
    v_mfma_f32_32x32x16_bf16 v[184:199], v[140:143], v[44:47], v[184:199]
    ds_read_b64_tr_b16 v[124:125], v85 offset:16384
    ds_read_b64_tr_b16 v[126:127], v85 offset:17408
    v_mfma_f32_32x32x16_bf16 v[200:215], v[144:147], v[44:47], v[200:215]
    ds_read_b64_tr_b16 v[128:129], v86 offset:16384
    ds_read_b64_tr_b16 v[130:131], v86 offset:17408
    v_mfma_f32_32x32x16_bf16 v[216:231], v[148:151], v[44:47], v[216:231]
    ds_read_b64_tr_b16 v[132:133], v87 offset:16384
    ds_read_b64_tr_b16 v[134:135], v87 offset:17408
    v_mfma_f32_4x4x4_16b_bf16 v[232:235], v[248:249], v[136:137], 0
    v_mfma_f32_4x4x4_16b_bf16 v[88:91], v[248:249], v[40:41], 0
    v_mfma_f32_4x4x4_16b_bf16 v[112:115], v[40:41], v[40:41], 0
    v_mfma_f32_4x4x4_16b_bf16 v[236:239], v[248:249], v[140:141], 0
    v_mfma_f32_4x4x4_16b_bf16 v[88:91], v[248:249], v[44:45], v[88:91]
    v_mfma_f32_4x4x4_16b_bf16 v[112:115], v[44:45], v[44:45], v[112:115]
    v_mfma_f32_4x4x4_16b_bf16 v[240:243], v[248:249], v[144:145], 0
    v_mfma_f32_4x4x4_16b_bf16 v[88:91], v[248:249], v[48:49], v[88:91]
    v_mfma_f32_4x4x4_16b_bf16 v[112:115], v[48:49], v[48:49], v[112:115]
    v_mfma_f32_4x4x4_16b_bf16 v[244:247], v[248:249], v[148:149], 0
    v_mfma_f32_4x4x4_16b_bf16 v[88:91], v[248:249], v[52:53], v[88:91]
    v_mfma_f32_4x4x4_16b_bf16 v[112:115], v[52:53], v[52:53], v[112:115]
    v_mfma_f32_4x4x4_16b_bf16 v[232:235], v[248:249], v[138:139], v[232:235]
    v_mfma_f32_4x4x4_16b_bf16 v[88:91], v[248:249], v[42:43], v[88:91]
    v_mfma_f32_4x4x4_16b_bf16 v[112:115], v[42:43], v[42:43], v[112:115]
    v_mfma_f32_4x4x4_16b_bf16 v[236:239], v[248:249], v[142:143], v[236:239]
    v_mfma_f32_4x4x4_16b_bf16 v[88:91], v[248:249], v[46:47], v[88:91]
    v_mfma_f32_4x4x4_16b_bf16 v[112:115], v[46:47], v[46:47], v[112:115]
    v_mfma_f32_4x4x4_16b_bf16 v[240:243], v[248:249], v[146:147], v[240:243]
    v_mfma_f32_4x4x4_16b_bf16 v[88:91], v[248:249], v[50:51], v[88:91]
    v_mfma_f32_4x4x4_16b_bf16 v[112:115], v[50:51], v[50:51], v[112:115]
    v_mfma_f32_4x4x4_16b_bf16 v[244:247], v[248:249], v[150:151], v[244:247]
    v_mfma_f32_4x4x4_16b_bf16 v[88:91], v[248:249], v[54:55], v[88:91]
    v_mfma_f32_4x4x4_16b_bf16 v[112:115], v[54:55], v[54:55], v[112:115]
    s_waitcnt lgkmcnt(0)
    v_mfma_f32_32x32x16_bf16 v[168:183], v[152:155], v[48:51], v[168:183]
    s_waitcnt vmcnt(4)
    s_barrier
    ds_read_b128 v[56:59], v108 offset:0
    ds_read_b64_tr_b16 v[136:137], v72 offset:0
    ds_read_b64_tr_b16 v[138:139], v72 offset:1024
    v_mfma_f32_32x32x16_bf16 v[184:199], v[156:159], v[48:51], v[184:199]
    ds_read_b128 v[60:63], v109 offset:0
    ds_read_b64_tr_b16 v[140:141], v73 offset:0
    ds_read_b64_tr_b16 v[142:143], v73 offset:1024
    s_mov_b32 s32, s86
    s_and_b32 s33, s87, 0xffff
    s_mov_b32 s34, s88
    v_mfma_f32_32x32x16_bf16 v[200:215], v[160:163], v[48:51], v[200:215]
    ds_read_b128 v[64:67], v110 offset:0
    ds_read_b64_tr_b16 v[144:145], v74 offset:0
    ds_read_b64_tr_b16 v[146:147], v74 offset:1024
    s_lshl_b32 s16, s14, 2
    v_mfma_f32_32x32x16_bf16 v[216:231], v[164:167], v[48:51], v[216:231]
    ds_read_b128 v[68:71], v111 offset:0
    ds_read_b64_tr_b16 v[148:149], v75 offset:0
    ds_read_b64_tr_b16 v[150:151], v75 offset:1024
    s_and_b32 s17, s15, 3
    v_mfma_f32_32x32x16_bf16 v[168:183], v[120:123], v[52:55], v[168:183]
    ds_read_b64_tr_b16 v[152:153], v76 offset:0
    ds_read_b64_tr_b16 v[154:155], v76 offset:1024
    s_add_u32 s16, s16, s17
    s_lshr_b32 s17, s15, 2
    v_mfma_f32_32x32x16_bf16 v[184:199], v[124:127], v[52:55], v[184:199]
    ds_read_b64_tr_b16 v[156:157], v77 offset:0
    ds_read_b64_tr_b16 v[158:159], v77 offset:1024
    s_lshl_b32 s40, s17, 3
    s_add_u32 s40, s40, s20
    v_mfma_f32_32x32x16_bf16 v[200:215], v[128:131], v[52:55], v[200:215]
    ds_read_b64_tr_b16 v[160:161], v78 offset:0
    ds_read_b64_tr_b16 v[162:163], v78 offset:1024
    s_add_u32 m0, s92, 0
    s_nop 0
    buffer_load_dwordx4 v100, s[32:35], s93 offen lds
    v_mfma_f32_32x32x16_bf16 v[216:231], v[132:135], v[52:55], v[216:231]
    ds_read_b64_tr_b16 v[164:165], v79 offset:0
    ds_read_b64_tr_b16 v[166:167], v79 offset:1024
    s_mul_i32 s80, s16, 5
    s_lshr_b32 s80, s80, 1
    s_waitcnt lgkmcnt(8)
    v_mfma_f32_32x32x16_bf16 v[168:183], v[136:139], v[56:59], v[168:183]
    ds_read_b64_tr_b16 v[120:121], v80 offset:0
    ds_read_b64_tr_b16 v[122:123], v80 offset:1024
    s_and_b32 s81, s16, 1
    s_add_u32 s44, s80, s81
    v_mfma_f32_32x32x16_bf16 v[184:199], v[140:143], v[56:59], v[184:199]
    ds_read_b64_tr_b16 v[124:125], v81 offset:0
    ds_read_b64_tr_b16 v[126:127], v81 offset:1024
    s_lshl_b32 s44, s44, 9
    s_xor_b32 s83, s81, 1
    v_mfma_f32_32x32x16_bf16 v[200:215], v[144:147], v[56:59], v[200:215]
    ds_read_b64_tr_b16 v[128:129], v82 offset:0
    ds_read_b64_tr_b16 v[130:131], v82 offset:1024
    s_add_u32 m0, s92, 1024
    s_nop 0
    buffer_load_dwordx4 v101, s[32:35], s93 offen lds
    v_mfma_f32_32x32x16_bf16 v[216:231], v[148:151], v[56:59], v[216:231]
    ds_read_b64_tr_b16 v[132:133], v83 offset:0
    ds_read_b64_tr_b16 v[134:135], v83 offset:1024
    s_lshl_b32 s83, s83, 1
    s_add_u32 s80, s80, s83
    s_waitcnt lgkmcnt(8)
    v_mfma_f32_32x32x16_bf16 v[168:183], v[152:155], v[60:63], v[168:183]
    ds_read_b64_tr_b16 v[136:137], v84 offset:0
    ds_read_b64_tr_b16 v[138:139], v84 offset:1024
    s_lshl_b32 s80, s80, 9
    s_lshl_b32 s81, s81, 3
    v_mfma_f32_32x32x16_bf16 v[184:199], v[156:159], v[60:63], v[184:199]
    ds_read_b64_tr_b16 v[140:141], v85 offset:0
    ds_read_b64_tr_b16 v[142:143], v85 offset:1024
    s_add_u32 s55, s80, s81
    s_mul_i32 s80, s40, 81920
    v_mfma_f32_32x32x16_bf16 v[200:215], v[160:163], v[60:63], v[200:215]
    ds_read_b64_tr_b16 v[144:145], v86 offset:0
    ds_read_b64_tr_b16 v[146:147], v86 offset:1024
    s_add_u32 m0, s92, 2048
    s_nop 0
    buffer_load_dwordx4 v102, s[32:35], s93 offen lds
    v_mfma_f32_32x32x16_bf16 v[216:231], v[164:167], v[60:63], v[216:231]
    ds_read_b64_tr_b16 v[148:149], v87 offset:0
    ds_read_b64_tr_b16 v[150:151], v87 offset:1024
    s_add_u32 s100, s44, s80
    s_add_u32 s101, s55, s80
    v_mfma_f32_4x4x4_16b_bf16 v[232:235], v[248:249], v[152:153], v[232:235]
    v_mfma_f32_4x4x4_16b_bf16 v[88:91], v[248:249], v[56:57], v[88:91]
    v_mfma_f32_4x4x4_16b_bf16 v[112:115], v[56:57], v[56:57], v[112:115]
    v_mfma_f32_4x4x4_16b_bf16 v[236:239], v[248:249], v[156:157], v[236:239]
    v_mfma_f32_4x4x4_16b_bf16 v[88:91], v[248:249], v[60:61], v[88:91]
    v_mfma_f32_4x4x4_16b_bf16 v[112:115], v[60:61], v[60:61], v[112:115]
    v_mfma_f32_4x4x4_16b_bf16 v[240:243], v[248:249], v[160:161], v[240:243]
    v_mfma_f32_4x4x4_16b_bf16 v[88:91], v[248:249], v[64:65], v[88:91]
    v_mfma_f32_4x4x4_16b_bf16 v[112:115], v[64:65], v[64:65], v[112:115]
    v_mfma_f32_4x4x4_16b_bf16 v[244:247], v[248:249], v[164:165], v[244:247]
    v_mfma_f32_4x4x4_16b_bf16 v[88:91], v[248:249], v[68:69], v[88:91]
    v_mfma_f32_4x4x4_16b_bf16 v[112:115], v[68:69], v[68:69], v[112:115]
    v_mfma_f32_4x4x4_16b_bf16 v[232:235], v[248:249], v[154:155], v[232:235]
    v_mfma_f32_4x4x4_16b_bf16 v[88:91], v[248:249], v[58:59], v[88:91]
    v_mfma_f32_4x4x4_16b_bf16 v[112:115], v[58:59], v[58:59], v[112:115]
    v_mfma_f32_4x4x4_16b_bf16 v[236:239], v[248:249], v[158:159], v[236:239]
    v_mfma_f32_4x4x4_16b_bf16 v[88:91], v[248:249], v[62:63], v[88:91]
    v_mfma_f32_4x4x4_16b_bf16 v[112:115], v[62:63], v[62:63], v[112:115]
    v_mfma_f32_4x4x4_16b_bf16 v[240:243], v[248:249], v[162:163], v[240:243]
    v_mfma_f32_4x4x4_16b_bf16 v[88:91], v[248:249], v[66:67], v[88:91]
    v_mfma_f32_4x4x4_16b_bf16 v[112:115], v[66:67], v[66:67], v[112:115]
    v_mfma_f32_4x4x4_16b_bf16 v[244:247], v[248:249], v[166:167], v[244:247]
    v_mfma_f32_4x4x4_16b_bf16 v[88:91], v[248:249], v[70:71], v[88:91]
    v_mfma_f32_4x4x4_16b_bf16 v[112:115], v[70:71], v[70:71], v[112:115]
    s_waitcnt lgkmcnt(0)
    v_mfma_f32_32x32x16_bf16 v[168:183], v[120:123], v[64:67], v[168:183]
    s_waitcnt vmcnt(3)
    s_barrier
    ds_read_b128 v[40:43], v108 offset:49152
    ds_read_b64_tr_b16 v[152:153], v72 offset:49152
    ds_read_b64_tr_b16 v[154:155], v72 offset:50176
    v_mfma_f32_32x32x16_bf16 v[184:199], v[124:127], v[64:67], v[184:199]
    ds_read_b128 v[44:47], v109 offset:49152
    ds_read_b64_tr_b16 v[156:157], v73 offset:49152
    ds_read_b64_tr_b16 v[158:159], v73 offset:50176
    s_add_u32 s98, s44, 40960
    v_mfma_f32_32x32x16_bf16 v[200:215], v[128:131], v[64:67], v[200:215]
    ds_read_b128 v[48:51], v110 offset:49152
    ds_read_b64_tr_b16 v[160:161], v74 offset:49152
    ds_read_b64_tr_b16 v[162:163], v74 offset:50176
    s_add_u32 m0, s92, 3072
    s_nop 0
    buffer_load_dwordx4 v103, s[32:35], s93 offen lds
    v_mfma_f32_32x32x16_bf16 v[216:231], v[132:135], v[64:67], v[216:231]
    ds_read_b128 v[52:55], v111 offset:49152
    ds_read_b64_tr_b16 v[164:165], v75 offset:49152
    ds_read_b64_tr_b16 v[166:167], v75 offset:50176
    s_add_u32 s99, s55, 40960
    v_mfma_f32_32x32x16_bf16 v[168:183], v[136:139], v[68:71], v[168:183]
    ds_read_b64_tr_b16 v[120:121], v76 offset:49152
    ds_read_b64_tr_b16 v[122:123], v76 offset:50176
    s_add_u32 s41, s16, s22
    s_and_b32 s41, s41, 7
    v_mfma_f32_32x32x16_bf16 v[184:199], v[140:143], v[68:71], v[184:199]
    ds_read_b64_tr_b16 v[124:125], v77 offset:49152
    ds_read_b64_tr_b16 v[126:127], v77 offset:50176
    s_mul_i32 s80, s22, 10240
    s_lshl_b32 s42, s23, 10
    v_mfma_f32_32x32x16_bf16 v[200:215], v[144:147], v[68:71], v[200:215]
    ds_read_b64_tr_b16 v[128:129], v78 offset:49152
    ds_read_b64_tr_b16 v[130:131], v78 offset:50176
    s_add_u32 m0, s92, 4096
    s_nop 0
    buffer_load_dwordx4 v104, s[32:35], s93 offen lds
    v_mfma_f32_32x32x16_bf16 v[216:231], v[148:151], v[68:71], v[216:231]
    ds_read_b64_tr_b16 v[132:133], v79 offset:49152
    ds_read_b64_tr_b16 v[134:135], v79 offset:50176
    s_add_u32 s42, s42, s80
    s_lshl_b32 s82, s23, 8
    s_waitcnt lgkmcnt(8)
    v_mfma_f32_32x32x16_bf16 v[168:183], v[152:155], v[40:43], v[168:183]
    ds_read_b64_tr_b16 v[136:137], v80 offset:49152
    ds_read_b64_tr_b16 v[138:139], v80 offset:50176
    s_add_u32 s82, s82, s80
    s_mul_i32 s43, s23, 1280
    v_mfma_f32_32x32x16_bf16 v[184:199], v[156:159], v[40:43], v[184:199]
    ds_read_b64_tr_b16 v[140:141], v81 offset:49152
    ds_read_b64_tr_b16 v[142:143], v81 offset:50176
    s_add_u32 s43, s43, s80
    s_lshl_b32 s18, s14, 3
    v_mfma_f32_32x32x16_bf16 v[200:215], v[160:163], v[40:43], v[200:215]
    ds_read_b64_tr_b16 v[144:145], v82 offset:49152
    ds_read_b64_tr_b16 v[146:147], v82 offset:50176
    s_and_b32 s19, s15, 7
    s_add_u32 s18, s18, s19
    v_mfma_f32_32x32x16_bf16 v[216:231], v[164:167], v[40:43], v[216:231]
    ds_read_b64_tr_b16 v[148:149], v83 offset:49152
    ds_read_b64_tr_b16 v[150:151], v83 offset:50176
    s_lshr_b32 s19, s15, 3
    s_mul_i32 s48, s23, 24
    s_waitcnt lgkmcnt(8)
    v_mfma_f32_32x32x16_bf16 v[168:183], v[120:123], v[44:47], v[168:183]
    ds_read_b64_tr_b16 v[152:153], v84 offset:49152
    ds_read_b64_tr_b16 v[154:155], v84 offset:50176
    s_add_u32 s49, s48, s22
    s_sub_u32 s48, s48, s22
    v_mfma_f32_32x32x16_bf16 v[184:199], v[124:127], v[44:47], v[184:199]
    ds_read_b64_tr_b16 v[156:157], v85 offset:49152
    ds_read_b64_tr_b16 v[158:159], v85 offset:50176
    s_add_u32 s48, s48, 1
    s_mul_i32 s50, s18, 96
    v_mfma_f32_32x32x16_bf16 v[200:215], v[128:131], v[44:47], v[200:215]
    ds_read_b64_tr_b16 v[160:161], v86 offset:49152
    ds_read_b64_tr_b16 v[162:163], v86 offset:50176
    s_add_u32 s51, s50, s48
    s_add_u32 s50, s50, s49
    v_mfma_f32_32x32x16_bf16 v[216:231], v[132:135], v[44:47], v[216:231]
    ds_read_b64_tr_b16 v[164:165], v87 offset:49152
    ds_read_b64_tr_b16 v[166:167], v87 offset:50176
    s_lshl_b32 s50, s50, 10
    s_lshl_b32 s51, s51, 10
    v_mfma_f32_4x4x4_16b_bf16 v[232:235], v[248:249], v[120:121], v[232:235]
    v_mfma_f32_4x4x4_16b_bf16 v[88:91], v[248:249], v[40:41], v[88:91]
    v_mfma_f32_4x4x4_16b_bf16 v[112:115], v[40:41], v[40:41], v[112:115]
    v_mfma_f32_4x4x4_16b_bf16 v[236:239], v[248:249], v[124:125], v[236:239]
    v_mfma_f32_4x4x4_16b_bf16 v[88:91], v[248:249], v[44:45], v[88:91]
    v_mfma_f32_4x4x4_16b_bf16 v[112:115], v[44:45], v[44:45], v[112:115]
    v_mfma_f32_4x4x4_16b_bf16 v[240:243], v[248:249], v[128:129], v[240:243]
    v_mfma_f32_4x4x4_16b_bf16 v[88:91], v[248:249], v[48:49], v[88:91]
    v_mfma_f32_4x4x4_16b_bf16 v[112:115], v[48:49], v[48:49], v[112:115]
    v_mfma_f32_4x4x4_16b_bf16 v[244:247], v[248:249], v[132:133], v[244:247]
    v_mfma_f32_4x4x4_16b_bf16 v[88:91], v[248:249], v[52:53], v[88:91]
    v_mfma_f32_4x4x4_16b_bf16 v[112:115], v[52:53], v[52:53], v[112:115]
    v_mfma_f32_4x4x4_16b_bf16 v[232:235], v[248:249], v[122:123], v[232:235]
    v_mfma_f32_4x4x4_16b_bf16 v[88:91], v[248:249], v[42:43], v[88:91]
    v_mfma_f32_4x4x4_16b_bf16 v[112:115], v[42:43], v[42:43], v[112:115]
    v_mfma_f32_4x4x4_16b_bf16 v[236:239], v[248:249], v[126:127], v[236:239]
    v_mfma_f32_4x4x4_16b_bf16 v[88:91], v[248:249], v[46:47], v[88:91]
    v_mfma_f32_4x4x4_16b_bf16 v[112:115], v[46:47], v[46:47], v[112:115]
    v_mfma_f32_4x4x4_16b_bf16 v[240:243], v[248:249], v[130:131], v[240:243]
    v_mfma_f32_4x4x4_16b_bf16 v[88:91], v[248:249], v[50:51], v[88:91]
    v_mfma_f32_4x4x4_16b_bf16 v[112:115], v[50:51], v[50:51], v[112:115]
    v_mfma_f32_4x4x4_16b_bf16 v[244:247], v[248:249], v[134:135], v[244:247]
    v_mfma_f32_4x4x4_16b_bf16 v[88:91], v[248:249], v[54:55], v[88:91]
    v_mfma_f32_4x4x4_16b_bf16 v[112:115], v[54:55], v[54:55], v[112:115]
    s_waitcnt lgkmcnt(0)
    v_mfma_f32_32x32x16_bf16 v[168:183], v[136:139], v[48:51], v[168:183]
    s_barrier
    ds_read_b128 v[56:59], v108 offset:32768
    ds_read_b64_tr_b16 v[120:121], v72 offset:32768
    ds_read_b64_tr_b16 v[122:123], v72 offset:33792
    v_mfma_f32_32x32x16_bf16 v[184:199], v[140:143], v[48:51], v[184:199]
    ds_read_b128 v[60:63], v109 offset:32768
    ds_read_b64_tr_b16 v[124:125], v73 offset:32768
    ds_read_b64_tr_b16 v[126:127], v73 offset:33792
    s_add_u32 s50, s50, 7864320
    v_mfma_f32_32x32x16_bf16 v[200:215], v[144:147], v[48:51], v[200:215]
    ds_read_b128 v[64:67], v110 offset:32768
    ds_read_b64_tr_b16 v[128:129], v74 offset:32768
    ds_read_b64_tr_b16 v[130:131], v74 offset:33792
    s_add_u32 s51, s51, 7864320
    v_mfma_f32_32x32x16_bf16 v[216:231], v[148:151], v[48:51], v[216:231]
    ds_read_b128 v[68:71], v111 offset:32768
    ds_read_b64_tr_b16 v[132:133], v75 offset:32768
    ds_read_b64_tr_b16 v[134:135], v75 offset:33792
    s_mul_i32 s52, s19, 5
    v_mfma_f32_32x32x16_bf16 v[168:183], v[152:155], v[52:55], v[168:183]
    ds_read_b64_tr_b16 v[136:137], v76 offset:32768
    ds_read_b64_tr_b16 v[138:139], v76 offset:33792
    s_mul_i32 s49, s49, 20
    s_mul_i32 s48, s48, 20
    v_mfma_f32_32x32x16_bf16 v[184:199], v[156:159], v[52:55], v[184:199]
    ds_read_b64_tr_b16 v[140:141], v77 offset:32768
    ds_read_b64_tr_b16 v[142:143], v77 offset:33792
    s_add_u32 s49, s49, s52
    s_add_u32 s48, s48, s52
    v_mfma_f32_32x32x16_bf16 v[200:215], v[160:163], v[52:55], v[200:215]
    ds_read_b64_tr_b16 v[144:145], v78 offset:32768
    ds_read_b64_tr_b16 v[146:147], v78 offset:33792
    s_lshl_b32 s49, s49, 10
    s_lshl_b32 s48, s48, 10
    v_mfma_f32_32x32x16_bf16 v[216:231], v[164:167], v[52:55], v[216:231]
    ds_read_b64_tr_b16 v[148:149], v79 offset:32768
    ds_read_b64_tr_b16 v[150:151], v79 offset:33792
    s_add_u32 s52, s49, 19402752
    s_lshl_b32 s53, s22, 11
    s_waitcnt lgkmcnt(8)
    v_mfma_f32_32x32x16_bf16 v[168:183], v[120:123], v[56:59], v[168:183]
    ds_read_b64_tr_b16 v[152:153], v80 offset:32768
    ds_read_b64_tr_b16 v[154:155], v80 offset:33792
    s_add_u32 s53, s53, 19398656
    s_add_u32 s49, s49, s53
    v_mfma_f32_32x32x16_bf16 v[184:199], v[124:127], v[56:59], v[184:199]
    ds_read_b64_tr_b16 v[156:157], v81 offset:32768
    ds_read_b64_tr_b16 v[158:159], v81 offset:33792
    s_add_u32 s48, s48, s53
    s_mul_i32 s53, s19, 5
    v_mfma_f32_32x32x16_bf16 v[200:215], v[128:131], v[56:59], v[200:215]
    ds_read_b64_tr_b16 v[160:161], v82 offset:32768
    ds_read_b64_tr_b16 v[162:163], v82 offset:33792
    s_add_u32 s54, s53, s23
    s_mul_i32 s80, s23, 200
    v_mfma_f32_32x32x16_bf16 v[216:231], v[132:135], v[56:59], v[216:231]
    ds_read_b64_tr_b16 v[164:165], v83 offset:32768
    ds_read_b64_tr_b16 v[166:167], v83 offset:33792
    s_add_u32 s80, s80, s53
    s_add_u32 s80, s80, 4
    s_waitcnt lgkmcnt(8)
    v_mfma_f32_32x32x16_bf16 v[168:183], v[136:139], v[60:63], v[168:183]
    ds_read_b64_tr_b16 v[120:121], v84 offset:32768
    ds_read_b64_tr_b16 v[122:123], v84 offset:33792
    s_cmp_eq_u32 s22, 0
    s_cselect_b32 s53, s54, s80
    v_mfma_f32_32x32x16_bf16 v[184:199], v[140:143], v[60:63], v[184:199]
    ds_read_b64_tr_b16 v[124:125], v85 offset:32768
    ds_read_b64_tr_b16 v[126:127], v85 offset:33792
    s_mul_i32 s80, s22, 300
    s_add_u32 s80, s80, 200
    v_mfma_f32_32x32x16_bf16 v[200:215], v[144:147], v[60:63], v[200:215]
    ds_read_b64_tr_b16 v[128:129], v86 offset:32768
    ds_read_b64_tr_b16 v[130:131], v86 offset:33792
    s_add_u32 s54, s54, s80
    s_lshl_b32 s53, s53, 10
    v_mfma_f32_32x32x16_bf16 v[216:231], v[148:151], v[60:63], v[216:231]
    ds_read_b64_tr_b16 v[132:133], v87 offset:32768
    ds_read_b64_tr_b16 v[134:135], v87 offset:33792
    s_lshl_b32 s54, s54, 10
    s_add_u32 s53, s53, 21364736
    v_mfma_f32_4x4x4_16b_bf16 v[232:235], v[248:249], v[136:137], v[232:235]
    v_mfma_f32_4x4x4_16b_bf16 v[88:91], v[248:249], v[56:57], v[88:91]
    v_mfma_f32_4x4x4_16b_bf16 v[112:115], v[56:57], v[56:57], v[112:115]
    v_mfma_f32_4x4x4_16b_bf16 v[236:239], v[248:249], v[140:141], v[236:239]
    v_mfma_f32_4x4x4_16b_bf16 v[88:91], v[248:249], v[60:61], v[88:91]
    v_mfma_f32_4x4x4_16b_bf16 v[112:115], v[60:61], v[60:61], v[112:115]
    v_mfma_f32_4x4x4_16b_bf16 v[240:243], v[248:249], v[144:145], v[240:243]
    v_mfma_f32_4x4x4_16b_bf16 v[88:91], v[248:249], v[64:65], v[88:91]
    v_mfma_f32_4x4x4_16b_bf16 v[112:115], v[64:65], v[64:65], v[112:115]
    v_mfma_f32_4x4x4_16b_bf16 v[244:247], v[248:249], v[148:149], v[244:247]
    v_mfma_f32_4x4x4_16b_bf16 v[88:91], v[248:249], v[68:69], v[88:91]
    v_mfma_f32_4x4x4_16b_bf16 v[112:115], v[68:69], v[68:69], v[112:115]
    v_mfma_f32_4x4x4_16b_bf16 v[232:235], v[248:249], v[138:139], v[232:235]
    v_mfma_f32_4x4x4_16b_bf16 v[88:91], v[248:249], v[58:59], v[88:91]
    v_mfma_f32_4x4x4_16b_bf16 v[112:115], v[58:59], v[58:59], v[112:115]
    v_mfma_f32_4x4x4_16b_bf16 v[236:239], v[248:249], v[142:143], v[236:239]
    v_mfma_f32_4x4x4_16b_bf16 v[88:91], v[248:249], v[62:63], v[88:91]
    v_mfma_f32_4x4x4_16b_bf16 v[112:115], v[62:63], v[62:63], v[112:115]
    v_mfma_f32_4x4x4_16b_bf16 v[240:243], v[248:249], v[146:147], v[240:243]
    v_mfma_f32_4x4x4_16b_bf16 v[88:91], v[248:249], v[66:67], v[88:91]
    v_mfma_f32_4x4x4_16b_bf16 v[112:115], v[66:67], v[66:67], v[112:115]
    v_mfma_f32_4x4x4_16b_bf16 v[244:247], v[248:249], v[150:151], v[244:247]
    v_mfma_f32_4x4x4_16b_bf16 v[88:91], v[248:249], v[70:71], v[88:91]
    v_mfma_f32_4x4x4_16b_bf16 v[112:115], v[70:71], v[70:71], v[112:115]
    s_waitcnt lgkmcnt(0)
    v_mfma_f32_32x32x16_bf16 v[168:183], v[152:155], v[64:67], v[168:183]
    s_barrier
    ds_read_b128 v[40:43], v108 offset:16384
    ds_read_b64_tr_b16 v[136:137], v72 offset:16384
    ds_read_b64_tr_b16 v[138:139], v72 offset:17408
    v_mfma_f32_32x32x16_bf16 v[184:199], v[156:159], v[64:67], v[184:199]
    ds_read_b128 v[44:47], v109 offset:16384
    ds_read_b64_tr_b16 v[140:141], v73 offset:16384
    ds_read_b64_tr_b16 v[142:143], v73 offset:17408
    s_add_u32 s54, s54, 21364736
    v_mfma_f32_32x32x16_bf16 v[200:215], v[160:163], v[64:67], v[200:215]
    ds_read_b128 v[48:51], v110 offset:16384
    ds_read_b64_tr_b16 v[144:145], v74 offset:16384
    ds_read_b64_tr_b16 v[146:147], v74 offset:17408
    s_mov_b32 s46, 0xfffff
    v_mfma_f32_32x32x16_bf16 v[216:231], v[164:167], v[64:67], v[216:231]
    ds_read_b128 v[52:55], v111 offset:16384
    ds_read_b64_tr_b16 v[148:149], v75 offset:16384
    ds_read_b64_tr_b16 v[150:151], v75 offset:17408
    s_mov_b32 s47, 0xfffff
    v_mfma_f32_32x32x16_bf16 v[168:183], v[120:123], v[68:71], v[168:183]
    ds_read_b64_tr_b16 v[152:153], v76 offset:16384
    ds_read_b64_tr_b16 v[154:155], v76 offset:17408
    s_lshl_b32 s4, s91, 4
    s_add_u32 s4, s4, s21
    v_mfma_f32_32x32x16_bf16 v[184:199], v[124:127], v[68:71], v[184:199]
    ds_read_b64_tr_b16 v[156:157], v77 offset:16384
    ds_read_b64_tr_b16 v[158:159], v77 offset:17408
    s_lshl_b32 s4, s4, 7
    s_add_u32 s4, s4, 22487040
    v_mfma_f32_32x32x16_bf16 v[200:215], v[128:131], v[68:71], v[200:215]
    ds_read_b64_tr_b16 v[160:161], v78 offset:16384
    ds_read_b64_tr_b16 v[162:163], v78 offset:17408
    s_lshl_b32 s5, s18, 2
    s_add_u32 s5, s5, s23
    v_mfma_f32_32x32x16_bf16 v[216:231], v[132:135], v[68:71], v[216:231]
    ds_read_b64_tr_b16 v[164:165], v79 offset:16384
    ds_read_b64_tr_b16 v[166:167], v79 offset:17408
    s_lshl_b32 s5, s5, 9
    s_add_u32 s5, s5, 22487040
    s_waitcnt lgkmcnt(8)
    v_mfma_f32_32x32x16_bf16 v[168:183], v[136:139], v[40:43], v[168:183]
    ds_read_b64_tr_b16 v[120:121], v80 offset:16384
    ds_read_b64_tr_b16 v[122:123], v80 offset:17408
    s_and_b32 s7, s15, 7
    s_add_u32 s7, s7, 7
    v_mfma_f32_32x32x16_bf16 v[184:199], v[140:143], v[40:43], v[184:199]
    ds_read_b64_tr_b16 v[124:125], v81 offset:16384
    ds_read_b64_tr_b16 v[126:127], v81 offset:17408
    s_mul_i32 s7, s7, 20480
    s_add_u32 s7, s7, s54
    v_mfma_f32_32x32x16_bf16 v[200:215], v[144:147], v[40:43], v[200:215]
    ds_read_b64_tr_b16 v[128:129], v82 offset:16384
    ds_read_b64_tr_b16 v[130:131], v82 offset:17408
    buffer_load_dword v105, v105, s[36:39], 0 offen
    v_and_b32 v18, 19, v2
    v_mfma_f32_32x32x16_bf16 v[216:231], v[148:151], v[40:43], v[216:231]
    ds_read_b64_tr_b16 v[132:133], v83 offset:16384
    ds_read_b64_tr_b16 v[134:135], v83 offset:17408
    v_bfe_u32 v19, v2, 2, 1
    v_lshl_add_u32 v18, v19, 3, v18
    s_waitcnt lgkmcnt(8)
    v_mfma_f32_32x32x16_bf16 v[168:183], v[152:155], v[44:47], v[168:183]
    ds_read_b64_tr_b16 v[136:137], v84 offset:16384
    ds_read_b64_tr_b16 v[138:139], v84 offset:17408
    v_bfe_u32 v19, v2, 3, 1
    v_lshl_add_u32 v18, v19, 2, v18
    v_mfma_f32_32x32x16_bf16 v[184:199], v[156:159], v[44:47], v[184:199]
    ds_read_b64_tr_b16 v[140:141], v85 offset:16384
    ds_read_b64_tr_b16 v[142:143], v85 offset:17408
    v_mul_u32_u24 v19, 20, v3
    v_add_u32 v19, v19, v2
    v_mfma_f32_32x32x16_bf16 v[200:215], v[160:163], v[44:47], v[200:215]
    ds_read_b64_tr_b16 v[144:145], v86 offset:16384
    ds_read_b64_tr_b16 v[146:147], v86 offset:17408
    v_lshlrev_b32 v19, 4, v19
    v_lshlrev_b32 v5, 3, v18
    v_mfma_f32_32x32x16_bf16 v[216:231], v[164:167], v[44:47], v[216:231]
    ds_read_b64_tr_b16 v[148:149], v87 offset:16384
    ds_read_b64_tr_b16 v[150:151], v87 offset:17408
    v_add_u32 v5, 4096, v5
    v_lshlrev_b32 v4, 4, v18
    v_mfma_f32_4x4x4_16b_bf16 v[232:235], v[248:249], v[152:153], v[232:235]
    v_mfma_f32_4x4x4_16b_bf16 v[88:91], v[248:249], v[40:41], v[88:91]
    v_mfma_f32_4x4x4_16b_bf16 v[112:115], v[40:41], v[40:41], v[112:115]
    v_mfma_f32_4x4x4_16b_bf16 v[236:239], v[248:249], v[156:157], v[236:239]
    v_mfma_f32_4x4x4_16b_bf16 v[88:91], v[248:249], v[44:45], v[88:91]
    v_mfma_f32_4x4x4_16b_bf16 v[112:115], v[44:45], v[44:45], v[112:115]
    v_mfma_f32_4x4x4_16b_bf16 v[240:243], v[248:249], v[160:161], v[240:243]
    v_mfma_f32_4x4x4_16b_bf16 v[88:91], v[248:249], v[48:49], v[88:91]
    v_mfma_f32_4x4x4_16b_bf16 v[112:115], v[48:49], v[48:49], v[112:115]
    v_mfma_f32_4x4x4_16b_bf16 v[244:247], v[248:249], v[164:165], v[244:247]
    v_mfma_f32_4x4x4_16b_bf16 v[88:91], v[248:249], v[52:53], v[88:91]
    v_mfma_f32_4x4x4_16b_bf16 v[112:115], v[52:53], v[52:53], v[112:115]
    v_mfma_f32_4x4x4_16b_bf16 v[232:235], v[248:249], v[154:155], v[232:235]
    v_mfma_f32_4x4x4_16b_bf16 v[88:91], v[248:249], v[42:43], v[88:91]
    v_mfma_f32_4x4x4_16b_bf16 v[112:115], v[42:43], v[42:43], v[112:115]
    v_mfma_f32_4x4x4_16b_bf16 v[236:239], v[248:249], v[158:159], v[236:239]
    v_mfma_f32_4x4x4_16b_bf16 v[88:91], v[248:249], v[46:47], v[88:91]
    v_mfma_f32_4x4x4_16b_bf16 v[112:115], v[46:47], v[46:47], v[112:115]
    v_mfma_f32_4x4x4_16b_bf16 v[240:243], v[248:249], v[162:163], v[240:243]
    v_mfma_f32_4x4x4_16b_bf16 v[88:91], v[248:249], v[50:51], v[88:91]
    v_mfma_f32_4x4x4_16b_bf16 v[112:115], v[50:51], v[50:51], v[112:115]
    v_mfma_f32_4x4x4_16b_bf16 v[244:247], v[248:249], v[166:167], v[244:247]
    v_mfma_f32_4x4x4_16b_bf16 v[88:91], v[248:249], v[54:55], v[88:91]
    v_mfma_f32_4x4x4_16b_bf16 v[112:115], v[54:55], v[54:55], v[112:115]
    s_waitcnt lgkmcnt(0)
    v_mfma_f32_32x32x16_bf16 v[168:183], v[120:123], v[48:51], v[168:183]
    s_waitcnt vmcnt(1)
    s_barrier
    ds_read_b128 v[56:59], v108 offset:0
    ds_read_b64_tr_b16 v[152:153], v72 offset:0
    ds_read_b64_tr_b16 v[154:155], v72 offset:1024
    v_mfma_f32_32x32x16_bf16 v[184:199], v[124:127], v[48:51], v[184:199]
    ds_read_b128 v[60:63], v109 offset:0
    ds_read_b64_tr_b16 v[156:157], v73 offset:0
    ds_read_b64_tr_b16 v[158:159], v73 offset:1024
    v_lshl_add_u32 v4, v3, 9, v4
    v_mfma_f32_32x32x16_bf16 v[200:215], v[128:131], v[48:51], v[200:215]
    ds_read_b128 v[64:67], v110 offset:0
    ds_read_b64_tr_b16 v[160:161], v74 offset:0
    ds_read_b64_tr_b16 v[162:163], v74 offset:1024
    v_add_u32 v6, 5120, v19
    v_mfma_f32_32x32x16_bf16 v[216:231], v[132:135], v[48:51], v[216:231]
    ds_read_b128 v[68:71], v111 offset:0
    ds_read_b64_tr_b16 v[164:165], v75 offset:0
    ds_read_b64_tr_b16 v[166:167], v75 offset:1024
    v_mov_b32 v7, 0xdddddddd
    v_mfma_f32_32x32x16_bf16 v[168:183], v[136:139], v[52:55], v[168:183]
    ds_read_b64_tr_b16 v[120:121], v76 offset:0
    ds_read_b64_tr_b16 v[122:123], v76 offset:1024
    s_mul_i32 s3, s20, 1280
    s_add_u32 s3, s3, 20480
    v_add_u32 v17, s3, v0
    v_mfma_f32_32x32x16_bf16 v[184:199], v[140:143], v[52:55], v[184:199]
    ds_read_b64_tr_b16 v[124:125], v77 offset:0
    ds_read_b64_tr_b16 v[126:127], v77 offset:1024
    v_mov_b32 v21, 0x3f803f80
    v_cmp_eq_u32 vcc, 20, v2
    s_nop 1
    v_cndmask_b32 v20, 0, v21, vcc
    v_mfma_f32_32x32x16_bf16 v[200:215], v[144:147], v[52:55], v[200:215]
    ds_read_b64_tr_b16 v[128:129], v78 offset:0
    ds_read_b64_tr_b16 v[130:131], v78 offset:1024
    v_mov_b32 v21, v20
    v_mov_b32 v22, v20
    v_mfma_f32_32x32x16_bf16 v[216:231], v[148:151], v[52:55], v[216:231]
    ds_read_b64_tr_b16 v[132:133], v79 offset:0
    ds_read_b64_tr_b16 v[134:135], v79 offset:1024
    v_mov_b32 v23, v20
    v_mov_b32 v24, v20
    s_waitcnt lgkmcnt(8)
    v_mfma_f32_32x32x16_bf16 v[168:183], v[152:155], v[56:59], v[168:183]
    ds_read_b64_tr_b16 v[136:137], v80 offset:0
    ds_read_b64_tr_b16 v[138:139], v80 offset:1024
    v_mov_b32 v25, v20
    v_mov_b32 v26, v20
    v_mfma_f32_32x32x16_bf16 v[184:199], v[156:159], v[56:59], v[184:199]
    ds_read_b64_tr_b16 v[140:141], v81 offset:0
    ds_read_b64_tr_b16 v[142:143], v81 offset:1024
    v_mov_b32 v27, v20
    v_mov_b32 v28, v20
    v_mfma_f32_32x32x16_bf16 v[200:215], v[160:163], v[56:59], v[200:215]
    ds_read_b64_tr_b16 v[144:145], v82 offset:0
    ds_read_b64_tr_b16 v[146:147], v82 offset:1024
    global_load_dwordx2 v[106:107], v9, s[84:85] sc1
    v_mov_b32 v29, v20
    v_mfma_f32_32x32x16_bf16 v[216:231], v[164:167], v[56:59], v[216:231]
    ds_read_b64_tr_b16 v[148:149], v83 offset:0
    ds_read_b64_tr_b16 v[150:151], v83 offset:1024
    v_mov_b32 v30, v20
    v_mov_b32 v31, v20
    s_waitcnt lgkmcnt(8)
    v_mfma_f32_32x32x16_bf16 v[168:183], v[120:123], v[60:63], v[168:183]
    ds_read_b64_tr_b16 v[152:153], v84 offset:0
    ds_read_b64_tr_b16 v[154:155], v84 offset:1024
    v_mov_b32 v32, v20
    v_mov_b32 v33, v20
    v_mfma_f32_32x32x16_bf16 v[184:199], v[124:127], v[60:63], v[184:199]
    ds_read_b64_tr_b16 v[156:157], v85 offset:0
    ds_read_b64_tr_b16 v[158:159], v85 offset:1024
    v_mov_b32 v34, v20
    v_mov_b32 v35, v20
    v_mfma_f32_32x32x16_bf16 v[200:215], v[128:131], v[60:63], v[200:215]
    ds_read_b64_tr_b16 v[160:161], v86 offset:0
    ds_read_b64_tr_b16 v[162:163], v86 offset:1024
    v_mov_b32 v36, v20
    v_mov_b32 v37, v20
    v_mfma_f32_32x32x16_bf16 v[216:231], v[132:135], v[60:63], v[216:231]
    ds_read_b64_tr_b16 v[164:165], v87 offset:0
    ds_read_b64_tr_b16 v[166:167], v87 offset:1024
    v_mov_b32 v38, v20
    v_mov_b32 v39, v20
    v_mfma_f32_4x4x4_16b_bf16 v[232:235], v[248:249], v[120:121], v[232:235]
    v_mfma_f32_4x4x4_16b_bf16 v[88:91], v[248:249], v[56:57], v[88:91]
    v_mfma_f32_4x4x4_16b_bf16 v[112:115], v[56:57], v[56:57], v[112:115]
    v_mfma_f32_4x4x4_16b_bf16 v[236:239], v[248:249], v[124:125], v[236:239]
    v_mfma_f32_4x4x4_16b_bf16 v[88:91], v[248:249], v[60:61], v[88:91]
    v_mfma_f32_4x4x4_16b_bf16 v[112:115], v[60:61], v[60:61], v[112:115]
    v_mfma_f32_4x4x4_16b_bf16 v[240:243], v[248:249], v[128:129], v[240:243]
    v_mfma_f32_4x4x4_16b_bf16 v[88:91], v[248:249], v[64:65], v[88:91]
    v_mfma_f32_4x4x4_16b_bf16 v[112:115], v[64:65], v[64:65], v[112:115]
    v_mfma_f32_4x4x4_16b_bf16 v[244:247], v[248:249], v[132:133], v[244:247]
    v_mfma_f32_4x4x4_16b_bf16 v[88:91], v[248:249], v[68:69], v[88:91]
    v_mfma_f32_4x4x4_16b_bf16 v[112:115], v[68:69], v[68:69], v[112:115]
    v_mfma_f32_4x4x4_16b_bf16 v[232:235], v[248:249], v[122:123], v[232:235]
    v_mfma_f32_4x4x4_16b_bf16 v[88:91], v[248:249], v[58:59], v[88:91]
    v_mfma_f32_4x4x4_16b_bf16 v[112:115], v[58:59], v[58:59], v[112:115]
    v_mfma_f32_4x4x4_16b_bf16 v[236:239], v[248:249], v[126:127], v[236:239]
    v_mfma_f32_4x4x4_16b_bf16 v[88:91], v[248:249], v[62:63], v[88:91]
    v_mfma_f32_4x4x4_16b_bf16 v[112:115], v[62:63], v[62:63], v[112:115]
    v_mfma_f32_4x4x4_16b_bf16 v[240:243], v[248:249], v[130:131], v[240:243]
    v_mfma_f32_4x4x4_16b_bf16 v[88:91], v[248:249], v[66:67], v[88:91]
    v_mfma_f32_4x4x4_16b_bf16 v[112:115], v[66:67], v[66:67], v[112:115]
    v_mfma_f32_4x4x4_16b_bf16 v[244:247], v[248:249], v[134:135], v[244:247]
    v_mfma_f32_4x4x4_16b_bf16 v[88:91], v[248:249], v[70:71], v[88:91]
    v_mfma_f32_4x4x4_16b_bf16 v[112:115], v[70:71], v[70:71], v[112:115]
    s_waitcnt lgkmcnt(0)
    v_mfma_f32_32x32x16_bf16 v[168:183], v[136:139], v[64:67], v[168:183]
    s_barrier
    ds_read_b128 v[40:43], v108 offset:49152
    ds_read_b64_tr_b16 v[120:121], v72 offset:49152
    ds_read_b64_tr_b16 v[122:123], v72 offset:50176
    v_mfma_f32_32x32x16_bf16 v[184:199], v[140:143], v[64:67], v[184:199]
    ds_read_b128 v[44:47], v109 offset:49152
    ds_read_b64_tr_b16 v[124:125], v73 offset:49152
    ds_read_b64_tr_b16 v[126:127], v73 offset:50176
    v_and_b32 v118, 3, v1
    v_mfma_f32_32x32x16_bf16 v[200:215], v[144:147], v[64:67], v[200:215]
    ds_read_b128 v[48:51], v110 offset:49152
    ds_read_b64_tr_b16 v[128:129], v74 offset:49152
    ds_read_b64_tr_b16 v[130:131], v74 offset:50176
    v_lshlrev_b32 v118, 7, v118
    v_mfma_f32_32x32x16_bf16 v[216:231], v[148:151], v[64:67], v[216:231]
    ds_read_b128 v[52:55], v111 offset:49152
    ds_read_b64_tr_b16 v[132:133], v75 offset:49152
    ds_read_b64_tr_b16 v[134:135], v75 offset:50176
    s_xor_b32 s3, s22, 1
    s_lshl_b32 s3, s3, 31
    v_mov_b32 v116, s3
    v_mfma_f32_32x32x16_bf16 v[168:183], v[152:155], v[68:71], v[168:183]
    ds_read_b64_tr_b16 v[136:137], v76 offset:49152
    ds_read_b64_tr_b16 v[138:139], v76 offset:50176
    s_mul_i32 s80, s16, 20
    s_add_u32 s81, s80, 19
    v_mfma_f32_32x32x16_bf16 v[184:199], v[156:159], v[68:71], v[184:199]
    ds_read_b64_tr_b16 v[140:141], v77 offset:49152
    ds_read_b64_tr_b16 v[142:143], v77 offset:50176
    s_lshr_b32 s80, s80, 7
    s_lshr_b32 s81, s81, 7
    v_mfma_f32_32x32x16_bf16 v[200:215], v[160:163], v[68:71], v[200:215]
    ds_read_b64_tr_b16 v[144:145], v78 offset:49152
    ds_read_b64_tr_b16 v[146:147], v78 offset:50176
    s_sub_u32 s83, s81, s80
    s_lshl_b32 s83, s83, 4
    v_mfma_f32_32x32x16_bf16 v[216:231], v[164:167], v[68:71], v[216:231]
    ds_read_b64_tr_b16 v[148:149], v79 offset:49152
    ds_read_b64_tr_b16 v[150:151], v79 offset:50176
    s_lshl_b32 s80, s80, 4
    s_cmp_lt_u32 s23, 2
    s_cselect_b32 s1, 5, 10
    s_waitcnt lgkmcnt(8)
    v_mfma_f32_32x32x16_bf16 v[168:183], v[120:123], v[40:43], v[168:183]
    ds_read_b64_tr_b16 v[152:153], v80 offset:49152
    ds_read_b64_tr_b16 v[154:155], v80 offset:50176
    s_lshl_b32 s1, s1, 4
    s_lshl_b32 s81, s17, 1
    v_mfma_f32_32x32x16_bf16 v[184:199], v[124:127], v[40:43], v[184:199]
    ds_read_b64_tr_b16 v[156:157], v81 offset:49152
    ds_read_b64_tr_b16 v[158:159], v81 offset:50176
    v_bfe_u32 v18, v1, 1, 1
    v_mul_lo_u32 v18, v18, s83
    v_mfma_f32_32x32x16_bf16 v[200:215], v[128:131], v[40:43], v[200:215]
    ds_read_b64_tr_b16 v[160:161], v82 offset:49152
    ds_read_b64_tr_b16 v[162:163], v82 offset:50176
    v_and_b32 v96, 1, v1
    v_add3_u32 v18, v18, v96, s80
    v_mfma_f32_32x32x16_bf16 v[216:231], v[132:135], v[40:43], v[216:231]
    ds_read_b64_tr_b16 v[164:165], v83 offset:49152
    ds_read_b64_tr_b16 v[166:167], v83 offset:50176
    v_lshrrev_b32 v96, 2, v1
    v_mul_u32_u24 v96, 80, v96
    s_waitcnt lgkmcnt(8)
    v_mfma_f32_32x32x16_bf16 v[168:183], v[136:139], v[44:47], v[168:183]
    ds_read_b64_tr_b16 v[120:121], v84 offset:49152
    ds_read_b64_tr_b16 v[122:123], v84 offset:50176
    v_add_u32 v18, v18, v96
    s_lshl_b32 s3, s41, 1
    v_mov_b32 v96, s3
    v_mfma_f32_32x32x16_bf16 v[184:199], v[140:143], v[44:47], v[184:199]
    ds_read_b64_tr_b16 v[124:125], v85 offset:49152
    ds_read_b64_tr_b16 v[126:127], v85 offset:50176
    v_mov_b32 v19, s81
    v_cmp_gt_u32 vcc, 4, v1
    s_nop 1
    v_cndmask_b32 v96, v96, v19, vcc
    v_mfma_f32_32x32x16_bf16 v[200:215], v[144:147], v[44:47], v[200:215]
    ds_read_b64_tr_b16 v[128:129], v86 offset:49152
    ds_read_b64_tr_b16 v[130:131], v86 offset:50176
    v_add_u32 v18, v18, v96
    v_lshlrev_b32 v18, 7, v18
    v_mfma_f32_32x32x16_bf16 v[216:231], v[148:151], v[44:47], v[216:231]
    ds_read_b64_tr_b16 v[132:133], v87 offset:49152
    ds_read_b64_tr_b16 v[134:135], v87 offset:50176
    v_bfe_u32 v19, v1, 4, 1
    v_mul_lo_u32 v19, v19, s83
    v_mfma_f32_4x4x4_16b_bf16 v[232:235], v[248:249], v[136:137], v[232:235]
    v_mfma_f32_4x4x4_16b_bf16 v[88:91], v[248:249], v[40:41], v[88:91]
    v_mfma_f32_4x4x4_16b_bf16 v[112:115], v[40:41], v[40:41], v[112:115]
    v_mfma_f32_4x4x4_16b_bf16 v[236:239], v[248:249], v[140:141], v[236:239]
    v_mfma_f32_4x4x4_16b_bf16 v[88:91], v[248:249], v[44:45], v[88:91]
    v_mfma_f32_4x4x4_16b_bf16 v[112:115], v[44:45], v[44:45], v[112:115]
    v_mfma_f32_4x4x4_16b_bf16 v[240:243], v[248:249], v[144:145], v[240:243]
    v_mfma_f32_4x4x4_16b_bf16 v[88:91], v[248:249], v[48:49], v[88:91]
    v_mfma_f32_4x4x4_16b_bf16 v[112:115], v[48:49], v[48:49], v[112:115]
    v_mfma_f32_4x4x4_16b_bf16 v[244:247], v[248:249], v[148:149], v[244:247]
    v_mfma_f32_4x4x4_16b_bf16 v[88:91], v[248:249], v[52:53], v[88:91]
    v_mfma_f32_4x4x4_16b_bf16 v[112:115], v[52:53], v[52:53], v[112:115]
    v_mfma_f32_4x4x4_16b_bf16 v[232:235], v[248:249], v[138:139], v[232:235]
    v_mfma_f32_4x4x4_16b_bf16 v[88:91], v[248:249], v[42:43], v[88:91]
    v_mfma_f32_4x4x4_16b_bf16 v[112:115], v[42:43], v[42:43], v[112:115]
    v_mfma_f32_4x4x4_16b_bf16 v[236:239], v[248:249], v[142:143], v[236:239]
    v_mfma_f32_4x4x4_16b_bf16 v[88:91], v[248:249], v[46:47], v[88:91]
    v_mfma_f32_4x4x4_16b_bf16 v[112:115], v[46:47], v[46:47], v[112:115]
    v_mfma_f32_4x4x4_16b_bf16 v[240:243], v[248:249], v[146:147], v[240:243]
    v_mfma_f32_4x4x4_16b_bf16 v[88:91], v[248:249], v[50:51], v[88:91]
    v_mfma_f32_4x4x4_16b_bf16 v[112:115], v[50:51], v[50:51], v[112:115]
    v_mfma_f32_4x4x4_16b_bf16 v[244:247], v[248:249], v[150:151], v[244:247]
    v_mfma_f32_4x4x4_16b_bf16 v[88:91], v[248:249], v[54:55], v[88:91]
    v_mfma_f32_4x4x4_16b_bf16 v[112:115], v[54:55], v[54:55], v[112:115]
    s_waitcnt lgkmcnt(0)
    v_mfma_f32_32x32x16_bf16 v[168:183], v[152:155], v[48:51], v[168:183]
    s_barrier
    ds_read_b128 v[56:59], v108 offset:32768
    ds_read_b64_tr_b16 v[136:137], v72 offset:32768
    ds_read_b64_tr_b16 v[138:139], v72 offset:33792
    v_mfma_f32_32x32x16_bf16 v[184:199], v[156:159], v[48:51], v[184:199]
    ds_read_b128 v[60:63], v109 offset:32768
    ds_read_b64_tr_b16 v[140:141], v73 offset:32768
    ds_read_b64_tr_b16 v[142:143], v73 offset:33792
    v_and_b32 v96, 15, v1
    v_mfma_f32_32x32x16_bf16 v[200:215], v[160:163], v[48:51], v[200:215]
    ds_read_b128 v[64:67], v110 offset:32768
    ds_read_b64_tr_b16 v[144:145], v74 offset:32768
    ds_read_b64_tr_b16 v[146:147], v74 offset:33792
    v_add3_u32 v19, v19, v96, s80
    v_mfma_f32_32x32x16_bf16 v[216:231], v[164:167], v[48:51], v[216:231]
    ds_read_b128 v[68:71], v111 offset:32768
    ds_read_b64_tr_b16 v[148:149], v75 offset:32768
    ds_read_b64_tr_b16 v[150:151], v75 offset:33792
    v_add_u32 v19, s1, v19
    v_mfma_f32_32x32x16_bf16 v[168:183], v[120:123], v[52:55], v[168:183]
    ds_read_b64_tr_b16 v[152:153], v76 offset:32768
    ds_read_b64_tr_b16 v[154:155], v76 offset:33792
    v_lshlrev_b32 v19, 7, v19
    s_mov_b32 s80, 22454272
    v_mfma_f32_32x32x16_bf16 v[184:199], v[124:127], v[52:55], v[184:199]
    ds_read_b64_tr_b16 v[156:157], v77 offset:32768
    ds_read_b64_tr_b16 v[158:159], v77 offset:33792
    v_min_u32 v97, 33, v1
    s_mul_i32 s83, s23, 24
    v_add_u32 v119, s83, v97
    v_mfma_f32_32x32x16_bf16 v[200:215], v[128:131], v[52:55], v[200:215]
    ds_read_b64_tr_b16 v[160:161], v78 offset:32768
    ds_read_b64_tr_b16 v[162:163], v78 offset:33792
    s_mul_i32 s83, s23, 10
    s_add_u32 s83, s83, 72
    v_add_u32 v96, s83, v97
    v_mfma_f32_32x32x16_bf16 v[216:231], v[132:135], v[52:55], v[216:231]
    ds_read_b64_tr_b16 v[164:165], v79 offset:32768
    ds_read_b64_tr_b16 v[166:167], v79 offset:33792
    v_cmp_gt_u32 vcc, 24, v1
    s_nop 1
    v_cndmask_b32 v119, v96, v119, vcc
    s_waitcnt lgkmcnt(8)
    v_mfma_f32_32x32x16_bf16 v[168:183], v[136:139], v[56:59], v[168:183]
    ds_read_b64_tr_b16 v[120:121], v80 offset:32768
    ds_read_b64_tr_b16 v[122:123], v80 offset:33792
    v_lshl_add_u32 v119, v119, 2, s19
    v_lshrrev_b32 v119, 1, v119
    v_mfma_f32_32x32x16_bf16 v[184:199], v[140:143], v[56:59], v[184:199]
    ds_read_b64_tr_b16 v[124:125], v81 offset:32768
    ds_read_b64_tr_b16 v[126:127], v81 offset:33792
    v_subrev_u32 v96, 16, v119
    v_cmp_gt_u32 vcc, 256, v119
    s_nop 1
    v_cndmask_b32 v119, v96, v119, vcc
    v_mfma_f32_32x32x16_bf16 v[200:215], v[144:147], v[56:59], v[200:215]
    ds_read_b64_tr_b16 v[128:129], v82 offset:32768
    ds_read_b64_tr_b16 v[130:131], v82 offset:33792
    v_lshlrev_b32 v119, 7, v119
    v_add_u32 v119, 22454272, v119
    v_mfma_f32_32x32x16_bf16 v[216:231], v[148:151], v[56:59], v[216:231]
    ds_read_b64_tr_b16 v[132:133], v83 offset:32768
    ds_read_b64_tr_b16 v[134:135], v83 offset:33792
    s_lshl_b32 s83, s23, 9
    s_add_u32 s83, s83, 30720
    s_waitcnt lgkmcnt(8)
    v_mfma_f32_32x32x16_bf16 v[168:183], v[152:155], v[60:63], v[168:183]
    ds_read_b64_tr_b16 v[136:137], v84 offset:32768
    ds_read_b64_tr_b16 v[138:139], v84 offset:33792
    v_lshl_add_u32 v255, v2, 4, s83
    v_mfma_f32_32x32x16_bf16 v[184:199], v[156:159], v[60:63], v[184:199]
    ds_read_b64_tr_b16 v[140:141], v85 offset:32768
    ds_read_b64_tr_b16 v[142:143], v85 offset:33792
    v_mfma_f32_32x32x16_bf16 v[200:215], v[160:163], v[60:63], v[200:215]
    ds_read_b64_tr_b16 v[144:145], v86 offset:32768
    ds_read_b64_tr_b16 v[146:147], v86 offset:33792
    v_mfma_f32_32x32x16_bf16 v[216:231], v[164:167], v[60:63], v[216:231]
    ds_read_b64_tr_b16 v[148:149], v87 offset:32768
    ds_read_b64_tr_b16 v[150:151], v87 offset:33792
    v_mfma_f32_4x4x4_16b_bf16 v[232:235], v[248:249], v[152:153], v[232:235]
    v_mfma_f32_4x4x4_16b_bf16 v[88:91], v[248:249], v[56:57], v[88:91]
    v_mfma_f32_4x4x4_16b_bf16 v[112:115], v[56:57], v[56:57], v[112:115]
    v_mfma_f32_4x4x4_16b_bf16 v[236:239], v[248:249], v[156:157], v[236:239]
    v_mfma_f32_4x4x4_16b_bf16 v[88:91], v[248:249], v[60:61], v[88:91]
    v_mfma_f32_4x4x4_16b_bf16 v[112:115], v[60:61], v[60:61], v[112:115]
    v_mfma_f32_4x4x4_16b_bf16 v[240:243], v[248:249], v[160:161], v[240:243]
    v_mfma_f32_4x4x4_16b_bf16 v[88:91], v[248:249], v[64:65], v[88:91]
    v_mfma_f32_4x4x4_16b_bf16 v[112:115], v[64:65], v[64:65], v[112:115]
    v_mfma_f32_4x4x4_16b_bf16 v[244:247], v[248:249], v[164:165], v[244:247]
    v_mfma_f32_4x4x4_16b_bf16 v[88:91], v[248:249], v[68:69], v[88:91]
    v_mfma_f32_4x4x4_16b_bf16 v[112:115], v[68:69], v[68:69], v[112:115]
    v_mfma_f32_4x4x4_16b_bf16 v[232:235], v[248:249], v[154:155], v[232:235]
    v_mfma_f32_4x4x4_16b_bf16 v[88:91], v[248:249], v[58:59], v[88:91]
    v_mfma_f32_4x4x4_16b_bf16 v[112:115], v[58:59], v[58:59], v[112:115]
    v_mfma_f32_4x4x4_16b_bf16 v[236:239], v[248:249], v[158:159], v[236:239]
    v_mfma_f32_4x4x4_16b_bf16 v[88:91], v[248:249], v[62:63], v[88:91]
    v_mfma_f32_4x4x4_16b_bf16 v[112:115], v[62:63], v[62:63], v[112:115]
    v_mfma_f32_4x4x4_16b_bf16 v[240:243], v[248:249], v[162:163], v[240:243]
    v_mfma_f32_4x4x4_16b_bf16 v[88:91], v[248:249], v[66:67], v[88:91]
    v_mfma_f32_4x4x4_16b_bf16 v[112:115], v[66:67], v[66:67], v[112:115]
    v_mfma_f32_4x4x4_16b_bf16 v[244:247], v[248:249], v[166:167], v[244:247]
    v_mfma_f32_4x4x4_16b_bf16 v[88:91], v[248:249], v[70:71], v[88:91]
    v_mfma_f32_4x4x4_16b_bf16 v[112:115], v[70:71], v[70:71], v[112:115]
    s_waitcnt lgkmcnt(0)
    v_mfma_f32_32x32x16_bf16 v[168:183], v[120:123], v[64:67], v[168:183]
    s_barrier
    ds_read_b128 v[40:43], v108 offset:16384
    ds_read_b64_tr_b16 v[152:153], v72 offset:16384
    ds_read_b64_tr_b16 v[154:155], v72 offset:17408
    v_mfma_f32_32x32x16_bf16 v[184:199], v[124:127], v[64:67], v[184:199]
    ds_read_b128 v[44:47], v109 offset:16384
    ds_read_b64_tr_b16 v[156:157], v73 offset:16384
    ds_read_b64_tr_b16 v[158:159], v73 offset:17408
    v_mfma_f32_32x32x16_bf16 v[200:215], v[128:131], v[64:67], v[200:215]
    ds_read_b128 v[48:51], v110 offset:16384
    ds_read_b64_tr_b16 v[160:161], v74 offset:16384
    ds_read_b64_tr_b16 v[162:163], v74 offset:17408
    v_mfma_f32_32x32x16_bf16 v[216:231], v[132:135], v[64:67], v[216:231]
    ds_read_b128 v[52:55], v111 offset:16384
    ds_read_b64_tr_b16 v[164:165], v75 offset:16384
    ds_read_b64_tr_b16 v[166:167], v75 offset:17408
    v_mfma_f32_32x32x16_bf16 v[168:183], v[136:139], v[68:71], v[168:183]
    ds_read_b64_tr_b16 v[120:121], v76 offset:16384
    ds_read_b64_tr_b16 v[122:123], v76 offset:17408
    v_mfma_f32_32x32x16_bf16 v[184:199], v[140:143], v[68:71], v[184:199]
    ds_read_b64_tr_b16 v[124:125], v77 offset:16384
    ds_read_b64_tr_b16 v[126:127], v77 offset:17408
    v_mfma_f32_32x32x16_bf16 v[200:215], v[144:147], v[68:71], v[200:215]
    ds_read_b64_tr_b16 v[128:129], v78 offset:16384
    ds_read_b64_tr_b16 v[130:131], v78 offset:17408
    v_mfma_f32_32x32x16_bf16 v[216:231], v[148:151], v[68:71], v[216:231]
    ds_read_b64_tr_b16 v[132:133], v79 offset:16384
    ds_read_b64_tr_b16 v[134:135], v79 offset:17408
    s_waitcnt lgkmcnt(8)
    v_mfma_f32_32x32x16_bf16 v[168:183], v[152:155], v[40:43], v[168:183]
    ds_read_b64_tr_b16 v[136:137], v80 offset:16384
    ds_read_b64_tr_b16 v[138:139], v80 offset:17408
    v_mfma_f32_32x32x16_bf16 v[184:199], v[156:159], v[40:43], v[184:199]
    ds_read_b64_tr_b16 v[140:141], v81 offset:16384
    ds_read_b64_tr_b16 v[142:143], v81 offset:17408
    v_mfma_f32_32x32x16_bf16 v[200:215], v[160:163], v[40:43], v[200:215]
    ds_read_b64_tr_b16 v[144:145], v82 offset:16384
    ds_read_b64_tr_b16 v[146:147], v82 offset:17408
    v_mfma_f32_32x32x16_bf16 v[216:231], v[164:167], v[40:43], v[216:231]
    ds_read_b64_tr_b16 v[148:149], v83 offset:16384
    ds_read_b64_tr_b16 v[150:151], v83 offset:17408
    s_waitcnt lgkmcnt(8)
    v_mfma_f32_32x32x16_bf16 v[168:183], v[120:123], v[44:47], v[168:183]
    ds_read_b64_tr_b16 v[152:153], v84 offset:16384
    ds_read_b64_tr_b16 v[154:155], v84 offset:17408
    s_waitcnt vmcnt(0)
    v_readfirstlane_b32 s90, v106
    v_mfma_f32_32x32x16_bf16 v[184:199], v[124:127], v[44:47], v[184:199]
    ds_read_b64_tr_b16 v[156:157], v85 offset:16384
    ds_read_b64_tr_b16 v[158:159], v85 offset:17408
    v_readfirstlane_b32 s81, v107
    v_mfma_f32_32x32x16_bf16 v[200:215], v[128:131], v[44:47], v[200:215]
    ds_read_b64_tr_b16 v[160:161], v86 offset:16384
    ds_read_b64_tr_b16 v[162:163], v86 offset:17408
    v_mfma_f32_32x32x16_bf16 v[216:231], v[132:135], v[44:47], v[216:231]
    ds_read_b64_tr_b16 v[164:165], v87 offset:16384
    ds_read_b64_tr_b16 v[166:167], v87 offset:17408
    v_mfma_f32_4x4x4_16b_bf16 v[232:235], v[248:249], v[120:121], v[232:235]
    v_mfma_f32_4x4x4_16b_bf16 v[88:91], v[248:249], v[40:41], v[88:91]
    v_mfma_f32_4x4x4_16b_bf16 v[112:115], v[40:41], v[40:41], v[112:115]
    v_mfma_f32_4x4x4_16b_bf16 v[236:239], v[248:249], v[124:125], v[236:239]
    v_mfma_f32_4x4x4_16b_bf16 v[88:91], v[248:249], v[44:45], v[88:91]
    v_mfma_f32_4x4x4_16b_bf16 v[112:115], v[44:45], v[44:45], v[112:115]
    v_mfma_f32_4x4x4_16b_bf16 v[240:243], v[248:249], v[128:129], v[240:243]
    v_mfma_f32_4x4x4_16b_bf16 v[88:91], v[248:249], v[48:49], v[88:91]
    v_mfma_f32_4x4x4_16b_bf16 v[112:115], v[48:49], v[48:49], v[112:115]
    v_mfma_f32_4x4x4_16b_bf16 v[244:247], v[248:249], v[132:133], v[244:247]
    v_mfma_f32_4x4x4_16b_bf16 v[88:91], v[248:249], v[52:53], v[88:91]
    v_mfma_f32_4x4x4_16b_bf16 v[112:115], v[52:53], v[52:53], v[112:115]
    v_mfma_f32_4x4x4_16b_bf16 v[232:235], v[248:249], v[122:123], v[232:235]
    v_mfma_f32_4x4x4_16b_bf16 v[88:91], v[248:249], v[42:43], v[88:91]
    v_mfma_f32_4x4x4_16b_bf16 v[112:115], v[42:43], v[42:43], v[112:115]
    v_mfma_f32_4x4x4_16b_bf16 v[236:239], v[248:249], v[126:127], v[236:239]
    v_mfma_f32_4x4x4_16b_bf16 v[88:91], v[248:249], v[46:47], v[88:91]
    v_mfma_f32_4x4x4_16b_bf16 v[112:115], v[46:47], v[46:47], v[112:115]
    v_mfma_f32_4x4x4_16b_bf16 v[240:243], v[248:249], v[130:131], v[240:243]
    v_mfma_f32_4x4x4_16b_bf16 v[88:91], v[248:249], v[50:51], v[88:91]
    v_mfma_f32_4x4x4_16b_bf16 v[112:115], v[50:51], v[50:51], v[112:115]
    v_mfma_f32_4x4x4_16b_bf16 v[244:247], v[248:249], v[134:135], v[244:247]
    v_mfma_f32_4x4x4_16b_bf16 v[88:91], v[248:249], v[54:55], v[88:91]
    v_mfma_f32_4x4x4_16b_bf16 v[112:115], v[54:55], v[54:55], v[112:115]
    s_waitcnt lgkmcnt(0)
    v_mfma_f32_32x32x16_bf16 v[168:183], v[136:139], v[48:51], v[168:183]
    s_barrier
    ds_read_b128 v[56:59], v108 offset:0
    ds_read_b64_tr_b16 v[120:121], v72 offset:0
    ds_read_b64_tr_b16 v[122:123], v72 offset:1024
    v_mfma_f32_32x32x16_bf16 v[184:199], v[140:143], v[48:51], v[184:199]
    ds_read_b128 v[60:63], v109 offset:0
    ds_read_b64_tr_b16 v[124:125], v73 offset:0
    ds_read_b64_tr_b16 v[126:127], v73 offset:1024
    v_mfma_f32_32x32x16_bf16 v[200:215], v[144:147], v[48:51], v[200:215]
    ds_read_b128 v[64:67], v110 offset:0
    ds_read_b64_tr_b16 v[128:129], v74 offset:0
    ds_read_b64_tr_b16 v[130:131], v74 offset:1024
    v_mfma_f32_32x32x16_bf16 v[216:231], v[148:151], v[48:51], v[216:231]
    ds_read_b128 v[68:71], v111 offset:0
    ds_read_b64_tr_b16 v[132:133], v75 offset:0
    ds_read_b64_tr_b16 v[134:135], v75 offset:1024
    v_mfma_f32_32x32x16_bf16 v[168:183], v[152:155], v[52:55], v[168:183]
    ds_read_b64_tr_b16 v[136:137], v76 offset:0
    ds_read_b64_tr_b16 v[138:139], v76 offset:1024
    v_mfma_f32_32x32x16_bf16 v[184:199], v[156:159], v[52:55], v[184:199]
    ds_read_b64_tr_b16 v[140:141], v77 offset:0
    ds_read_b64_tr_b16 v[142:143], v77 offset:1024
    v_mfma_f32_32x32x16_bf16 v[200:215], v[160:163], v[52:55], v[200:215]
    ds_read_b64_tr_b16 v[144:145], v78 offset:0
    ds_read_b64_tr_b16 v[146:147], v78 offset:1024
    v_mfma_f32_32x32x16_bf16 v[216:231], v[164:167], v[52:55], v[216:231]
    ds_read_b64_tr_b16 v[148:149], v79 offset:0
    ds_read_b64_tr_b16 v[150:151], v79 offset:1024
    s_waitcnt lgkmcnt(8)
    v_mfma_f32_32x32x16_bf16 v[168:183], v[120:123], v[56:59], v[168:183]
    ds_read_b64_tr_b16 v[152:153], v80 offset:0
    ds_read_b64_tr_b16 v[154:155], v80 offset:1024
    v_mfma_f32_32x32x16_bf16 v[184:199], v[124:127], v[56:59], v[184:199]
    ds_read_b64_tr_b16 v[156:157], v81 offset:0
    ds_read_b64_tr_b16 v[158:159], v81 offset:1024
    v_mfma_f32_32x32x16_bf16 v[200:215], v[128:131], v[56:59], v[200:215]
    ds_read_b64_tr_b16 v[160:161], v82 offset:0
    ds_read_b64_tr_b16 v[162:163], v82 offset:1024
    v_mfma_f32_32x32x16_bf16 v[216:231], v[132:135], v[56:59], v[216:231]
    ds_read_b64_tr_b16 v[164:165], v83 offset:0
    ds_read_b64_tr_b16 v[166:167], v83 offset:1024
    v_mfma_f32_4x4x4_16b_bf16 v[232:235], v[248:249], v[120:121], v[232:235]
    v_mfma_f32_4x4x4_16b_bf16 v[88:91], v[248:249], v[56:57], v[88:91]
    v_mfma_f32_4x4x4_16b_bf16 v[112:115], v[56:57], v[56:57], v[112:115]
    v_mfma_f32_4x4x4_16b_bf16 v[236:239], v[248:249], v[124:125], v[236:239]
    v_mfma_f32_4x4x4_16b_bf16 v[88:91], v[248:249], v[60:61], v[88:91]
    v_mfma_f32_4x4x4_16b_bf16 v[112:115], v[60:61], v[60:61], v[112:115]
    v_mfma_f32_4x4x4_16b_bf16 v[240:243], v[248:249], v[128:129], v[240:243]
    v_mfma_f32_4x4x4_16b_bf16 v[88:91], v[248:249], v[64:65], v[88:91]
    v_mfma_f32_4x4x4_16b_bf16 v[112:115], v[64:65], v[64:65], v[112:115]
    v_mfma_f32_4x4x4_16b_bf16 v[244:247], v[248:249], v[132:133], v[244:247]
    v_mfma_f32_4x4x4_16b_bf16 v[88:91], v[248:249], v[68:69], v[88:91]
    v_mfma_f32_4x4x4_16b_bf16 v[112:115], v[68:69], v[68:69], v[112:115]
    v_mfma_f32_4x4x4_16b_bf16 v[232:235], v[248:249], v[122:123], v[232:235]
    v_mfma_f32_4x4x4_16b_bf16 v[88:91], v[248:249], v[58:59], v[88:91]
    v_mfma_f32_4x4x4_16b_bf16 v[112:115], v[58:59], v[58:59], v[112:115]
    v_mfma_f32_4x4x4_16b_bf16 v[236:239], v[248:249], v[126:127], v[236:239]
    v_mfma_f32_4x4x4_16b_bf16 v[88:91], v[248:249], v[62:63], v[88:91]
    v_mfma_f32_4x4x4_16b_bf16 v[112:115], v[62:63], v[62:63], v[112:115]
    v_mfma_f32_4x4x4_16b_bf16 v[240:243], v[248:249], v[130:131], v[240:243]
    v_mfma_f32_4x4x4_16b_bf16 v[88:91], v[248:249], v[66:67], v[88:91]
    v_mfma_f32_4x4x4_16b_bf16 v[112:115], v[66:67], v[66:67], v[112:115]
    v_mfma_f32_4x4x4_16b_bf16 v[244:247], v[248:249], v[134:135], v[244:247]
    v_mfma_f32_4x4x4_16b_bf16 v[88:91], v[248:249], v[70:71], v[88:91]
    v_mfma_f32_4x4x4_16b_bf16 v[112:115], v[70:71], v[70:71], v[112:115]
    s_waitcnt lgkmcnt(8)
    v_mfma_f32_32x32x16_bf16 v[168:183], v[136:139], v[60:63], v[168:183]
    ds_read_b64_tr_b16 v[120:121], v84 offset:0
    ds_read_b64_tr_b16 v[122:123], v84 offset:1024
    s_nop 1
    ds_write_b32 v95, v232 offset:0
    ds_write_b32 v95, v236 offset:1024
    v_mfma_f32_32x32x16_bf16 v[184:199], v[140:143], v[60:63], v[184:199]
    ds_read_b64_tr_b16 v[124:125], v85 offset:0
    ds_read_b64_tr_b16 v[126:127], v85 offset:1024
    ds_write_b32 v95, v240 offset:2048
    ds_write_b32 v95, v244 offset:3072
    s_mov_b32 s3, 0x3acccccd
    v_mfma_f32_32x32x16_bf16 v[200:215], v[144:147], v[60:63], v[200:215]
    ds_read_b64_tr_b16 v[128:129], v86 offset:0
    ds_read_b64_tr_b16 v[130:131], v86 offset:1024
    s_mov_b32 s92, 0xaaaaaaaa
    s_mov_b32 s93, 0xaaaaaaaa
    s_mov_b32 s94, 0xcccccccc
    s_mov_b32 s95, 0xcccccccc
    v_mfma_f32_32x32x16_bf16 v[216:231], v[148:151], v[60:63], v[216:231]
    ds_read_b64_tr_b16 v[132:133], v87 offset:0
    ds_read_b64_tr_b16 v[134:135], v87 offset:1024
    v_cndmask_b32 v112, v112, v113, s[92:93]
    v_cndmask_b32 v114, v114, v115, s[92:93]
    v_cndmask_b32 v112, v112, v114, s[94:95]
    s_waitcnt lgkmcnt(0)
    v_mfma_f32_32x32x16_bf16 v[168:183], v[152:155], v[64:67], v[168:183]
    s_barrier
    s_add_u32 m0, s45, 81920
    s_add_u32 s1, s96, 1376256
    s_cmp_ge_u32 s1, s97
    s_cselect_b32 s0, 1966080, 0
    s_sub_u32 s1, s1, s0
    buffer_load_dwordx4 v250, s[36:39], s1 offen offset:0 lds
    v_mfma_f32_32x32x16_bf16 v[184:199], v[156:159], v[64:67], v[184:199]
    buffer_load_dwordx4 v251, s[36:39], s1 offen offset:1024 lds
    ds_read_b128 v[84:87], v253 offset:3072
    ds_read_b128 v[80:83], v253 offset:2048
    ds_read_b128 v[76:79], v253 offset:1024
    ds_read_b128 v[72:75], v253 offset:0
    v_mfma_f32_32x32x16_bf16 v[200:215], v[160:163], v[64:67], v[200:215]
    buffer_load_dwordx4 v252, s[36:39], s1 offen offset:2048 lds
    v_mov_b32 v89, v88
    v_mov_b32 v113, v112
    s_nop 1
    v_permlane32_swap_b32 v88, v89
    v_mfma_f32_32x32x16_bf16 v[216:231], v[164:167], v[64:67], v[216:231]
    s_add_u32 m0, s45, 69632
    s_add_u32 s1, s96, 1572864
    s_cmp_ge_u32 s1, s97
    s_cselect_b32 s0, 1966080, 0
    s_sub_u32 s1, s1, s0
    buffer_load_dwordx4 v250, s[36:39], s1 offen offset:0 lds
    v_mfma_f32_32x32x16_bf16 v[168:183], v[120:123], v[68:71], v[168:183]
    buffer_load_dwordx4 v251, s[36:39], s1 offen offset:1024 lds
    v_permlane32_swap_b32 v112, v113
    s_nop 1
    v_add_f32 v88, v88, v89
    v_add_f32 v112, v112, v113
    v_mfma_f32_32x32x16_bf16 v[184:199], v[124:127], v[68:71], v[184:199]
    buffer_load_dwordx4 v252, s[36:39], s1 offen offset:2048 lds
    v_mul_f32 v88, s3, v88
    v_mul_f32 v112, s3, v112
    v_fma_f32 v112, -v88, v88, v112
    v_max_f32 v112, 0, v112
    v_mfma_f32_32x32x16_bf16 v[200:215], v[128:131], v[68:71], v[200:215]
    s_add_u32 m0, s45, 57344
    s_add_u32 s1, s96, 1769472
    s_cmp_ge_u32 s1, s97
    s_cselect_b32 s0, 1966080, 0
    s_sub_u32 s1, s1, s0
    buffer_load_dwordx4 v250, s[36:39], s1 offen offset:0 lds
    v_mfma_f32_32x32x16_bf16 v[216:231], v[132:135], v[68:71], v[216:231]
    buffer_load_dwordx4 v251, s[36:39], s1 offen offset:1024 lds
    v_cvt_pk_bf16_f32 v92, -v88, -v88
    v_cvt_pk_bf16_f32 v112, v112, v112
    v_and_b32 v112, 0xffff0000, v112
    v_add_f32 v112, 0x3727c5ac, v112
    buffer_load_dwordx4 v252, s[36:39], s1 offen offset:2048 lds
    v_cvt_pk_bf16_f32 v112, v112, v112
    v_and_b32 v112, 0xffff0000, v112
    v_sqrt_f32 v112, v112
    s_nop 0
    v_cvt_pk_bf16_f32 v93, v112, 0
    v_lshlrev_b32 v94, 16, v93
    v_rcp_f32 v94, v94
    s_nop 0
    v_mov_b32 v100, v94
    s_waitcnt lgkmcnt(0)
    v_add_f32 v72, v72, v73
    v_add_f32 v74, v74, v75
    v_add_f32 v72, v72, v74
    v_and_b32 v73, 0xffff0000, v72
    v_sub_f32 v72, v72, v73
    v_cvt_pk_bf16_f32 v8, v73, v72
    v_add_f32 v76, v76, v77
    v_add_f32 v78, v78, v79
    v_add_f32 v76, v76, v78
    v_and_b32 v77, 0xffff0000, v76
    v_sub_f32 v76, v76, v77
    v_cvt_pk_bf16_f32 v10, v77, v76
    v_add_f32 v80, v80, v81
    v_add_f32 v82, v82, v83
    v_add_f32 v80, v80, v82
    v_and_b32 v81, 0xffff0000, v80
    v_sub_f32 v80, v80, v81
    v_cvt_pk_bf16_f32 v12, v81, v80
    v_add_f32 v84, v84, v85
    v_add_f32 v86, v86, v87
    v_add_f32 v84, v84, v86
    v_and_b32 v85, 0xffff0000, v84
    v_sub_f32 v84, v84, v85
    v_cvt_pk_bf16_f32 v14, v85, v84
    s_nop 0
    v_mfma_f32_32x32x8_bf16 v[168:183], v[8:9], v[92:93], v[168:183]
    v_mfma_f32_32x32x8_bf16 v[184:199], v[10:11], v[92:93], v[184:199]
    v_mfma_f32_32x32x8_bf16 v[200:215], v[12:13], v[92:93], v[200:215]
    v_mfma_f32_32x32x8_bf16 v[216:231], v[14:15], v[92:93], v[216:231]
    s_setprio 3
    s_cmp_lt_u32 s21, 5
    s_cselect_b32 s3, 0x3ea52b5c, 1.0
    v_mul_f32 v100, s3, v100
    s_lshl_b32 s1, s21, 13
    s_mul_i32 s3, s91, 81920
    s_add_u32 s1, s1, s3
    s_nop 3
    v_mul_f32 v168, v100, v168
    v_mul_f32 v169, v100, v169
    v_mul_f32 v170, v100, v170
    v_mul_f32 v171, v100, v171
    v_mul_f32 v172, v100, v172
    v_mul_f32 v173, v100, v173
    v_mul_f32 v174, v100, v174
    v_mul_f32 v175, v100, v175
    v_cvt_pk_bf16_f32 v168, v168, v169
    v_cvt_pk_bf16_f32 v169, v170, v171
    v_cvt_pk_bf16_f32 v170, v172, v173
    v_cvt_pk_bf16_f32 v171, v174, v175
    s_nop 0
    v_permlane32_swap_b32 v168, v170
    v_permlane32_swap_b32 v169, v171
    buffer_store_dwordx4 v[168:171], v0, s[28:31], s1 offen offset:0 sc1
    v_mul_f32 v176, v100, v176
    v_mul_f32 v177, v100, v177
    v_mul_f32 v178, v100, v178
    v_mul_f32 v179, v100, v179
    v_mul_f32 v180, v100, v180
    v_mul_f32 v181, v100, v181
    v_mul_f32 v182, v100, v182
    v_mul_f32 v183, v100, v183
    v_cvt_pk_bf16_f32 v172, v176, v177
    v_cvt_pk_bf16_f32 v173, v178, v179
    v_cvt_pk_bf16_f32 v174, v180, v181
    v_cvt_pk_bf16_f32 v175, v182, v183
    s_nop 0
    v_permlane32_swap_b32 v172, v174
    v_permlane32_swap_b32 v173, v175
    buffer_store_dwordx4 v[172:175], v0, s[28:31], s1 offen offset:1024 sc1
    v_mul_f32 v184, v100, v184
    v_mul_f32 v185, v100, v185
    v_mul_f32 v186, v100, v186
    v_mul_f32 v187, v100, v187
    v_mul_f32 v188, v100, v188
    v_mul_f32 v189, v100, v189
    v_mul_f32 v190, v100, v190
    v_mul_f32 v191, v100, v191
    v_cvt_pk_bf16_f32 v184, v184, v185
    v_cvt_pk_bf16_f32 v185, v186, v187
    v_cvt_pk_bf16_f32 v186, v188, v189
    v_cvt_pk_bf16_f32 v187, v190, v191
    s_nop 0
    v_permlane32_swap_b32 v184, v186
    v_permlane32_swap_b32 v185, v187
    buffer_store_dwordx4 v[184:187], v0, s[28:31], s1 offen offset:2048 sc1
    v_mul_f32 v192, v100, v192
    v_mul_f32 v193, v100, v193
    v_mul_f32 v194, v100, v194
    v_mul_f32 v195, v100, v195
    v_mul_f32 v196, v100, v196
    v_mul_f32 v197, v100, v197
    v_mul_f32 v198, v100, v198
    v_mul_f32 v199, v100, v199
    v_cvt_pk_bf16_f32 v188, v192, v193
    v_cvt_pk_bf16_f32 v189, v194, v195
    v_cvt_pk_bf16_f32 v190, v196, v197
    v_cvt_pk_bf16_f32 v191, v198, v199
    s_nop 0
    v_permlane32_swap_b32 v188, v190
    v_permlane32_swap_b32 v189, v191
    buffer_store_dwordx4 v[188:191], v0, s[28:31], s1 offen offset:3072 sc1
    s_add_u32 s1, s1, 4096
    v_mul_f32 v200, v100, v200
    v_mul_f32 v201, v100, v201
    v_mul_f32 v202, v100, v202
    v_mul_f32 v203, v100, v203
    v_mul_f32 v204, v100, v204
    v_mul_f32 v205, v100, v205
    v_mul_f32 v206, v100, v206
    v_mul_f32 v207, v100, v207
    v_cvt_pk_bf16_f32 v200, v200, v201
    v_cvt_pk_bf16_f32 v201, v202, v203
    v_cvt_pk_bf16_f32 v202, v204, v205
    v_cvt_pk_bf16_f32 v203, v206, v207
    s_nop 0
    v_permlane32_swap_b32 v200, v202
    v_permlane32_swap_b32 v201, v203
    buffer_store_dwordx4 v[200:203], v0, s[28:31], s1 offen offset:0 sc1
    v_mul_f32 v208, v100, v208
    v_mul_f32 v209, v100, v209
    v_mul_f32 v210, v100, v210
    v_mul_f32 v211, v100, v211
    v_mul_f32 v212, v100, v212
    v_mul_f32 v213, v100, v213
    v_mul_f32 v214, v100, v214
    v_mul_f32 v215, v100, v215
    v_cvt_pk_bf16_f32 v204, v208, v209
    v_cvt_pk_bf16_f32 v205, v210, v211
    v_cvt_pk_bf16_f32 v206, v212, v213
    v_cvt_pk_bf16_f32 v207, v214, v215
    s_nop 0
    v_permlane32_swap_b32 v204, v206
    v_permlane32_swap_b32 v205, v207
    buffer_store_dwordx4 v[204:207], v0, s[28:31], s1 offen offset:1024 sc1
    v_mul_f32 v216, v100, v216
    v_mul_f32 v217, v100, v217
    v_mul_f32 v218, v100, v218
    v_mul_f32 v219, v100, v219
    v_mul_f32 v220, v100, v220
    v_mul_f32 v221, v100, v221
    v_mul_f32 v222, v100, v222
    v_mul_f32 v223, v100, v223
    v_cvt_pk_bf16_f32 v216, v216, v217
    v_cvt_pk_bf16_f32 v217, v218, v219
    v_cvt_pk_bf16_f32 v218, v220, v221
    v_cvt_pk_bf16_f32 v219, v222, v223
    s_nop 0
    v_permlane32_swap_b32 v216, v218
    v_permlane32_swap_b32 v217, v219
    buffer_store_dwordx4 v[216:219], v0, s[28:31], s1 offen offset:2048 sc1
    v_mul_f32 v224, v100, v224
    v_mul_f32 v225, v100, v225
    v_mul_f32 v226, v100, v226
    v_mul_f32 v227, v100, v227
    v_mul_f32 v228, v100, v228
    v_mul_f32 v229, v100, v229
    v_mul_f32 v230, v100, v230
    v_mul_f32 v231, v100, v231
    v_cvt_pk_bf16_f32 v220, v224, v225
    v_cvt_pk_bf16_f32 v221, v226, v227
    v_cvt_pk_bf16_f32 v222, v228, v229
    v_cvt_pk_bf16_f32 v223, v230, v231
    s_nop 0
    v_permlane32_swap_b32 v220, v222
    v_permlane32_swap_b32 v221, v223
    buffer_store_dwordx4 v[220:223], v0, s[28:31], s1 offen offset:3072 sc1
    s_branch L_g0m
L_g0V:
    s_setprio 0
    s_waitcnt vmcnt(9)
    s_waitcnt lgkmcnt(0)
    s_barrier
    ds_read_b128 v[40:43], v108 offset:16384
    ds_read_b128 v[44:47], v109 offset:16384
    ds_read_b128 v[48:51], v110 offset:16384
    ds_read_b128 v[52:55], v111 offset:16384
    ds_read_b64_tr_b16 v[120:121], v72 offset:16384
    ds_read_b64_tr_b16 v[122:123], v72 offset:17408
    ds_read_b64_tr_b16 v[124:125], v73 offset:16384
    ds_read_b64_tr_b16 v[126:127], v73 offset:17408
    ds_read_b64_tr_b16 v[128:129], v74 offset:16384
    ds_read_b64_tr_b16 v[130:131], v74 offset:17408
    ds_read_b64_tr_b16 v[132:133], v75 offset:16384
    ds_read_b64_tr_b16 v[134:135], v75 offset:17408
    ds_read_b64_tr_b16 v[136:137], v76 offset:16384
    ds_read_b64_tr_b16 v[138:139], v76 offset:17408
    ds_read_b64_tr_b16 v[140:141], v77 offset:16384
    ds_read_b64_tr_b16 v[142:143], v77 offset:17408
    ds_read_b64_tr_b16 v[144:145], v78 offset:16384
    ds_read_b64_tr_b16 v[146:147], v78 offset:17408
    ds_read_b64_tr_b16 v[148:149], v79 offset:16384
    ds_read_b64_tr_b16 v[150:151], v79 offset:17408
    s_waitcnt lgkmcnt(8)
    v_mfma_f32_32x32x16_bf16 v[168:183], v[40:43], v[120:123], 0
    ds_read_b64_tr_b16 v[152:153], v80 offset:16384
    ds_read_b64_tr_b16 v[154:155], v80 offset:17408
    v_mfma_f32_32x32x16_bf16 v[184:199], v[40:43], v[124:127], 0
    ds_read_b64_tr_b16 v[156:157], v81 offset:16384
    ds_read_b64_tr_b16 v[158:159], v81 offset:17408
    v_mfma_f32_32x32x16_bf16 v[200:215], v[40:43], v[128:131], 0
    ds_read_b64_tr_b16 v[160:161], v82 offset:16384
    ds_read_b64_tr_b16 v[162:163], v82 offset:17408
    v_mfma_f32_32x32x16_bf16 v[216:231], v[40:43], v[132:135], 0
    ds_read_b64_tr_b16 v[164:165], v83 offset:16384
    ds_read_b64_tr_b16 v[166:167], v83 offset:17408
    s_waitcnt lgkmcnt(8)
    v_mfma_f32_32x32x16_bf16 v[168:183], v[44:47], v[136:139], v[168:183]
    ds_read_b64_tr_b16 v[120:121], v84 offset:16384
    ds_read_b64_tr_b16 v[122:123], v84 offset:17408
    v_mfma_f32_32x32x16_bf16 v[184:199], v[44:47], v[140:143], v[184:199]
    ds_read_b64_tr_b16 v[124:125], v85 offset:16384
    ds_read_b64_tr_b16 v[126:127], v85 offset:17408
    v_mfma_f32_32x32x16_bf16 v[200:215], v[44:47], v[144:147], v[200:215]
    ds_read_b64_tr_b16 v[128:129], v86 offset:16384
    ds_read_b64_tr_b16 v[130:131], v86 offset:17408
    v_mfma_f32_32x32x16_bf16 v[216:231], v[44:47], v[148:151], v[216:231]
    ds_read_b64_tr_b16 v[132:133], v87 offset:16384
    ds_read_b64_tr_b16 v[134:135], v87 offset:17408
    v_mfma_f32_4x4x4_16b_bf16 v[232:235], v[248:249], v[136:137], 0
    v_mfma_f32_4x4x4_16b_bf16 v[88:91], v[248:249], v[40:41], 0
    v_mfma_f32_4x4x4_16b_bf16 v[112:115], v[40:41], v[40:41], 0
    v_mfma_f32_4x4x4_16b_bf16 v[236:239], v[248:249], v[140:141], 0
    v_mfma_f32_4x4x4_16b_bf16 v[88:91], v[248:249], v[44:45], v[88:91]
    v_mfma_f32_4x4x4_16b_bf16 v[112:115], v[44:45], v[44:45], v[112:115]
    v_mfma_f32_4x4x4_16b_bf16 v[240:243], v[248:249], v[144:145], 0
    v_mfma_f32_4x4x4_16b_bf16 v[88:91], v[248:249], v[48:49], v[88:91]
    v_mfma_f32_4x4x4_16b_bf16 v[112:115], v[48:49], v[48:49], v[112:115]
    v_mfma_f32_4x4x4_16b_bf16 v[244:247], v[248:249], v[148:149], 0
    v_mfma_f32_4x4x4_16b_bf16 v[88:91], v[248:249], v[52:53], v[88:91]
    v_mfma_f32_4x4x4_16b_bf16 v[112:115], v[52:53], v[52:53], v[112:115]
    v_mfma_f32_4x4x4_16b_bf16 v[232:235], v[248:249], v[138:139], v[232:235]
    v_mfma_f32_4x4x4_16b_bf16 v[88:91], v[248:249], v[42:43], v[88:91]
    v_mfma_f32_4x4x4_16b_bf16 v[112:115], v[42:43], v[42:43], v[112:115]
    v_mfma_f32_4x4x4_16b_bf16 v[236:239], v[248:249], v[142:143], v[236:239]
    v_mfma_f32_4x4x4_16b_bf16 v[88:91], v[248:249], v[46:47], v[88:91]
    v_mfma_f32_4x4x4_16b_bf16 v[112:115], v[46:47], v[46:47], v[112:115]
    v_mfma_f32_4x4x4_16b_bf16 v[240:243], v[248:249], v[146:147], v[240:243]
    v_mfma_f32_4x4x4_16b_bf16 v[88:91], v[248:249], v[50:51], v[88:91]
    v_mfma_f32_4x4x4_16b_bf16 v[112:115], v[50:51], v[50:51], v[112:115]
    v_mfma_f32_4x4x4_16b_bf16 v[244:247], v[248:249], v[150:151], v[244:247]
    v_mfma_f32_4x4x4_16b_bf16 v[88:91], v[248:249], v[54:55], v[88:91]
    v_mfma_f32_4x4x4_16b_bf16 v[112:115], v[54:55], v[54:55], v[112:115]
    s_waitcnt lgkmcnt(0)
    v_mfma_f32_32x32x16_bf16 v[168:183], v[48:51], v[152:155], v[168:183]
    s_waitcnt vmcnt(4)
    s_barrier
    ds_read_b128 v[56:59], v108 offset:0
    ds_read_b64_tr_b16 v[136:137], v72 offset:0
    ds_read_b64_tr_b16 v[138:139], v72 offset:1024
    v_mfma_f32_32x32x16_bf16 v[184:199], v[48:51], v[156:159], v[184:199]
    ds_read_b128 v[60:63], v109 offset:0
    ds_read_b64_tr_b16 v[140:141], v73 offset:0
    ds_read_b64_tr_b16 v[142:143], v73 offset:1024
    s_mov_b32 s32, s86
    s_and_b32 s33, s87, 0xffff
    s_mov_b32 s34, s88
    v_mfma_f32_32x32x16_bf16 v[200:215], v[48:51], v[160:163], v[200:215]
    ds_read_b128 v[64:67], v110 offset:0
    ds_read_b64_tr_b16 v[144:145], v74 offset:0
    ds_read_b64_tr_b16 v[146:147], v74 offset:1024
    s_lshl_b32 s16, s14, 2
    v_mfma_f32_32x32x16_bf16 v[216:231], v[48:51], v[164:167], v[216:231]
    ds_read_b128 v[68:71], v111 offset:0
    ds_read_b64_tr_b16 v[148:149], v75 offset:0
    ds_read_b64_tr_b16 v[150:151], v75 offset:1024
    s_and_b32 s17, s15, 3
    v_mfma_f32_32x32x16_bf16 v[168:183], v[52:55], v[120:123], v[168:183]
    ds_read_b64_tr_b16 v[152:153], v76 offset:0
    ds_read_b64_tr_b16 v[154:155], v76 offset:1024
    s_add_u32 s16, s16, s17
    s_lshr_b32 s17, s15, 2
    v_mfma_f32_32x32x16_bf16 v[184:199], v[52:55], v[124:127], v[184:199]
    ds_read_b64_tr_b16 v[156:157], v77 offset:0
    ds_read_b64_tr_b16 v[158:159], v77 offset:1024
    s_lshl_b32 s40, s17, 3
    s_add_u32 s40, s40, s20
    v_mfma_f32_32x32x16_bf16 v[200:215], v[52:55], v[128:131], v[200:215]
    ds_read_b64_tr_b16 v[160:161], v78 offset:0
    ds_read_b64_tr_b16 v[162:163], v78 offset:1024
    s_add_u32 m0, s92, 0
    s_nop 0
    buffer_load_dwordx4 v100, s[32:35], s93 offen lds
    v_mfma_f32_32x32x16_bf16 v[216:231], v[52:55], v[132:135], v[216:231]
    ds_read_b64_tr_b16 v[164:165], v79 offset:0
    ds_read_b64_tr_b16 v[166:167], v79 offset:1024
    s_mul_i32 s80, s16, 5
    s_lshr_b32 s80, s80, 1
    s_waitcnt lgkmcnt(8)
    v_mfma_f32_32x32x16_bf16 v[168:183], v[56:59], v[136:139], v[168:183]
    ds_read_b64_tr_b16 v[120:121], v80 offset:0
    ds_read_b64_tr_b16 v[122:123], v80 offset:1024
    s_and_b32 s81, s16, 1
    s_add_u32 s44, s80, s81
    v_mfma_f32_32x32x16_bf16 v[184:199], v[56:59], v[140:143], v[184:199]
    ds_read_b64_tr_b16 v[124:125], v81 offset:0
    ds_read_b64_tr_b16 v[126:127], v81 offset:1024
    s_lshl_b32 s44, s44, 9
    s_xor_b32 s83, s81, 1
    v_mfma_f32_32x32x16_bf16 v[200:215], v[56:59], v[144:147], v[200:215]
    ds_read_b64_tr_b16 v[128:129], v82 offset:0
    ds_read_b64_tr_b16 v[130:131], v82 offset:1024
    s_add_u32 m0, s92, 1024
    s_nop 0
    buffer_load_dwordx4 v101, s[32:35], s93 offen lds
    v_mfma_f32_32x32x16_bf16 v[216:231], v[56:59], v[148:151], v[216:231]
    ds_read_b64_tr_b16 v[132:133], v83 offset:0
    ds_read_b64_tr_b16 v[134:135], v83 offset:1024
    s_lshl_b32 s83, s83, 1
    s_add_u32 s80, s80, s83
    s_waitcnt lgkmcnt(8)
    v_mfma_f32_32x32x16_bf16 v[168:183], v[60:63], v[152:155], v[168:183]
    ds_read_b64_tr_b16 v[136:137], v84 offset:0
    ds_read_b64_tr_b16 v[138:139], v84 offset:1024
    s_lshl_b32 s80, s80, 9
    s_lshl_b32 s81, s81, 3
    v_mfma_f32_32x32x16_bf16 v[184:199], v[60:63], v[156:159], v[184:199]
    ds_read_b64_tr_b16 v[140:141], v85 offset:0
    ds_read_b64_tr_b16 v[142:143], v85 offset:1024
    s_add_u32 s55, s80, s81
    s_mul_i32 s80, s40, 81920
    v_mfma_f32_32x32x16_bf16 v[200:215], v[60:63], v[160:163], v[200:215]
    ds_read_b64_tr_b16 v[144:145], v86 offset:0
    ds_read_b64_tr_b16 v[146:147], v86 offset:1024
    s_add_u32 m0, s92, 2048
    s_nop 0
    buffer_load_dwordx4 v102, s[32:35], s93 offen lds
    v_mfma_f32_32x32x16_bf16 v[216:231], v[60:63], v[164:167], v[216:231]
    ds_read_b64_tr_b16 v[148:149], v87 offset:0
    ds_read_b64_tr_b16 v[150:151], v87 offset:1024
    s_add_u32 s100, s44, s80
    s_add_u32 s101, s55, s80
    v_mfma_f32_4x4x4_16b_bf16 v[232:235], v[248:249], v[152:153], v[232:235]
    v_mfma_f32_4x4x4_16b_bf16 v[88:91], v[248:249], v[56:57], v[88:91]
    v_mfma_f32_4x4x4_16b_bf16 v[112:115], v[56:57], v[56:57], v[112:115]
    v_mfma_f32_4x4x4_16b_bf16 v[236:239], v[248:249], v[156:157], v[236:239]
    v_mfma_f32_4x4x4_16b_bf16 v[88:91], v[248:249], v[60:61], v[88:91]
    v_mfma_f32_4x4x4_16b_bf16 v[112:115], v[60:61], v[60:61], v[112:115]
    v_mfma_f32_4x4x4_16b_bf16 v[240:243], v[248:249], v[160:161], v[240:243]
    v_mfma_f32_4x4x4_16b_bf16 v[88:91], v[248:249], v[64:65], v[88:91]
    v_mfma_f32_4x4x4_16b_bf16 v[112:115], v[64:65], v[64:65], v[112:115]
    v_mfma_f32_4x4x4_16b_bf16 v[244:247], v[248:249], v[164:165], v[244:247]
    v_mfma_f32_4x4x4_16b_bf16 v[88:91], v[248:249], v[68:69], v[88:91]
    v_mfma_f32_4x4x4_16b_bf16 v[112:115], v[68:69], v[68:69], v[112:115]
    v_mfma_f32_4x4x4_16b_bf16 v[232:235], v[248:249], v[154:155], v[232:235]
    v_mfma_f32_4x4x4_16b_bf16 v[88:91], v[248:249], v[58:59], v[88:91]
    v_mfma_f32_4x4x4_16b_bf16 v[112:115], v[58:59], v[58:59], v[112:115]
    v_mfma_f32_4x4x4_16b_bf16 v[236:239], v[248:249], v[158:159], v[236:239]
    v_mfma_f32_4x4x4_16b_bf16 v[88:91], v[248:249], v[62:63], v[88:91]
    v_mfma_f32_4x4x4_16b_bf16 v[112:115], v[62:63], v[62:63], v[112:115]
    v_mfma_f32_4x4x4_16b_bf16 v[240:243], v[248:249], v[162:163], v[240:243]
    v_mfma_f32_4x4x4_16b_bf16 v[88:91], v[248:249], v[66:67], v[88:91]
    v_mfma_f32_4x4x4_16b_bf16 v[112:115], v[66:67], v[66:67], v[112:115]
    v_mfma_f32_4x4x4_16b_bf16 v[244:247], v[248:249], v[166:167], v[244:247]
    v_mfma_f32_4x4x4_16b_bf16 v[88:91], v[248:249], v[70:71], v[88:91]
    v_mfma_f32_4x4x4_16b_bf16 v[112:115], v[70:71], v[70:71], v[112:115]
    s_waitcnt lgkmcnt(0)
    v_mfma_f32_32x32x16_bf16 v[168:183], v[64:67], v[120:123], v[168:183]
    s_waitcnt vmcnt(3)
    s_barrier
    ds_read_b128 v[40:43], v108 offset:49152
    ds_read_b64_tr_b16 v[152:153], v72 offset:49152
    ds_read_b64_tr_b16 v[154:155], v72 offset:50176
    v_mfma_f32_32x32x16_bf16 v[184:199], v[64:67], v[124:127], v[184:199]
    ds_read_b128 v[44:47], v109 offset:49152
    ds_read_b64_tr_b16 v[156:157], v73 offset:49152
    ds_read_b64_tr_b16 v[158:159], v73 offset:50176
    s_add_u32 s98, s44, 40960
    v_mfma_f32_32x32x16_bf16 v[200:215], v[64:67], v[128:131], v[200:215]
    ds_read_b128 v[48:51], v110 offset:49152
    ds_read_b64_tr_b16 v[160:161], v74 offset:49152
    ds_read_b64_tr_b16 v[162:163], v74 offset:50176
    s_add_u32 m0, s92, 3072
    s_nop 0
    buffer_load_dwordx4 v103, s[32:35], s93 offen lds
    v_mfma_f32_32x32x16_bf16 v[216:231], v[64:67], v[132:135], v[216:231]
    ds_read_b128 v[52:55], v111 offset:49152
    ds_read_b64_tr_b16 v[164:165], v75 offset:49152
    ds_read_b64_tr_b16 v[166:167], v75 offset:50176
    s_add_u32 s99, s55, 40960
    v_mfma_f32_32x32x16_bf16 v[168:183], v[68:71], v[136:139], v[168:183]
    ds_read_b64_tr_b16 v[120:121], v76 offset:49152
    ds_read_b64_tr_b16 v[122:123], v76 offset:50176
    s_add_u32 s41, s16, s22
    s_and_b32 s41, s41, 7
    v_mfma_f32_32x32x16_bf16 v[184:199], v[68:71], v[140:143], v[184:199]
    ds_read_b64_tr_b16 v[124:125], v77 offset:49152
    ds_read_b64_tr_b16 v[126:127], v77 offset:50176
    s_mul_i32 s80, s22, 10240
    s_lshl_b32 s42, s23, 10
    v_mfma_f32_32x32x16_bf16 v[200:215], v[68:71], v[144:147], v[200:215]
    ds_read_b64_tr_b16 v[128:129], v78 offset:49152
    ds_read_b64_tr_b16 v[130:131], v78 offset:50176
    s_add_u32 m0, s92, 4096
    s_nop 0
    buffer_load_dwordx4 v104, s[32:35], s93 offen lds
    v_mfma_f32_32x32x16_bf16 v[216:231], v[68:71], v[148:151], v[216:231]
    ds_read_b64_tr_b16 v[132:133], v79 offset:49152
    ds_read_b64_tr_b16 v[134:135], v79 offset:50176
    s_add_u32 s42, s42, s80
    s_lshl_b32 s82, s23, 8
    s_waitcnt lgkmcnt(8)
    v_mfma_f32_32x32x16_bf16 v[168:183], v[40:43], v[152:155], v[168:183]
    ds_read_b64_tr_b16 v[136:137], v80 offset:49152
    ds_read_b64_tr_b16 v[138:139], v80 offset:50176
    s_add_u32 s82, s82, s80
    s_mul_i32 s43, s23, 1280
    v_mfma_f32_32x32x16_bf16 v[184:199], v[40:43], v[156:159], v[184:199]
    ds_read_b64_tr_b16 v[140:141], v81 offset:49152
    ds_read_b64_tr_b16 v[142:143], v81 offset:50176
    s_add_u32 s43, s43, s80
    s_lshl_b32 s18, s14, 3
    v_mfma_f32_32x32x16_bf16 v[200:215], v[40:43], v[160:163], v[200:215]
    ds_read_b64_tr_b16 v[144:145], v82 offset:49152
    ds_read_b64_tr_b16 v[146:147], v82 offset:50176
    s_and_b32 s19, s15, 7
    s_add_u32 s18, s18, s19
    v_mfma_f32_32x32x16_bf16 v[216:231], v[40:43], v[164:167], v[216:231]
    ds_read_b64_tr_b16 v[148:149], v83 offset:49152
    ds_read_b64_tr_b16 v[150:151], v83 offset:50176
    s_lshr_b32 s19, s15, 3
    s_mul_i32 s48, s23, 24
    s_waitcnt lgkmcnt(8)
    v_mfma_f32_32x32x16_bf16 v[168:183], v[44:47], v[120:123], v[168:183]
    ds_read_b64_tr_b16 v[152:153], v84 offset:49152
    ds_read_b64_tr_b16 v[154:155], v84 offset:50176
    s_add_u32 s49, s48, s22
    s_sub_u32 s48, s48, s22
    v_mfma_f32_32x32x16_bf16 v[184:199], v[44:47], v[124:127], v[184:199]
    ds_read_b64_tr_b16 v[156:157], v85 offset:49152
    ds_read_b64_tr_b16 v[158:159], v85 offset:50176
    s_add_u32 s48, s48, 1
    s_mul_i32 s50, s18, 96
    v_mfma_f32_32x32x16_bf16 v[200:215], v[44:47], v[128:131], v[200:215]
    ds_read_b64_tr_b16 v[160:161], v86 offset:49152
    ds_read_b64_tr_b16 v[162:163], v86 offset:50176
    s_add_u32 s51, s50, s48
    s_add_u32 s50, s50, s49
    v_mfma_f32_32x32x16_bf16 v[216:231], v[44:47], v[132:135], v[216:231]
    ds_read_b64_tr_b16 v[164:165], v87 offset:49152
    ds_read_b64_tr_b16 v[166:167], v87 offset:50176
    s_lshl_b32 s50, s50, 10
    s_lshl_b32 s51, s51, 10
    v_mfma_f32_4x4x4_16b_bf16 v[232:235], v[248:249], v[120:121], v[232:235]
    v_mfma_f32_4x4x4_16b_bf16 v[88:91], v[248:249], v[40:41], v[88:91]
    v_mfma_f32_4x4x4_16b_bf16 v[112:115], v[40:41], v[40:41], v[112:115]
    v_mfma_f32_4x4x4_16b_bf16 v[236:239], v[248:249], v[124:125], v[236:239]
    v_mfma_f32_4x4x4_16b_bf16 v[88:91], v[248:249], v[44:45], v[88:91]
    v_mfma_f32_4x4x4_16b_bf16 v[112:115], v[44:45], v[44:45], v[112:115]
    v_mfma_f32_4x4x4_16b_bf16 v[240:243], v[248:249], v[128:129], v[240:243]
    v_mfma_f32_4x4x4_16b_bf16 v[88:91], v[248:249], v[48:49], v[88:91]
    v_mfma_f32_4x4x4_16b_bf16 v[112:115], v[48:49], v[48:49], v[112:115]
    v_mfma_f32_4x4x4_16b_bf16 v[244:247], v[248:249], v[132:133], v[244:247]
    v_mfma_f32_4x4x4_16b_bf16 v[88:91], v[248:249], v[52:53], v[88:91]
    v_mfma_f32_4x4x4_16b_bf16 v[112:115], v[52:53], v[52:53], v[112:115]
    v_mfma_f32_4x4x4_16b_bf16 v[232:235], v[248:249], v[122:123], v[232:235]
    v_mfma_f32_4x4x4_16b_bf16 v[88:91], v[248:249], v[42:43], v[88:91]
    v_mfma_f32_4x4x4_16b_bf16 v[112:115], v[42:43], v[42:43], v[112:115]
    v_mfma_f32_4x4x4_16b_bf16 v[236:239], v[248:249], v[126:127], v[236:239]
    v_mfma_f32_4x4x4_16b_bf16 v[88:91], v[248:249], v[46:47], v[88:91]
    v_mfma_f32_4x4x4_16b_bf16 v[112:115], v[46:47], v[46:47], v[112:115]
    v_mfma_f32_4x4x4_16b_bf16 v[240:243], v[248:249], v[130:131], v[240:243]
    v_mfma_f32_4x4x4_16b_bf16 v[88:91], v[248:249], v[50:51], v[88:91]
    v_mfma_f32_4x4x4_16b_bf16 v[112:115], v[50:51], v[50:51], v[112:115]
    v_mfma_f32_4x4x4_16b_bf16 v[244:247], v[248:249], v[134:135], v[244:247]
    v_mfma_f32_4x4x4_16b_bf16 v[88:91], v[248:249], v[54:55], v[88:91]
    v_mfma_f32_4x4x4_16b_bf16 v[112:115], v[54:55], v[54:55], v[112:115]
    s_waitcnt lgkmcnt(0)
    v_mfma_f32_32x32x16_bf16 v[168:183], v[48:51], v[136:139], v[168:183]
    s_barrier
    ds_read_b128 v[56:59], v108 offset:32768
    ds_read_b64_tr_b16 v[120:121], v72 offset:32768
    ds_read_b64_tr_b16 v[122:123], v72 offset:33792
    v_mfma_f32_32x32x16_bf16 v[184:199], v[48:51], v[140:143], v[184:199]
    ds_read_b128 v[60:63], v109 offset:32768
    ds_read_b64_tr_b16 v[124:125], v73 offset:32768
    ds_read_b64_tr_b16 v[126:127], v73 offset:33792
    s_add_u32 s50, s50, 7864320
    v_mfma_f32_32x32x16_bf16 v[200:215], v[48:51], v[144:147], v[200:215]
    ds_read_b128 v[64:67], v110 offset:32768
    ds_read_b64_tr_b16 v[128:129], v74 offset:32768
    ds_read_b64_tr_b16 v[130:131], v74 offset:33792
    s_add_u32 s51, s51, 7864320
    v_mfma_f32_32x32x16_bf16 v[216:231], v[48:51], v[148:151], v[216:231]
    ds_read_b128 v[68:71], v111 offset:32768
    ds_read_b64_tr_b16 v[132:133], v75 offset:32768
    ds_read_b64_tr_b16 v[134:135], v75 offset:33792
    s_mul_i32 s52, s19, 5
    v_mfma_f32_32x32x16_bf16 v[168:183], v[52:55], v[152:155], v[168:183]
    ds_read_b64_tr_b16 v[136:137], v76 offset:32768
    ds_read_b64_tr_b16 v[138:139], v76 offset:33792
    s_mul_i32 s49, s49, 20
    s_mul_i32 s48, s48, 20
    v_mfma_f32_32x32x16_bf16 v[184:199], v[52:55], v[156:159], v[184:199]
    ds_read_b64_tr_b16 v[140:141], v77 offset:32768
    ds_read_b64_tr_b16 v[142:143], v77 offset:33792
    s_add_u32 s49, s49, s52
    s_add_u32 s48, s48, s52
    v_mfma_f32_32x32x16_bf16 v[200:215], v[52:55], v[160:163], v[200:215]
    ds_read_b64_tr_b16 v[144:145], v78 offset:32768
    ds_read_b64_tr_b16 v[146:147], v78 offset:33792
    s_lshl_b32 s49, s49, 10
    s_lshl_b32 s48, s48, 10
    v_mfma_f32_32x32x16_bf16 v[216:231], v[52:55], v[164:167], v[216:231]
    ds_read_b64_tr_b16 v[148:149], v79 offset:32768
    ds_read_b64_tr_b16 v[150:151], v79 offset:33792
    s_add_u32 s52, s49, 19402752
    s_lshl_b32 s53, s22, 11
    s_waitcnt lgkmcnt(8)
    v_mfma_f32_32x32x16_bf16 v[168:183], v[56:59], v[120:123], v[168:183]
    ds_read_b64_tr_b16 v[152:153], v80 offset:32768
    ds_read_b64_tr_b16 v[154:155], v80 offset:33792
    s_add_u32 s53, s53, 19398656
    s_add_u32 s49, s49, s53
    v_mfma_f32_32x32x16_bf16 v[184:199], v[56:59], v[124:127], v[184:199]
    ds_read_b64_tr_b16 v[156:157], v81 offset:32768
    ds_read_b64_tr_b16 v[158:159], v81 offset:33792
    s_add_u32 s48, s48, s53
    s_mul_i32 s53, s19, 5
    v_mfma_f32_32x32x16_bf16 v[200:215], v[56:59], v[128:131], v[200:215]
    ds_read_b64_tr_b16 v[160:161], v82 offset:32768
    ds_read_b64_tr_b16 v[162:163], v82 offset:33792
    s_add_u32 s54, s53, s23
    s_mul_i32 s80, s23, 200
    v_mfma_f32_32x32x16_bf16 v[216:231], v[56:59], v[132:135], v[216:231]
    ds_read_b64_tr_b16 v[164:165], v83 offset:32768
    ds_read_b64_tr_b16 v[166:167], v83 offset:33792
    s_add_u32 s80, s80, s53
    s_add_u32 s80, s80, 4
    s_waitcnt lgkmcnt(8)
    v_mfma_f32_32x32x16_bf16 v[168:183], v[60:63], v[136:139], v[168:183]
    ds_read_b64_tr_b16 v[120:121], v84 offset:32768
    ds_read_b64_tr_b16 v[122:123], v84 offset:33792
    s_cmp_eq_u32 s22, 0
    s_cselect_b32 s53, s54, s80
    v_mfma_f32_32x32x16_bf16 v[184:199], v[60:63], v[140:143], v[184:199]
    ds_read_b64_tr_b16 v[124:125], v85 offset:32768
    ds_read_b64_tr_b16 v[126:127], v85 offset:33792
    s_mul_i32 s80, s22, 300
    s_add_u32 s80, s80, 200
    v_mfma_f32_32x32x16_bf16 v[200:215], v[60:63], v[144:147], v[200:215]
    ds_read_b64_tr_b16 v[128:129], v86 offset:32768
    ds_read_b64_tr_b16 v[130:131], v86 offset:33792
    s_add_u32 s54, s54, s80
    s_lshl_b32 s53, s53, 10
    v_mfma_f32_32x32x16_bf16 v[216:231], v[60:63], v[148:151], v[216:231]
    ds_read_b64_tr_b16 v[132:133], v87 offset:32768
    ds_read_b64_tr_b16 v[134:135], v87 offset:33792
    s_lshl_b32 s54, s54, 10
    s_add_u32 s53, s53, 21364736
    v_mfma_f32_4x4x4_16b_bf16 v[232:235], v[248:249], v[136:137], v[232:235]
    v_mfma_f32_4x4x4_16b_bf16 v[88:91], v[248:249], v[56:57], v[88:91]
    v_mfma_f32_4x4x4_16b_bf16 v[112:115], v[56:57], v[56:57], v[112:115]
    v_mfma_f32_4x4x4_16b_bf16 v[236:239], v[248:249], v[140:141], v[236:239]
    v_mfma_f32_4x4x4_16b_bf16 v[88:91], v[248:249], v[60:61], v[88:91]
    v_mfma_f32_4x4x4_16b_bf16 v[112:115], v[60:61], v[60:61], v[112:115]
    v_mfma_f32_4x4x4_16b_bf16 v[240:243], v[248:249], v[144:145], v[240:243]
    v_mfma_f32_4x4x4_16b_bf16 v[88:91], v[248:249], v[64:65], v[88:91]
    v_mfma_f32_4x4x4_16b_bf16 v[112:115], v[64:65], v[64:65], v[112:115]
    v_mfma_f32_4x4x4_16b_bf16 v[244:247], v[248:249], v[148:149], v[244:247]
    v_mfma_f32_4x4x4_16b_bf16 v[88:91], v[248:249], v[68:69], v[88:91]
    v_mfma_f32_4x4x4_16b_bf16 v[112:115], v[68:69], v[68:69], v[112:115]
    v_mfma_f32_4x4x4_16b_bf16 v[232:235], v[248:249], v[138:139], v[232:235]
    v_mfma_f32_4x4x4_16b_bf16 v[88:91], v[248:249], v[58:59], v[88:91]
    v_mfma_f32_4x4x4_16b_bf16 v[112:115], v[58:59], v[58:59], v[112:115]
    v_mfma_f32_4x4x4_16b_bf16 v[236:239], v[248:249], v[142:143], v[236:239]
    v_mfma_f32_4x4x4_16b_bf16 v[88:91], v[248:249], v[62:63], v[88:91]
    v_mfma_f32_4x4x4_16b_bf16 v[112:115], v[62:63], v[62:63], v[112:115]
    v_mfma_f32_4x4x4_16b_bf16 v[240:243], v[248:249], v[146:147], v[240:243]
    v_mfma_f32_4x4x4_16b_bf16 v[88:91], v[248:249], v[66:67], v[88:91]
    v_mfma_f32_4x4x4_16b_bf16 v[112:115], v[66:67], v[66:67], v[112:115]
    v_mfma_f32_4x4x4_16b_bf16 v[244:247], v[248:249], v[150:151], v[244:247]
    v_mfma_f32_4x4x4_16b_bf16 v[88:91], v[248:249], v[70:71], v[88:91]
    v_mfma_f32_4x4x4_16b_bf16 v[112:115], v[70:71], v[70:71], v[112:115]
    s_waitcnt lgkmcnt(0)
    v_mfma_f32_32x32x16_bf16 v[168:183], v[64:67], v[152:155], v[168:183]
    s_barrier
    ds_read_b128 v[40:43], v108 offset:16384
    ds_read_b64_tr_b16 v[136:137], v72 offset:16384
    ds_read_b64_tr_b16 v[138:139], v72 offset:17408
    v_mfma_f32_32x32x16_bf16 v[184:199], v[64:67], v[156:159], v[184:199]
    ds_read_b128 v[44:47], v109 offset:16384
    ds_read_b64_tr_b16 v[140:141], v73 offset:16384
    ds_read_b64_tr_b16 v[142:143], v73 offset:17408
    s_add_u32 s54, s54, 21364736
    v_mfma_f32_32x32x16_bf16 v[200:215], v[64:67], v[160:163], v[200:215]
    ds_read_b128 v[48:51], v110 offset:16384
    ds_read_b64_tr_b16 v[144:145], v74 offset:16384
    ds_read_b64_tr_b16 v[146:147], v74 offset:17408
    s_mov_b32 s46, 0xfffff
    v_mfma_f32_32x32x16_bf16 v[216:231], v[64:67], v[164:167], v[216:231]
    ds_read_b128 v[52:55], v111 offset:16384
    ds_read_b64_tr_b16 v[148:149], v75 offset:16384
    ds_read_b64_tr_b16 v[150:151], v75 offset:17408
    s_mov_b32 s47, 0xfffff
    v_mfma_f32_32x32x16_bf16 v[168:183], v[68:71], v[120:123], v[168:183]
    ds_read_b64_tr_b16 v[152:153], v76 offset:16384
    ds_read_b64_tr_b16 v[154:155], v76 offset:17408
    s_lshl_b32 s4, s91, 4
    s_add_u32 s4, s4, s21
    v_mfma_f32_32x32x16_bf16 v[184:199], v[68:71], v[124:127], v[184:199]
    ds_read_b64_tr_b16 v[156:157], v77 offset:16384
    ds_read_b64_tr_b16 v[158:159], v77 offset:17408
    s_lshl_b32 s4, s4, 7
    s_add_u32 s4, s4, 22487040
    v_mfma_f32_32x32x16_bf16 v[200:215], v[68:71], v[128:131], v[200:215]
    ds_read_b64_tr_b16 v[160:161], v78 offset:16384
    ds_read_b64_tr_b16 v[162:163], v78 offset:17408
    s_lshl_b32 s5, s18, 2
    s_add_u32 s5, s5, s23
    v_mfma_f32_32x32x16_bf16 v[216:231], v[68:71], v[132:135], v[216:231]
    ds_read_b64_tr_b16 v[164:165], v79 offset:16384
    ds_read_b64_tr_b16 v[166:167], v79 offset:17408
    s_lshl_b32 s5, s5, 9
    s_add_u32 s5, s5, 22487040
    s_waitcnt lgkmcnt(8)
    v_mfma_f32_32x32x16_bf16 v[168:183], v[40:43], v[136:139], v[168:183]
    ds_read_b64_tr_b16 v[120:121], v80 offset:16384
    ds_read_b64_tr_b16 v[122:123], v80 offset:17408
    s_and_b32 s7, s15, 7
    s_add_u32 s7, s7, 7
    v_mfma_f32_32x32x16_bf16 v[184:199], v[40:43], v[140:143], v[184:199]
    ds_read_b64_tr_b16 v[124:125], v81 offset:16384
    ds_read_b64_tr_b16 v[126:127], v81 offset:17408
    s_mul_i32 s7, s7, 20480
    s_add_u32 s7, s7, s54
    v_mfma_f32_32x32x16_bf16 v[200:215], v[40:43], v[144:147], v[200:215]
    ds_read_b64_tr_b16 v[128:129], v82 offset:16384
    ds_read_b64_tr_b16 v[130:131], v82 offset:17408
    buffer_load_dword v105, v105, s[36:39], 0 offen
    v_and_b32 v18, 19, v2
    v_mfma_f32_32x32x16_bf16 v[216:231], v[40:43], v[148:151], v[216:231]
    ds_read_b64_tr_b16 v[132:133], v83 offset:16384
    ds_read_b64_tr_b16 v[134:135], v83 offset:17408
    v_bfe_u32 v19, v2, 2, 1
    v_lshl_add_u32 v18, v19, 3, v18
    s_waitcnt lgkmcnt(8)
    v_mfma_f32_32x32x16_bf16 v[168:183], v[44:47], v[152:155], v[168:183]
    ds_read_b64_tr_b16 v[136:137], v84 offset:16384
    ds_read_b64_tr_b16 v[138:139], v84 offset:17408
    v_bfe_u32 v19, v2, 3, 1
    v_lshl_add_u32 v18, v19, 2, v18
    v_mfma_f32_32x32x16_bf16 v[184:199], v[44:47], v[156:159], v[184:199]
    ds_read_b64_tr_b16 v[140:141], v85 offset:16384
    ds_read_b64_tr_b16 v[142:143], v85 offset:17408
    v_mul_u32_u24 v19, 20, v3
    v_add_u32 v19, v19, v2
    v_mfma_f32_32x32x16_bf16 v[200:215], v[44:47], v[160:163], v[200:215]
    ds_read_b64_tr_b16 v[144:145], v86 offset:16384
    ds_read_b64_tr_b16 v[146:147], v86 offset:17408
    v_lshlrev_b32 v19, 4, v19
    v_lshlrev_b32 v5, 3, v18
    v_mfma_f32_32x32x16_bf16 v[216:231], v[44:47], v[164:167], v[216:231]
    ds_read_b64_tr_b16 v[148:149], v87 offset:16384
    ds_read_b64_tr_b16 v[150:151], v87 offset:17408
    v_add_u32 v5, 4096, v5
    v_lshlrev_b32 v4, 4, v18
    v_mfma_f32_4x4x4_16b_bf16 v[232:235], v[248:249], v[152:153], v[232:235]
    v_mfma_f32_4x4x4_16b_bf16 v[88:91], v[248:249], v[40:41], v[88:91]
    v_mfma_f32_4x4x4_16b_bf16 v[112:115], v[40:41], v[40:41], v[112:115]
    v_mfma_f32_4x4x4_16b_bf16 v[236:239], v[248:249], v[156:157], v[236:239]
    v_mfma_f32_4x4x4_16b_bf16 v[88:91], v[248:249], v[44:45], v[88:91]
    v_mfma_f32_4x4x4_16b_bf16 v[112:115], v[44:45], v[44:45], v[112:115]
    v_mfma_f32_4x4x4_16b_bf16 v[240:243], v[248:249], v[160:161], v[240:243]
    v_mfma_f32_4x4x4_16b_bf16 v[88:91], v[248:249], v[48:49], v[88:91]
    v_mfma_f32_4x4x4_16b_bf16 v[112:115], v[48:49], v[48:49], v[112:115]
    v_mfma_f32_4x4x4_16b_bf16 v[244:247], v[248:249], v[164:165], v[244:247]
    v_mfma_f32_4x4x4_16b_bf16 v[88:91], v[248:249], v[52:53], v[88:91]
    v_mfma_f32_4x4x4_16b_bf16 v[112:115], v[52:53], v[52:53], v[112:115]
    v_mfma_f32_4x4x4_16b_bf16 v[232:235], v[248:249], v[154:155], v[232:235]
    v_mfma_f32_4x4x4_16b_bf16 v[88:91], v[248:249], v[42:43], v[88:91]
    v_mfma_f32_4x4x4_16b_bf16 v[112:115], v[42:43], v[42:43], v[112:115]
    v_mfma_f32_4x4x4_16b_bf16 v[236:239], v[248:249], v[158:159], v[236:239]
    v_mfma_f32_4x4x4_16b_bf16 v[88:91], v[248:249], v[46:47], v[88:91]
    v_mfma_f32_4x4x4_16b_bf16 v[112:115], v[46:47], v[46:47], v[112:115]
    v_mfma_f32_4x4x4_16b_bf16 v[240:243], v[248:249], v[162:163], v[240:243]
    v_mfma_f32_4x4x4_16b_bf16 v[88:91], v[248:249], v[50:51], v[88:91]
    v_mfma_f32_4x4x4_16b_bf16 v[112:115], v[50:51], v[50:51], v[112:115]
    v_mfma_f32_4x4x4_16b_bf16 v[244:247], v[248:249], v[166:167], v[244:247]
    v_mfma_f32_4x4x4_16b_bf16 v[88:91], v[248:249], v[54:55], v[88:91]
    v_mfma_f32_4x4x4_16b_bf16 v[112:115], v[54:55], v[54:55], v[112:115]
    s_waitcnt lgkmcnt(0)
    v_mfma_f32_32x32x16_bf16 v[168:183], v[48:51], v[120:123], v[168:183]
    s_waitcnt vmcnt(1)
    s_barrier
    ds_read_b128 v[56:59], v108 offset:0
    ds_read_b64_tr_b16 v[152:153], v72 offset:0
    ds_read_b64_tr_b16 v[154:155], v72 offset:1024
    v_mfma_f32_32x32x16_bf16 v[184:199], v[48:51], v[124:127], v[184:199]
    ds_read_b128 v[60:63], v109 offset:0
    ds_read_b64_tr_b16 v[156:157], v73 offset:0
    ds_read_b64_tr_b16 v[158:159], v73 offset:1024
    v_lshl_add_u32 v4, v3, 9, v4
    v_mfma_f32_32x32x16_bf16 v[200:215], v[48:51], v[128:131], v[200:215]
    ds_read_b128 v[64:67], v110 offset:0
    ds_read_b64_tr_b16 v[160:161], v74 offset:0
    ds_read_b64_tr_b16 v[162:163], v74 offset:1024
    v_add_u32 v6, 5120, v19
    v_mfma_f32_32x32x16_bf16 v[216:231], v[48:51], v[132:135], v[216:231]
    ds_read_b128 v[68:71], v111 offset:0
    ds_read_b64_tr_b16 v[164:165], v75 offset:0
    ds_read_b64_tr_b16 v[166:167], v75 offset:1024
    v_mov_b32 v7, 0xdddddddd
    v_mfma_f32_32x32x16_bf16 v[168:183], v[52:55], v[136:139], v[168:183]
    ds_read_b64_tr_b16 v[120:121], v76 offset:0
    ds_read_b64_tr_b16 v[122:123], v76 offset:1024
    s_mul_i32 s3, s20, 1280
    s_add_u32 s3, s3, 20480
    v_add_u32 v17, s3, v0
    v_mfma_f32_32x32x16_bf16 v[184:199], v[52:55], v[140:143], v[184:199]
    ds_read_b64_tr_b16 v[124:125], v77 offset:0
    ds_read_b64_tr_b16 v[126:127], v77 offset:1024
    v_mov_b32 v21, 0x3f803f80
    v_cmp_eq_u32 vcc, 20, v2
    s_nop 1
    v_cndmask_b32 v20, 0, v21, vcc
    v_mfma_f32_32x32x16_bf16 v[200:215], v[52:55], v[144:147], v[200:215]
    ds_read_b64_tr_b16 v[128:129], v78 offset:0
    ds_read_b64_tr_b16 v[130:131], v78 offset:1024
    v_mov_b32 v21, v20
    v_mov_b32 v22, v20
    v_mfma_f32_32x32x16_bf16 v[216:231], v[52:55], v[148:151], v[216:231]
    ds_read_b64_tr_b16 v[132:133], v79 offset:0
    ds_read_b64_tr_b16 v[134:135], v79 offset:1024
    v_mov_b32 v23, v20
    v_mov_b32 v24, v20
    s_waitcnt lgkmcnt(8)
    v_mfma_f32_32x32x16_bf16 v[168:183], v[56:59], v[152:155], v[168:183]
    ds_read_b64_tr_b16 v[136:137], v80 offset:0
    ds_read_b64_tr_b16 v[138:139], v80 offset:1024
    v_mov_b32 v25, v20
    v_mov_b32 v26, v20
    v_mfma_f32_32x32x16_bf16 v[184:199], v[56:59], v[156:159], v[184:199]
    ds_read_b64_tr_b16 v[140:141], v81 offset:0
    ds_read_b64_tr_b16 v[142:143], v81 offset:1024
    v_mov_b32 v27, v20
    v_mov_b32 v28, v20
    v_mfma_f32_32x32x16_bf16 v[200:215], v[56:59], v[160:163], v[200:215]
    ds_read_b64_tr_b16 v[144:145], v82 offset:0
    ds_read_b64_tr_b16 v[146:147], v82 offset:1024
    global_load_dwordx2 v[106:107], v9, s[84:85] sc1
    v_mov_b32 v29, v20
    v_mfma_f32_32x32x16_bf16 v[216:231], v[56:59], v[164:167], v[216:231]
    ds_read_b64_tr_b16 v[148:149], v83 offset:0
    ds_read_b64_tr_b16 v[150:151], v83 offset:1024
    v_mov_b32 v30, v20
    v_mov_b32 v31, v20
    s_waitcnt lgkmcnt(8)
    v_mfma_f32_32x32x16_bf16 v[168:183], v[60:63], v[120:123], v[168:183]
    ds_read_b64_tr_b16 v[152:153], v84 offset:0
    ds_read_b64_tr_b16 v[154:155], v84 offset:1024
    v_mov_b32 v32, v20
    v_mov_b32 v33, v20
    v_mfma_f32_32x32x16_bf16 v[184:199], v[60:63], v[124:127], v[184:199]
    ds_read_b64_tr_b16 v[156:157], v85 offset:0
    ds_read_b64_tr_b16 v[158:159], v85 offset:1024
    v_mov_b32 v34, v20
    v_mov_b32 v35, v20
    v_mfma_f32_32x32x16_bf16 v[200:215], v[60:63], v[128:131], v[200:215]
    ds_read_b64_tr_b16 v[160:161], v86 offset:0
    ds_read_b64_tr_b16 v[162:163], v86 offset:1024
    v_mov_b32 v36, v20
    v_mov_b32 v37, v20
    v_mfma_f32_32x32x16_bf16 v[216:231], v[60:63], v[132:135], v[216:231]
    ds_read_b64_tr_b16 v[164:165], v87 offset:0
    ds_read_b64_tr_b16 v[166:167], v87 offset:1024
    v_mov_b32 v38, v20
    v_mov_b32 v39, v20
    v_mfma_f32_4x4x4_16b_bf16 v[232:235], v[248:249], v[120:121], v[232:235]
    v_mfma_f32_4x4x4_16b_bf16 v[88:91], v[248:249], v[56:57], v[88:91]
    v_mfma_f32_4x4x4_16b_bf16 v[112:115], v[56:57], v[56:57], v[112:115]
    v_mfma_f32_4x4x4_16b_bf16 v[236:239], v[248:249], v[124:125], v[236:239]
    v_mfma_f32_4x4x4_16b_bf16 v[88:91], v[248:249], v[60:61], v[88:91]
    v_mfma_f32_4x4x4_16b_bf16 v[112:115], v[60:61], v[60:61], v[112:115]
    v_mfma_f32_4x4x4_16b_bf16 v[240:243], v[248:249], v[128:129], v[240:243]
    v_mfma_f32_4x4x4_16b_bf16 v[88:91], v[248:249], v[64:65], v[88:91]
    v_mfma_f32_4x4x4_16b_bf16 v[112:115], v[64:65], v[64:65], v[112:115]
    v_mfma_f32_4x4x4_16b_bf16 v[244:247], v[248:249], v[132:133], v[244:247]
    v_mfma_f32_4x4x4_16b_bf16 v[88:91], v[248:249], v[68:69], v[88:91]
    v_mfma_f32_4x4x4_16b_bf16 v[112:115], v[68:69], v[68:69], v[112:115]
    v_mfma_f32_4x4x4_16b_bf16 v[232:235], v[248:249], v[122:123], v[232:235]
    v_mfma_f32_4x4x4_16b_bf16 v[88:91], v[248:249], v[58:59], v[88:91]
    v_mfma_f32_4x4x4_16b_bf16 v[112:115], v[58:59], v[58:59], v[112:115]
    v_mfma_f32_4x4x4_16b_bf16 v[236:239], v[248:249], v[126:127], v[236:239]
    v_mfma_f32_4x4x4_16b_bf16 v[88:91], v[248:249], v[62:63], v[88:91]
    v_mfma_f32_4x4x4_16b_bf16 v[112:115], v[62:63], v[62:63], v[112:115]
    v_mfma_f32_4x4x4_16b_bf16 v[240:243], v[248:249], v[130:131], v[240:243]
    v_mfma_f32_4x4x4_16b_bf16 v[88:91], v[248:249], v[66:67], v[88:91]
    v_mfma_f32_4x4x4_16b_bf16 v[112:115], v[66:67], v[66:67], v[112:115]
    v_mfma_f32_4x4x4_16b_bf16 v[244:247], v[248:249], v[134:135], v[244:247]
    v_mfma_f32_4x4x4_16b_bf16 v[88:91], v[248:249], v[70:71], v[88:91]
    v_mfma_f32_4x4x4_16b_bf16 v[112:115], v[70:71], v[70:71], v[112:115]
    s_waitcnt lgkmcnt(0)
    v_mfma_f32_32x32x16_bf16 v[168:183], v[64:67], v[136:139], v[168:183]
    s_barrier
    ds_read_b128 v[40:43], v108 offset:49152
    ds_read_b64_tr_b16 v[120:121], v72 offset:49152
    ds_read_b64_tr_b16 v[122:123], v72 offset:50176
    v_mfma_f32_32x32x16_bf16 v[184:199], v[64:67], v[140:143], v[184:199]
    ds_read_b128 v[44:47], v109 offset:49152
    ds_read_b64_tr_b16 v[124:125], v73 offset:49152
    ds_read_b64_tr_b16 v[126:127], v73 offset:50176
    v_and_b32 v118, 3, v1
    v_mfma_f32_32x32x16_bf16 v[200:215], v[64:67], v[144:147], v[200:215]
    ds_read_b128 v[48:51], v110 offset:49152
    ds_read_b64_tr_b16 v[128:129], v74 offset:49152
    ds_read_b64_tr_b16 v[130:131], v74 offset:50176
    v_lshlrev_b32 v118, 7, v118
    v_mfma_f32_32x32x16_bf16 v[216:231], v[64:67], v[148:151], v[216:231]
    ds_read_b128 v[52:55], v111 offset:49152
    ds_read_b64_tr_b16 v[132:133], v75 offset:49152
    ds_read_b64_tr_b16 v[134:135], v75 offset:50176
    s_xor_b32 s3, s22, 1
    s_lshl_b32 s3, s3, 31
    v_mov_b32 v116, s3
    v_mfma_f32_32x32x16_bf16 v[168:183], v[68:71], v[152:155], v[168:183]
    ds_read_b64_tr_b16 v[136:137], v76 offset:49152
    ds_read_b64_tr_b16 v[138:139], v76 offset:50176
    s_mul_i32 s80, s16, 20
    s_add_u32 s81, s80, 19
    v_mfma_f32_32x32x16_bf16 v[184:199], v[68:71], v[156:159], v[184:199]
    ds_read_b64_tr_b16 v[140:141], v77 offset:49152
    ds_read_b64_tr_b16 v[142:143], v77 offset:50176
    s_lshr_b32 s80, s80, 7
    s_lshr_b32 s81, s81, 7
    v_mfma_f32_32x32x16_bf16 v[200:215], v[68:71], v[160:163], v[200:215]
    ds_read_b64_tr_b16 v[144:145], v78 offset:49152
    ds_read_b64_tr_b16 v[146:147], v78 offset:50176
    s_sub_u32 s83, s81, s80
    s_lshl_b32 s83, s83, 4
    v_mfma_f32_32x32x16_bf16 v[216:231], v[68:71], v[164:167], v[216:231]
    ds_read_b64_tr_b16 v[148:149], v79 offset:49152
    ds_read_b64_tr_b16 v[150:151], v79 offset:50176
    s_lshl_b32 s80, s80, 4
    s_cmp_lt_u32 s23, 2
    s_cselect_b32 s1, 5, 10
    s_waitcnt lgkmcnt(8)
    v_mfma_f32_32x32x16_bf16 v[168:183], v[40:43], v[120:123], v[168:183]
    ds_read_b64_tr_b16 v[152:153], v80 offset:49152
    ds_read_b64_tr_b16 v[154:155], v80 offset:50176
    s_lshl_b32 s1, s1, 4
    s_lshl_b32 s81, s17, 1
    v_mfma_f32_32x32x16_bf16 v[184:199], v[40:43], v[124:127], v[184:199]
    ds_read_b64_tr_b16 v[156:157], v81 offset:49152
    ds_read_b64_tr_b16 v[158:159], v81 offset:50176
    v_bfe_u32 v18, v1, 1, 1
    v_mul_lo_u32 v18, v18, s83
    v_mfma_f32_32x32x16_bf16 v[200:215], v[40:43], v[128:131], v[200:215]
    ds_read_b64_tr_b16 v[160:161], v82 offset:49152
    ds_read_b64_tr_b16 v[162:163], v82 offset:50176
    v_and_b32 v96, 1, v1
    v_add3_u32 v18, v18, v96, s80
    v_mfma_f32_32x32x16_bf16 v[216:231], v[40:43], v[132:135], v[216:231]
    ds_read_b64_tr_b16 v[164:165], v83 offset:49152
    ds_read_b64_tr_b16 v[166:167], v83 offset:50176
    v_lshrrev_b32 v96, 2, v1
    v_mul_u32_u24 v96, 80, v96
    s_waitcnt lgkmcnt(8)
    v_mfma_f32_32x32x16_bf16 v[168:183], v[44:47], v[136:139], v[168:183]
    ds_read_b64_tr_b16 v[120:121], v84 offset:49152
    ds_read_b64_tr_b16 v[122:123], v84 offset:50176
    v_add_u32 v18, v18, v96
    s_lshl_b32 s3, s41, 1
    v_mov_b32 v96, s3
    v_mfma_f32_32x32x16_bf16 v[184:199], v[44:47], v[140:143], v[184:199]
    ds_read_b64_tr_b16 v[124:125], v85 offset:49152
    ds_read_b64_tr_b16 v[126:127], v85 offset:50176
    v_mov_b32 v19, s81
    v_cmp_gt_u32 vcc, 4, v1
    s_nop 1
    v_cndmask_b32 v96, v96, v19, vcc
    v_mfma_f32_32x32x16_bf16 v[200:215], v[44:47], v[144:147], v[200:215]
    ds_read_b64_tr_b16 v[128:129], v86 offset:49152
    ds_read_b64_tr_b16 v[130:131], v86 offset:50176
    v_add_u32 v18, v18, v96
    v_lshlrev_b32 v18, 7, v18
    v_mfma_f32_32x32x16_bf16 v[216:231], v[44:47], v[148:151], v[216:231]
    ds_read_b64_tr_b16 v[132:133], v87 offset:49152
    ds_read_b64_tr_b16 v[134:135], v87 offset:50176
    v_bfe_u32 v19, v1, 4, 1
    v_mul_lo_u32 v19, v19, s83
    v_mfma_f32_4x4x4_16b_bf16 v[232:235], v[248:249], v[136:137], v[232:235]
    v_mfma_f32_4x4x4_16b_bf16 v[88:91], v[248:249], v[40:41], v[88:91]
    v_mfma_f32_4x4x4_16b_bf16 v[112:115], v[40:41], v[40:41], v[112:115]
    v_mfma_f32_4x4x4_16b_bf16 v[236:239], v[248:249], v[140:141], v[236:239]
    v_mfma_f32_4x4x4_16b_bf16 v[88:91], v[248:249], v[44:45], v[88:91]
    v_mfma_f32_4x4x4_16b_bf16 v[112:115], v[44:45], v[44:45], v[112:115]
    v_mfma_f32_4x4x4_16b_bf16 v[240:243], v[248:249], v[144:145], v[240:243]
    v_mfma_f32_4x4x4_16b_bf16 v[88:91], v[248:249], v[48:49], v[88:91]
    v_mfma_f32_4x4x4_16b_bf16 v[112:115], v[48:49], v[48:49], v[112:115]
    v_mfma_f32_4x4x4_16b_bf16 v[244:247], v[248:249], v[148:149], v[244:247]
    v_mfma_f32_4x4x4_16b_bf16 v[88:91], v[248:249], v[52:53], v[88:91]
    v_mfma_f32_4x4x4_16b_bf16 v[112:115], v[52:53], v[52:53], v[112:115]
    v_mfma_f32_4x4x4_16b_bf16 v[232:235], v[248:249], v[138:139], v[232:235]
    v_mfma_f32_4x4x4_16b_bf16 v[88:91], v[248:249], v[42:43], v[88:91]
    v_mfma_f32_4x4x4_16b_bf16 v[112:115], v[42:43], v[42:43], v[112:115]
    v_mfma_f32_4x4x4_16b_bf16 v[236:239], v[248:249], v[142:143], v[236:239]
    v_mfma_f32_4x4x4_16b_bf16 v[88:91], v[248:249], v[46:47], v[88:91]
    v_mfma_f32_4x4x4_16b_bf16 v[112:115], v[46:47], v[46:47], v[112:115]
    v_mfma_f32_4x4x4_16b_bf16 v[240:243], v[248:249], v[146:147], v[240:243]
    v_mfma_f32_4x4x4_16b_bf16 v[88:91], v[248:249], v[50:51], v[88:91]
    v_mfma_f32_4x4x4_16b_bf16 v[112:115], v[50:51], v[50:51], v[112:115]
    v_mfma_f32_4x4x4_16b_bf16 v[244:247], v[248:249], v[150:151], v[244:247]
    v_mfma_f32_4x4x4_16b_bf16 v[88:91], v[248:249], v[54:55], v[88:91]
    v_mfma_f32_4x4x4_16b_bf16 v[112:115], v[54:55], v[54:55], v[112:115]
    s_waitcnt lgkmcnt(0)
    v_mfma_f32_32x32x16_bf16 v[168:183], v[48:51], v[152:155], v[168:183]
    s_barrier
    ds_read_b128 v[56:59], v108 offset:32768
    ds_read_b64_tr_b16 v[136:137], v72 offset:32768
    ds_read_b64_tr_b16 v[138:139], v72 offset:33792
    v_mfma_f32_32x32x16_bf16 v[184:199], v[48:51], v[156:159], v[184:199]
    ds_read_b128 v[60:63], v109 offset:32768
    ds_read_b64_tr_b16 v[140:141], v73 offset:32768
    ds_read_b64_tr_b16 v[142:143], v73 offset:33792
    v_and_b32 v96, 15, v1
    v_mfma_f32_32x32x16_bf16 v[200:215], v[48:51], v[160:163], v[200:215]
    ds_read_b128 v[64:67], v110 offset:32768
    ds_read_b64_tr_b16 v[144:145], v74 offset:32768
    ds_read_b64_tr_b16 v[146:147], v74 offset:33792
    v_add3_u32 v19, v19, v96, s80
    v_mfma_f32_32x32x16_bf16 v[216:231], v[48:51], v[164:167], v[216:231]
    ds_read_b128 v[68:71], v111 offset:32768
    ds_read_b64_tr_b16 v[148:149], v75 offset:32768
    ds_read_b64_tr_b16 v[150:151], v75 offset:33792
    v_add_u32 v19, s1, v19
    v_mfma_f32_32x32x16_bf16 v[168:183], v[52:55], v[120:123], v[168:183]
    ds_read_b64_tr_b16 v[152:153], v76 offset:32768
    ds_read_b64_tr_b16 v[154:155], v76 offset:33792
    v_lshlrev_b32 v19, 7, v19
    s_mov_b32 s80, 22454272
    v_mfma_f32_32x32x16_bf16 v[184:199], v[52:55], v[124:127], v[184:199]
    ds_read_b64_tr_b16 v[156:157], v77 offset:32768
    ds_read_b64_tr_b16 v[158:159], v77 offset:33792
    v_min_u32 v97, 33, v1
    s_mul_i32 s83, s23, 24
    v_add_u32 v119, s83, v97
    v_mfma_f32_32x32x16_bf16 v[200:215], v[52:55], v[128:131], v[200:215]
    ds_read_b64_tr_b16 v[160:161], v78 offset:32768
    ds_read_b64_tr_b16 v[162:163], v78 offset:33792
    s_mul_i32 s83, s23, 10
    s_add_u32 s83, s83, 72
    v_add_u32 v96, s83, v97
    v_mfma_f32_32x32x16_bf16 v[216:231], v[52:55], v[132:135], v[216:231]
    ds_read_b64_tr_b16 v[164:165], v79 offset:32768
    ds_read_b64_tr_b16 v[166:167], v79 offset:33792
    v_cmp_gt_u32 vcc, 24, v1
    s_nop 1
    v_cndmask_b32 v119, v96, v119, vcc
    s_waitcnt lgkmcnt(8)
    v_mfma_f32_32x32x16_bf16 v[168:183], v[56:59], v[136:139], v[168:183]
    ds_read_b64_tr_b16 v[120:121], v80 offset:32768
    ds_read_b64_tr_b16 v[122:123], v80 offset:33792
    v_lshl_add_u32 v119, v119, 2, s19
    v_lshrrev_b32 v119, 1, v119
    v_mfma_f32_32x32x16_bf16 v[184:199], v[56:59], v[140:143], v[184:199]
    ds_read_b64_tr_b16 v[124:125], v81 offset:32768
    ds_read_b64_tr_b16 v[126:127], v81 offset:33792
    v_subrev_u32 v96, 16, v119
    v_cmp_gt_u32 vcc, 256, v119
    s_nop 1
    v_cndmask_b32 v119, v96, v119, vcc
    v_mfma_f32_32x32x16_bf16 v[200:215], v[56:59], v[144:147], v[200:215]
    ds_read_b64_tr_b16 v[128:129], v82 offset:32768
    ds_read_b64_tr_b16 v[130:131], v82 offset:33792
    v_lshlrev_b32 v119, 7, v119
    v_add_u32 v119, 22454272, v119
    v_mfma_f32_32x32x16_bf16 v[216:231], v[56:59], v[148:151], v[216:231]
    ds_read_b64_tr_b16 v[132:133], v83 offset:32768
    ds_read_b64_tr_b16 v[134:135], v83 offset:33792
    s_lshl_b32 s83, s23, 9
    s_add_u32 s83, s83, 30720
    s_waitcnt lgkmcnt(8)
    v_mfma_f32_32x32x16_bf16 v[168:183], v[60:63], v[152:155], v[168:183]
    ds_read_b64_tr_b16 v[136:137], v84 offset:32768
    ds_read_b64_tr_b16 v[138:139], v84 offset:33792
    v_lshl_add_u32 v255, v2, 4, s83
    v_mfma_f32_32x32x16_bf16 v[184:199], v[60:63], v[156:159], v[184:199]
    ds_read_b64_tr_b16 v[140:141], v85 offset:32768
    ds_read_b64_tr_b16 v[142:143], v85 offset:33792
    v_mfma_f32_32x32x16_bf16 v[200:215], v[60:63], v[160:163], v[200:215]
    ds_read_b64_tr_b16 v[144:145], v86 offset:32768
    ds_read_b64_tr_b16 v[146:147], v86 offset:33792
    v_mfma_f32_32x32x16_bf16 v[216:231], v[60:63], v[164:167], v[216:231]
    ds_read_b64_tr_b16 v[148:149], v87 offset:32768
    ds_read_b64_tr_b16 v[150:151], v87 offset:33792
    v_mfma_f32_4x4x4_16b_bf16 v[232:235], v[248:249], v[152:153], v[232:235]
    v_mfma_f32_4x4x4_16b_bf16 v[88:91], v[248:249], v[56:57], v[88:91]
    v_mfma_f32_4x4x4_16b_bf16 v[112:115], v[56:57], v[56:57], v[112:115]
    v_mfma_f32_4x4x4_16b_bf16 v[236:239], v[248:249], v[156:157], v[236:239]
    v_mfma_f32_4x4x4_16b_bf16 v[88:91], v[248:249], v[60:61], v[88:91]
    v_mfma_f32_4x4x4_16b_bf16 v[112:115], v[60:61], v[60:61], v[112:115]
    v_mfma_f32_4x4x4_16b_bf16 v[240:243], v[248:249], v[160:161], v[240:243]
    v_mfma_f32_4x4x4_16b_bf16 v[88:91], v[248:249], v[64:65], v[88:91]
    v_mfma_f32_4x4x4_16b_bf16 v[112:115], v[64:65], v[64:65], v[112:115]
    v_mfma_f32_4x4x4_16b_bf16 v[244:247], v[248:249], v[164:165], v[244:247]
    v_mfma_f32_4x4x4_16b_bf16 v[88:91], v[248:249], v[68:69], v[88:91]
    v_mfma_f32_4x4x4_16b_bf16 v[112:115], v[68:69], v[68:69], v[112:115]
    v_mfma_f32_4x4x4_16b_bf16 v[232:235], v[248:249], v[154:155], v[232:235]
    v_mfma_f32_4x4x4_16b_bf16 v[88:91], v[248:249], v[58:59], v[88:91]
    v_mfma_f32_4x4x4_16b_bf16 v[112:115], v[58:59], v[58:59], v[112:115]
    v_mfma_f32_4x4x4_16b_bf16 v[236:239], v[248:249], v[158:159], v[236:239]
    v_mfma_f32_4x4x4_16b_bf16 v[88:91], v[248:249], v[62:63], v[88:91]
    v_mfma_f32_4x4x4_16b_bf16 v[112:115], v[62:63], v[62:63], v[112:115]
    v_mfma_f32_4x4x4_16b_bf16 v[240:243], v[248:249], v[162:163], v[240:243]
    v_mfma_f32_4x4x4_16b_bf16 v[88:91], v[248:249], v[66:67], v[88:91]
    v_mfma_f32_4x4x4_16b_bf16 v[112:115], v[66:67], v[66:67], v[112:115]
    v_mfma_f32_4x4x4_16b_bf16 v[244:247], v[248:249], v[166:167], v[244:247]
    v_mfma_f32_4x4x4_16b_bf16 v[88:91], v[248:249], v[70:71], v[88:91]
    v_mfma_f32_4x4x4_16b_bf16 v[112:115], v[70:71], v[70:71], v[112:115]
    s_waitcnt lgkmcnt(0)
    v_mfma_f32_32x32x16_bf16 v[168:183], v[64:67], v[120:123], v[168:183]
    s_barrier
    ds_read_b128 v[40:43], v108 offset:16384
    ds_read_b64_tr_b16 v[152:153], v72 offset:16384
    ds_read_b64_tr_b16 v[154:155], v72 offset:17408
    v_mfma_f32_32x32x16_bf16 v[184:199], v[64:67], v[124:127], v[184:199]
    ds_read_b128 v[44:47], v109 offset:16384
    ds_read_b64_tr_b16 v[156:157], v73 offset:16384
    ds_read_b64_tr_b16 v[158:159], v73 offset:17408
    v_mfma_f32_32x32x16_bf16 v[200:215], v[64:67], v[128:131], v[200:215]
    ds_read_b128 v[48:51], v110 offset:16384
    ds_read_b64_tr_b16 v[160:161], v74 offset:16384
    ds_read_b64_tr_b16 v[162:163], v74 offset:17408
    v_mfma_f32_32x32x16_bf16 v[216:231], v[64:67], v[132:135], v[216:231]
    ds_read_b128 v[52:55], v111 offset:16384
    ds_read_b64_tr_b16 v[164:165], v75 offset:16384
    ds_read_b64_tr_b16 v[166:167], v75 offset:17408
    v_mfma_f32_32x32x16_bf16 v[168:183], v[68:71], v[136:139], v[168:183]
    ds_read_b64_tr_b16 v[120:121], v76 offset:16384
    ds_read_b64_tr_b16 v[122:123], v76 offset:17408
    v_mfma_f32_32x32x16_bf16 v[184:199], v[68:71], v[140:143], v[184:199]
    ds_read_b64_tr_b16 v[124:125], v77 offset:16384
    ds_read_b64_tr_b16 v[126:127], v77 offset:17408
    v_mfma_f32_32x32x16_bf16 v[200:215], v[68:71], v[144:147], v[200:215]
    ds_read_b64_tr_b16 v[128:129], v78 offset:16384
    ds_read_b64_tr_b16 v[130:131], v78 offset:17408
    v_mfma_f32_32x32x16_bf16 v[216:231], v[68:71], v[148:151], v[216:231]
    ds_read_b64_tr_b16 v[132:133], v79 offset:16384
    ds_read_b64_tr_b16 v[134:135], v79 offset:17408
    s_waitcnt lgkmcnt(8)
    v_mfma_f32_32x32x16_bf16 v[168:183], v[40:43], v[152:155], v[168:183]
    ds_read_b64_tr_b16 v[136:137], v80 offset:16384
    ds_read_b64_tr_b16 v[138:139], v80 offset:17408
    v_mfma_f32_32x32x16_bf16 v[184:199], v[40:43], v[156:159], v[184:199]
    ds_read_b64_tr_b16 v[140:141], v81 offset:16384
    ds_read_b64_tr_b16 v[142:143], v81 offset:17408
    v_mfma_f32_32x32x16_bf16 v[200:215], v[40:43], v[160:163], v[200:215]
    ds_read_b64_tr_b16 v[144:145], v82 offset:16384
    ds_read_b64_tr_b16 v[146:147], v82 offset:17408
    v_mfma_f32_32x32x16_bf16 v[216:231], v[40:43], v[164:167], v[216:231]
    ds_read_b64_tr_b16 v[148:149], v83 offset:16384
    ds_read_b64_tr_b16 v[150:151], v83 offset:17408
    s_waitcnt lgkmcnt(8)
    v_mfma_f32_32x32x16_bf16 v[168:183], v[44:47], v[120:123], v[168:183]
    ds_read_b64_tr_b16 v[152:153], v84 offset:16384
    ds_read_b64_tr_b16 v[154:155], v84 offset:17408
    s_waitcnt vmcnt(0)
    v_readfirstlane_b32 s90, v106
    v_mfma_f32_32x32x16_bf16 v[184:199], v[44:47], v[124:127], v[184:199]
    ds_read_b64_tr_b16 v[156:157], v85 offset:16384
    ds_read_b64_tr_b16 v[158:159], v85 offset:17408
    v_readfirstlane_b32 s81, v107
    v_mfma_f32_32x32x16_bf16 v[200:215], v[44:47], v[128:131], v[200:215]
    ds_read_b64_tr_b16 v[160:161], v86 offset:16384
    ds_read_b64_tr_b16 v[162:163], v86 offset:17408
    v_mfma_f32_32x32x16_bf16 v[216:231], v[44:47], v[132:135], v[216:231]
    ds_read_b64_tr_b16 v[164:165], v87 offset:16384
    ds_read_b64_tr_b16 v[166:167], v87 offset:17408
    v_mfma_f32_4x4x4_16b_bf16 v[232:235], v[248:249], v[120:121], v[232:235]
    v_mfma_f32_4x4x4_16b_bf16 v[88:91], v[248:249], v[40:41], v[88:91]
    v_mfma_f32_4x4x4_16b_bf16 v[112:115], v[40:41], v[40:41], v[112:115]
    v_mfma_f32_4x4x4_16b_bf16 v[236:239], v[248:249], v[124:125], v[236:239]
    v_mfma_f32_4x4x4_16b_bf16 v[88:91], v[248:249], v[44:45], v[88:91]
    v_mfma_f32_4x4x4_16b_bf16 v[112:115], v[44:45], v[44:45], v[112:115]
    v_mfma_f32_4x4x4_16b_bf16 v[240:243], v[248:249], v[128:129], v[240:243]
    v_mfma_f32_4x4x4_16b_bf16 v[88:91], v[248:249], v[48:49], v[88:91]
    v_mfma_f32_4x4x4_16b_bf16 v[112:115], v[48:49], v[48:49], v[112:115]
    v_mfma_f32_4x4x4_16b_bf16 v[244:247], v[248:249], v[132:133], v[244:247]
    v_mfma_f32_4x4x4_16b_bf16 v[88:91], v[248:249], v[52:53], v[88:91]
    v_mfma_f32_4x4x4_16b_bf16 v[112:115], v[52:53], v[52:53], v[112:115]
    v_mfma_f32_4x4x4_16b_bf16 v[232:235], v[248:249], v[122:123], v[232:235]
    v_mfma_f32_4x4x4_16b_bf16 v[88:91], v[248:249], v[42:43], v[88:91]
    v_mfma_f32_4x4x4_16b_bf16 v[112:115], v[42:43], v[42:43], v[112:115]
    v_mfma_f32_4x4x4_16b_bf16 v[236:239], v[248:249], v[126:127], v[236:239]
    v_mfma_f32_4x4x4_16b_bf16 v[88:91], v[248:249], v[46:47], v[88:91]
    v_mfma_f32_4x4x4_16b_bf16 v[112:115], v[46:47], v[46:47], v[112:115]
    v_mfma_f32_4x4x4_16b_bf16 v[240:243], v[248:249], v[130:131], v[240:243]
    v_mfma_f32_4x4x4_16b_bf16 v[88:91], v[248:249], v[50:51], v[88:91]
    v_mfma_f32_4x4x4_16b_bf16 v[112:115], v[50:51], v[50:51], v[112:115]
    v_mfma_f32_4x4x4_16b_bf16 v[244:247], v[248:249], v[134:135], v[244:247]
    v_mfma_f32_4x4x4_16b_bf16 v[88:91], v[248:249], v[54:55], v[88:91]
    v_mfma_f32_4x4x4_16b_bf16 v[112:115], v[54:55], v[54:55], v[112:115]
    s_waitcnt lgkmcnt(0)
    v_mfma_f32_32x32x16_bf16 v[168:183], v[48:51], v[136:139], v[168:183]
    s_barrier
    ds_read_b128 v[56:59], v108 offset:0
    ds_read_b64_tr_b16 v[120:121], v72 offset:0
    ds_read_b64_tr_b16 v[122:123], v72 offset:1024
    v_mfma_f32_32x32x16_bf16 v[184:199], v[48:51], v[140:143], v[184:199]
    ds_read_b128 v[60:63], v109 offset:0
    ds_read_b64_tr_b16 v[124:125], v73 offset:0
    ds_read_b64_tr_b16 v[126:127], v73 offset:1024
    v_mfma_f32_32x32x16_bf16 v[200:215], v[48:51], v[144:147], v[200:215]
    ds_read_b128 v[64:67], v110 offset:0
    ds_read_b64_tr_b16 v[128:129], v74 offset:0
    ds_read_b64_tr_b16 v[130:131], v74 offset:1024
    v_mfma_f32_32x32x16_bf16 v[216:231], v[48:51], v[148:151], v[216:231]
    ds_read_b128 v[68:71], v111 offset:0
    ds_read_b64_tr_b16 v[132:133], v75 offset:0
    ds_read_b64_tr_b16 v[134:135], v75 offset:1024
    v_mfma_f32_32x32x16_bf16 v[168:183], v[52:55], v[152:155], v[168:183]
    ds_read_b64_tr_b16 v[136:137], v76 offset:0
    ds_read_b64_tr_b16 v[138:139], v76 offset:1024
    v_mfma_f32_32x32x16_bf16 v[184:199], v[52:55], v[156:159], v[184:199]
    ds_read_b64_tr_b16 v[140:141], v77 offset:0
    ds_read_b64_tr_b16 v[142:143], v77 offset:1024
    v_mfma_f32_32x32x16_bf16 v[200:215], v[52:55], v[160:163], v[200:215]
    ds_read_b64_tr_b16 v[144:145], v78 offset:0
    ds_read_b64_tr_b16 v[146:147], v78 offset:1024
    v_mfma_f32_32x32x16_bf16 v[216:231], v[52:55], v[164:167], v[216:231]
    ds_read_b64_tr_b16 v[148:149], v79 offset:0
    ds_read_b64_tr_b16 v[150:151], v79 offset:1024
    s_waitcnt lgkmcnt(8)
    v_mfma_f32_32x32x16_bf16 v[168:183], v[56:59], v[120:123], v[168:183]
    ds_read_b64_tr_b16 v[152:153], v80 offset:0
    ds_read_b64_tr_b16 v[154:155], v80 offset:1024
    v_mfma_f32_32x32x16_bf16 v[184:199], v[56:59], v[124:127], v[184:199]
    ds_read_b64_tr_b16 v[156:157], v81 offset:0
    ds_read_b64_tr_b16 v[158:159], v81 offset:1024
    v_mfma_f32_32x32x16_bf16 v[200:215], v[56:59], v[128:131], v[200:215]
    ds_read_b64_tr_b16 v[160:161], v82 offset:0
    ds_read_b64_tr_b16 v[162:163], v82 offset:1024
    v_mfma_f32_32x32x16_bf16 v[216:231], v[56:59], v[132:135], v[216:231]
    ds_read_b64_tr_b16 v[164:165], v83 offset:0
    ds_read_b64_tr_b16 v[166:167], v83 offset:1024
    v_mfma_f32_4x4x4_16b_bf16 v[232:235], v[248:249], v[120:121], v[232:235]
    v_mfma_f32_4x4x4_16b_bf16 v[88:91], v[248:249], v[56:57], v[88:91]
    v_mfma_f32_4x4x4_16b_bf16 v[112:115], v[56:57], v[56:57], v[112:115]
    v_mfma_f32_4x4x4_16b_bf16 v[236:239], v[248:249], v[124:125], v[236:239]
    v_mfma_f32_4x4x4_16b_bf16 v[88:91], v[248:249], v[60:61], v[88:91]
    v_mfma_f32_4x4x4_16b_bf16 v[112:115], v[60:61], v[60:61], v[112:115]
    v_mfma_f32_4x4x4_16b_bf16 v[240:243], v[248:249], v[128:129], v[240:243]
    v_mfma_f32_4x4x4_16b_bf16 v[88:91], v[248:249], v[64:65], v[88:91]
    v_mfma_f32_4x4x4_16b_bf16 v[112:115], v[64:65], v[64:65], v[112:115]
    v_mfma_f32_4x4x4_16b_bf16 v[244:247], v[248:249], v[132:133], v[244:247]
    v_mfma_f32_4x4x4_16b_bf16 v[88:91], v[248:249], v[68:69], v[88:91]
    v_mfma_f32_4x4x4_16b_bf16 v[112:115], v[68:69], v[68:69], v[112:115]
    v_mfma_f32_4x4x4_16b_bf16 v[232:235], v[248:249], v[122:123], v[232:235]
    v_mfma_f32_4x4x4_16b_bf16 v[88:91], v[248:249], v[58:59], v[88:91]
    v_mfma_f32_4x4x4_16b_bf16 v[112:115], v[58:59], v[58:59], v[112:115]
    v_mfma_f32_4x4x4_16b_bf16 v[236:239], v[248:249], v[126:127], v[236:239]
    v_mfma_f32_4x4x4_16b_bf16 v[88:91], v[248:249], v[62:63], v[88:91]
    v_mfma_f32_4x4x4_16b_bf16 v[112:115], v[62:63], v[62:63], v[112:115]
    v_mfma_f32_4x4x4_16b_bf16 v[240:243], v[248:249], v[130:131], v[240:243]
    v_mfma_f32_4x4x4_16b_bf16 v[88:91], v[248:249], v[66:67], v[88:91]
    v_mfma_f32_4x4x4_16b_bf16 v[112:115], v[66:67], v[66:67], v[112:115]
    v_mfma_f32_4x4x4_16b_bf16 v[244:247], v[248:249], v[134:135], v[244:247]
    v_mfma_f32_4x4x4_16b_bf16 v[88:91], v[248:249], v[70:71], v[88:91]
    v_mfma_f32_4x4x4_16b_bf16 v[112:115], v[70:71], v[70:71], v[112:115]
    s_waitcnt lgkmcnt(8)
    v_mfma_f32_32x32x16_bf16 v[168:183], v[60:63], v[136:139], v[168:183]
    ds_read_b64_tr_b16 v[120:121], v84 offset:0
    ds_read_b64_tr_b16 v[122:123], v84 offset:1024
    s_nop 1
    ds_write_b32 v95, v232 offset:0
    ds_write_b32 v95, v236 offset:1024
    v_mfma_f32_32x32x16_bf16 v[184:199], v[60:63], v[140:143], v[184:199]
    ds_read_b64_tr_b16 v[124:125], v85 offset:0
    ds_read_b64_tr_b16 v[126:127], v85 offset:1024
    ds_write_b32 v95, v240 offset:2048
    ds_write_b32 v95, v244 offset:3072
    s_mov_b32 s3, 0x3acccccd
    v_mfma_f32_32x32x16_bf16 v[200:215], v[60:63], v[144:147], v[200:215]
    ds_read_b64_tr_b16 v[128:129], v86 offset:0
    ds_read_b64_tr_b16 v[130:131], v86 offset:1024
    s_mov_b32 s92, 0xaaaaaaaa
    s_mov_b32 s93, 0xaaaaaaaa
    s_mov_b32 s94, 0xcccccccc
    s_mov_b32 s95, 0xcccccccc
    v_mfma_f32_32x32x16_bf16 v[216:231], v[60:63], v[148:151], v[216:231]
    ds_read_b64_tr_b16 v[132:133], v87 offset:0
    ds_read_b64_tr_b16 v[134:135], v87 offset:1024
    v_cndmask_b32 v112, v112, v113, s[92:93]
    v_cndmask_b32 v114, v114, v115, s[92:93]
    v_cndmask_b32 v112, v112, v114, s[94:95]
    s_waitcnt lgkmcnt(0)
    v_mfma_f32_32x32x16_bf16 v[168:183], v[64:67], v[152:155], v[168:183]
    s_barrier
    s_add_u32 m0, s45, 81920
    s_add_u32 s1, s96, 1376256
    s_cmp_ge_u32 s1, s97
    s_cselect_b32 s0, 1966080, 0
    s_sub_u32 s1, s1, s0
    buffer_load_dwordx4 v250, s[36:39], s1 offen offset:0 lds
    v_mfma_f32_32x32x16_bf16 v[184:199], v[64:67], v[156:159], v[184:199]
    buffer_load_dwordx4 v251, s[36:39], s1 offen offset:1024 lds
    ds_read_b128 v[84:87], v253 offset:3072
    ds_read_b128 v[80:83], v253 offset:2048
    ds_read_b128 v[76:79], v253 offset:1024
    ds_read_b128 v[72:75], v253 offset:0
    v_mfma_f32_32x32x16_bf16 v[200:215], v[64:67], v[160:163], v[200:215]
    buffer_load_dwordx4 v252, s[36:39], s1 offen offset:2048 lds
    v_mov_b32 v89, v88
    v_mov_b32 v113, v112
    s_nop 1
    v_permlane32_swap_b32 v88, v89
    v_mfma_f32_32x32x16_bf16 v[216:231], v[64:67], v[164:167], v[216:231]
    s_add_u32 m0, s45, 69632
    s_add_u32 s1, s96, 1572864
    s_cmp_ge_u32 s1, s97
    s_cselect_b32 s0, 1966080, 0
    s_sub_u32 s1, s1, s0
    buffer_load_dwordx4 v250, s[36:39], s1 offen offset:0 lds
    v_mfma_f32_32x32x16_bf16 v[168:183], v[68:71], v[120:123], v[168:183]
    buffer_load_dwordx4 v251, s[36:39], s1 offen offset:1024 lds
    v_permlane32_swap_b32 v112, v113
    s_nop 1
    v_add_f32 v88, v88, v89
    v_add_f32 v112, v112, v113
    v_mfma_f32_32x32x16_bf16 v[184:199], v[68:71], v[124:127], v[184:199]
    buffer_load_dwordx4 v252, s[36:39], s1 offen offset:2048 lds
    v_mul_f32 v88, s3, v88
    v_mul_f32 v112, s3, v112
    v_fma_f32 v112, -v88, v88, v112
    v_max_f32 v112, 0, v112
    v_mfma_f32_32x32x16_bf16 v[200:215], v[68:71], v[128:131], v[200:215]
    s_add_u32 m0, s45, 57344
    s_add_u32 s1, s96, 1769472
    s_cmp_ge_u32 s1, s97
    s_cselect_b32 s0, 1966080, 0
    s_sub_u32 s1, s1, s0
    buffer_load_dwordx4 v250, s[36:39], s1 offen offset:0 lds
    v_mfma_f32_32x32x16_bf16 v[216:231], v[68:71], v[132:135], v[216:231]
    buffer_load_dwordx4 v251, s[36:39], s1 offen offset:1024 lds
    v_cvt_pk_bf16_f32 v92, -v88, -v88
    v_cvt_pk_bf16_f32 v112, v112, v112
    v_and_b32 v112, 0xffff0000, v112
    v_add_f32 v112, 0x3727c5ac, v112
    buffer_load_dwordx4 v252, s[36:39], s1 offen offset:2048 lds
    v_cvt_pk_bf16_f32 v112, v112, v112
    v_and_b32 v112, 0xffff0000, v112
    v_sqrt_f32 v112, v112
    s_nop 0
    v_cvt_pk_bf16_f32 v93, v112, 0
    v_lshlrev_b32 v94, 16, v93
    v_rcp_f32 v94, v94
    s_nop 0
    s_lshl_b32 s3, s23, 7
    s_add_u32 s3, s3, 162816
    v_lshl_add_u32 v96, v2, 2, s3
    v_lshl_add_u32 v97, v3, 4, s3
    ds_write_b32 v96, v94
    ds_read_b128 v[100:103], v97 offset:0
    ds_read_b128 v[104:107], v97 offset:32
    ds_read_b128 v[108:111], v97 offset:64
    ds_read_b128 v[112:115], v97 offset:96
    s_waitcnt lgkmcnt(5)
    v_add_f32 v72, v72, v73
    v_add_f32 v74, v74, v75
    v_add_f32 v72, v72, v74
    v_and_b32 v73, 0xffff0000, v72
    v_sub_f32 v72, v72, v73
    v_cvt_pk_bf16_f32 v8, v73, v72
    v_add_f32 v76, v76, v77
    v_add_f32 v78, v78, v79
    v_add_f32 v76, v76, v78
    v_and_b32 v77, 0xffff0000, v76
    v_sub_f32 v76, v76, v77
    v_cvt_pk_bf16_f32 v10, v77, v76
    v_add_f32 v80, v80, v81
    v_add_f32 v82, v82, v83
    v_add_f32 v80, v80, v82
    v_and_b32 v81, 0xffff0000, v80
    v_sub_f32 v80, v80, v81
    v_cvt_pk_bf16_f32 v12, v81, v80
    v_add_f32 v84, v84, v85
    v_add_f32 v86, v86, v87
    v_add_f32 v84, v84, v86
    v_and_b32 v85, 0xffff0000, v84
    v_sub_f32 v84, v84, v85
    v_cvt_pk_bf16_f32 v14, v85, v84
    s_waitcnt lgkmcnt(0)
    s_nop 0
    v_mfma_f32_32x32x8_bf16 v[168:183], v[92:93], v[8:9], v[168:183]
    v_mfma_f32_32x32x8_bf16 v[184:199], v[92:93], v[10:11], v[184:199]
    v_mfma_f32_32x32x8_bf16 v[200:215], v[92:93], v[12:13], v[200:215]
    v_mfma_f32_32x32x8_bf16 v[216:231], v[92:93], v[14:15], v[216:231]
    s_setprio 3
    s_mul_i32 s1, s91, 40960
    s_sub_u32 s3, s21, 10
    s_lshl_b32 s3, s3, 13
    s_add_u32 s1, s1, s3
    s_add_u32 s1, s1, 5242880
    s_cmp_eq_u32 s21, 15
    s_cselect_b32 s1, 0x7ff00000, s1
    s_nop 1
    v_mul_f32 v168, v100, v168
    v_mul_f32 v169, v101, v169
    v_mul_f32 v170, v102, v170
    v_mul_f32 v171, v103, v171
    v_mul_f32 v172, v104, v172
    v_mul_f32 v173, v105, v173
    v_mul_f32 v174, v106, v174
    v_mul_f32 v175, v107, v175
    v_cvt_pk_bf16_f32 v168, v168, v169
    v_cvt_pk_bf16_f32 v169, v170, v171
    v_cvt_pk_bf16_f32 v170, v172, v173
    v_cvt_pk_bf16_f32 v171, v174, v175
    buffer_store_dwordx4 v[168:171], v0, s[28:31], s1 offen offset:0 sc1
    v_mul_f32 v176, v108, v176
    v_mul_f32 v177, v109, v177
    v_mul_f32 v178, v110, v178
    v_mul_f32 v179, v111, v179
    v_mul_f32 v180, v112, v180
    v_mul_f32 v181, v113, v181
    v_mul_f32 v182, v114, v182
    v_mul_f32 v183, v115, v183
    v_cvt_pk_bf16_f32 v172, v176, v177
    v_cvt_pk_bf16_f32 v173, v178, v179
    v_cvt_pk_bf16_f32 v174, v180, v181
    v_cvt_pk_bf16_f32 v175, v182, v183
    buffer_store_dwordx4 v[172:175], v0, s[28:31], s1 offen offset:1024 sc1
    v_mul_f32 v184, v100, v184
    v_mul_f32 v185, v101, v185
    v_mul_f32 v186, v102, v186
    v_mul_f32 v187, v103, v187
    v_mul_f32 v188, v104, v188
    v_mul_f32 v189, v105, v189
    v_mul_f32 v190, v106, v190
    v_mul_f32 v191, v107, v191
    v_cvt_pk_bf16_f32 v184, v184, v185
    v_cvt_pk_bf16_f32 v185, v186, v187
    v_cvt_pk_bf16_f32 v186, v188, v189
    v_cvt_pk_bf16_f32 v187, v190, v191
    buffer_store_dwordx4 v[184:187], v0, s[28:31], s1 offen offset:2048 sc1
    v_mul_f32 v192, v108, v192
    v_mul_f32 v193, v109, v193
    v_mul_f32 v194, v110, v194
    v_mul_f32 v195, v111, v195
    v_mul_f32 v196, v112, v196
    v_mul_f32 v197, v113, v197
    v_mul_f32 v198, v114, v198
    v_mul_f32 v199, v115, v199
    v_cvt_pk_bf16_f32 v188, v192, v193
    v_cvt_pk_bf16_f32 v189, v194, v195
    v_cvt_pk_bf16_f32 v190, v196, v197
    v_cvt_pk_bf16_f32 v191, v198, v199
    buffer_store_dwordx4 v[188:191], v0, s[28:31], s1 offen offset:3072 sc1
    s_add_u32 s1, s1, 4096
    v_mul_f32 v200, v100, v200
    v_mul_f32 v201, v101, v201
    v_mul_f32 v202, v102, v202
    v_mul_f32 v203, v103, v203
    v_mul_f32 v204, v104, v204
    v_mul_f32 v205, v105, v205
    v_mul_f32 v206, v106, v206
    v_mul_f32 v207, v107, v207
    v_cvt_pk_bf16_f32 v200, v200, v201
    v_cvt_pk_bf16_f32 v201, v202, v203
    v_cvt_pk_bf16_f32 v202, v204, v205
    v_cvt_pk_bf16_f32 v203, v206, v207
    buffer_store_dwordx4 v[200:203], v0, s[28:31], s1 offen offset:0 sc1
    v_mul_f32 v208, v108, v208
    v_mul_f32 v209, v109, v209
    v_mul_f32 v210, v110, v210
    v_mul_f32 v211, v111, v211
    v_mul_f32 v212, v112, v212
    v_mul_f32 v213, v113, v213
    v_mul_f32 v214, v114, v214
    v_mul_f32 v215, v115, v215
    v_cvt_pk_bf16_f32 v204, v208, v209
    v_cvt_pk_bf16_f32 v205, v210, v211
    v_cvt_pk_bf16_f32 v206, v212, v213
    v_cvt_pk_bf16_f32 v207, v214, v215
    buffer_store_dwordx4 v[204:207], v0, s[28:31], s1 offen offset:1024 sc1
    v_mul_f32 v216, v100, v216
    v_mul_f32 v217, v101, v217
    v_mul_f32 v218, v102, v218
    v_mul_f32 v219, v103, v219
    v_mul_f32 v220, v104, v220
    v_mul_f32 v221, v105, v221
    v_mul_f32 v222, v106, v222
    v_mul_f32 v223, v107, v223
    v_cvt_pk_bf16_f32 v216, v216, v217
    v_cvt_pk_bf16_f32 v217, v218, v219
    v_cvt_pk_bf16_f32 v218, v220, v221
    v_cvt_pk_bf16_f32 v219, v222, v223
    buffer_store_dwordx4 v[216:219], v0, s[28:31], s1 offen offset:2048 sc1
    v_mul_f32 v224, v108, v224
    v_mul_f32 v225, v109, v225
    v_mul_f32 v226, v110, v226
    v_mul_f32 v227, v111, v227
    v_mul_f32 v228, v112, v228
    v_mul_f32 v229, v113, v229
    v_mul_f32 v230, v114, v230
    v_mul_f32 v231, v115, v231
    v_cvt_pk_bf16_f32 v220, v224, v225
    v_cvt_pk_bf16_f32 v221, v226, v227
    v_cvt_pk_bf16_f32 v222, v228, v229
    v_cvt_pk_bf16_f32 v223, v230, v231
    buffer_store_dwordx4 v[220:223], v0, s[28:31], s1 offen offset:3072 sc1
L_g0m:
    s_cmp_lg_u32 s81, 0
    s_cbranch_scc1 L_tag0_x
    s_mov_b32 s83, 0
    v_mov_b32 v62, 0
L_tag0:
    global_load_dwordx2 v[60:61], v62, s[84:85] sc1
    s_add_u32 s83, s83, 1
    s_waitcnt vmcnt(0)
    v_readfirstlane_b32 s90, v60
    v_readfirstlane_b32 s3, v61
    s_cmp_gt_u32 s83, 100000
    s_cbranch_scc1 L_tag0_x
    s_cmp_eq_u32 s3, 0
    s_cbranch_scc1 L_tag0
L_tag0_x:
    s_setprio 0
    v_mul_f32 v94, v94, v94
    v_mov_b32 v60, s90
    v_mov_b32 v61, 1
    v_mov_b32 v62, 1
    ds_write_b128 v255, v[92:95]
    s_waitcnt vmcnt(8)
    s_mov_b64 exec, 1
    ds_add_u32 v254, v62 offset:8
    s_mov_b64 exec, -1
    v_mul_u32_u24 v48, 3277, v1
    v_lshrrev_b32 v48, 16, v48
    v_mul_u32_u24 v49, 20, v48
    v_sub_u32 v49, v1, v49
    s_mul_i32 s3, s16, 20
    v_add_u32 v49, s3, v49
    v_and_b32 v50, 31, v49
    v_lshrrev_b32 v49, 5, v49
    v_lshlrev_b32 v50, 4, v50
    v_lshl_add_u32 v50, v49, 11, v50
    v_and_b32 v49, 3, v48
    v_lshl_add_u32 v50, v49, 9, v50
    v_lshrrev_b32 v48, 2, v48
    v_mul_u32_u24 v48, 40960, v48
    v_add_u32 v250, v48, v50
    v_add_u32 v251, 64, v1
    v_mul_u32_u24 v48, 3277, v251
    v_lshrrev_b32 v48, 16, v48
    v_mul_u32_u24 v49, 20, v48
    v_sub_u32 v49, v251, v49
    s_mul_i32 s3, s16, 20
    v_add_u32 v49, s3, v49
    v_and_b32 v50, 31, v49
    v_lshrrev_b32 v49, 5, v49
    v_lshlrev_b32 v50, 4, v50
    v_lshl_add_u32 v50, v49, 11, v50
    v_and_b32 v49, 3, v48
    v_lshl_add_u32 v50, v49, 9, v50
    v_lshrrev_b32 v48, 2, v48
    v_mul_u32_u24 v48, 40960, v48
    v_add_u32 v251, v48, v50
    v_lshrrev_b32 v252, 1, v1
    v_lshlrev_b32 v252, 4, v252
    v_and_b32 v48, 1, v1
    v_lshl_add_u32 v252, v48, 2, v252
    s_setprio 0
    s_waitcnt vmcnt(0)
    s_mov_b64 exec, 1
    ds_add_rtn_u32 v61, v254, v61
    s_waitcnt lgkmcnt(0)
    v_readfirstlane_b32 s3, v61
    s_mov_b32 s83, 0
    s_add_u32 s1, s6, 0x70000000
    s_nop 1
    s_cmp_eq_u32 s3, 7
    s_cselect_b32 s6, s6, s1
    buffer_store_dword v60, v9, s[28:31], s6 offen sc1
    s_mov_b64 exec, -1
L_pollA:
    s_mov_b64 exec, 0xfff
    buffer_load_dword v64, v18, s[28:31], s80 offen sc1
    s_add_u32 s83, s83, 1
    s_waitcnt vmcnt(0)
    v_cmp_ne_u32 vcc, s90, v64
    s_mov_b64 exec, -1
    s_nop 3
    s_cbranch_vccz L_pollAx
    s_cmp_lt_u32 s83, 100000
    s_cbranch_scc1 L_pollA
L_pollAx:
    s_lshl_b32 s44, s41, 3
    s_add_u32 s44, s44, s20
    s_mul_i32 s44, s44, 81920
    s_add_u32 m0, s42, 0
    s_add_u32 s3, s98, s44
    buffer_load_dwordx4 v0, s[28:31], s3 offen sc1 lds
    s_add_u32 m0, s82, 4096
    s_add_u32 s3, s99, s44
    buffer_load_dword v252, s[28:31], s3 offen sc1 lds
    s_lshr_b32 s55, s44, 1
    s_add_u32 m0, s43, 5120
    s_add_u32 s55, s55, 5242880
    buffer_load_dwordx4 v250, s[28:31], s55 offen sc1 lds
    s_add_u32 m0, s43, 6144
    s_mov_b64 exec, 0xffff
    buffer_load_dwordx4 v251, s[28:31], s55 offen sc1 lds
    s_mov_b64 exec, -1
    s_mul_i32 s3, s23, 1280
    s_add_u32 m0, s3, 20480
    s_nop 0
    buffer_load_dwordx4 v0, s[28:31], s100 offen sc1 lds
    s_add_u32 m0, s3, 21504
    s_add_u32 s100, s100, 327680
    buffer_load_dword v252, s[28:31], s101 offen sc1 lds
    s_add_u32 m0, s3, 25600
    s_add_u32 s101, s101, 327680
    buffer_load_dwordx4 v0, s[28:31], s100 offen sc1 lds
    s_add_u32 m0, s3, 26624
    s_nop 0
    buffer_load_dword v252, s[28:31], s101 offen sc1 lds
    s_lshl_b32 s44, s41, 3
    s_add_u32 s44, s44, s20
    s_add_u32 s44, s44, 4
    s_mul_i32 s44, s44, 81920
    s_add_u32 m0, s42, 10240
    s_add_u32 s3, s98, s44
    buffer_load_dwordx4 v0, s[28:31], s3 offen sc1 lds
    s_add_u32 m0, s82, 14336
    s_add_u32 s3, s99, s44
    buffer_load_dword v252, s[28:31], s3 offen sc1 lds
    s_lshr_b32 s55, s44, 1
    s_add_u32 m0, s43, 15360
    s_add_u32 s55, s55, 5242880
    buffer_load_dwordx4 v250, s[28:31], s55 offen sc1 lds
    s_add_u32 m0, s43, 16384
    s_mov_b64 exec, 0xffff
    buffer_load_dwordx4 v251, s[28:31], s55 offen sc1 lds
    s_mov_b64 exec, -1
    s_add_u32 s41, s41, 1
    s_and_b32 s41, s41, 7
    v_add_u32 v42, 22454272, v19
    s_waitcnt vmcnt(8)
    s_mov_b32 exec_hi, 0
    buffer_load_dword v41, v42, s[28:31], 0 offen sc1
    s_mov_b32 exec_hi, -1
    s_setprio 0
    s_waitcnt vmcnt(5)
    s_branch L_att
L_g1:
    v_bfe_u32 v172, v1, 1, 3
    v_xor_b32 v172, v172, v3
    v_lshlrev_b32 v172, 4, v172
    v_lshl_add_u32 v172, v2, 7, v172
    v_add_u32 v172, s43, v172
    v_xor_b32 v173, 32, v172
    v_xor_b32 v174, 64, v172
    v_xor_b32 v175, 96, v172
    s_mov_b32 s28, s12
    s_and_b32 s29, s13, 0xffff
    s_mov_b32 s30, 22618368
    s_mov_b32 s31, 0x20000
    s_mov_b32 s36, s92
    s_and_b32 s37, s93, 0xffff
    s_mov_b32 s38, 1966080
    s_mov_b32 s39, 0x20000
    v_lshrrev_b32 v190, 4, v1
    v_mul_u32_u24 v188, 3840, v190
    v_and_b32 v189, 15, v1
    v_lshlrev_b32 v190, 2, v190
    v_xor_b32 v189, v189, v190
    v_lshl_add_u32 v176, v189, 4, v188
    v_add_u32 v177, 14336, v176
    v_add_u32 v178, 28672, v176
    v_add_u32 v179, 43008, v176
    s_mul_i32 s83, s23, 61440
    s_lshl_b32 s3, s21, 8
    s_add_u32 s83, s83, s3
    s_add_u32 s41, s83, 2457600
    s_mul_i32 s3, s42, 245760
    s_add_u32 s83, s83, s3
    s_add_u32 s1, s83, 491520
    s_add_u32 m0, s43, 49152
    s_add_u32 s0, s0, 128
    s_cmp_ge_u32 s0, s40
    s_cselect_b32 s3, 1280, 0
    s_sub_u32 s0, s0, s3
    buffer_load_dwordx4 v168, s[24:27], s0 offen offset:0 lds
    buffer_load_dwordx4 v169, s[24:27], s0 offen offset:1024 lds
    buffer_load_dwordx4 v170, s[24:27], s0 offen offset:2048 lds
    buffer_load_dwordx4 v171, s[24:27], s0 offen offset:3072 lds
    s_setprio 0
    s_waitcnt vmcnt(8)
    s_barrier
    ds_read_b128 v[8:11], v172 offset:16384
    ds_read_b128 v[12:15], v173 offset:16384
    ds_read_b128 v[16:19], v174 offset:16384
    ds_read_b128 v[20:23], v175 offset:16384
    s_add_u32 m0, s43, 32768
    s_add_u32 s0, s0, 128
    s_cmp_ge_u32 s0, s40
    s_cselect_b32 s3, 1280, 0
    s_sub_u32 s0, s0, s3
    buffer_load_dwordx4 v168, s[24:27], s0 offen offset:0 lds
    buffer_load_dwordx4 v169, s[24:27], s0 offen offset:1024 lds
    buffer_load_dwordx4 v170, s[24:27], s0 offen offset:2048 lds
    buffer_load_dwordx4 v171, s[24:27], s0 offen offset:3072 lds
    s_add_u32 m0, s43, 98304
    s_add_u32 s1, s1, 245760
    s_cmp_ge_u32 s1, s41
    s_cselect_b32 s3, 2457600, 0
    s_sub_u32 s1, s1, s3
    buffer_load_dwordx4 v176, s[32:35], s1 offen offset:0 lds
    buffer_load_dwordx4 v177, s[32:35], s1 offen offset:1024 lds
    buffer_load_dwordx4 v178, s[32:35], s1 offen offset:2048 lds
    buffer_load_dwordx4 v179, s[32:35], s1 offen offset:3072 lds
    s_waitcnt vmcnt(12)
    ds_read_b128 v[24:27], v172 offset:0
    ds_read_b128 v[28:31], v173 offset:0
    ds_read_b128 v[32:35], v174 offset:0
    ds_read_b128 v[36:39], v175 offset:0
    s_waitcnt lgkmcnt(4)
    s_barrier
    s_add_u32 m0, s43, 16384
    s_add_u32 s0, s0, 128
    s_cmp_ge_u32 s0, s40
    s_cselect_b32 s3, 1280, 0
    s_sub_u32 s0, s0, s3
    buffer_load_dwordx4 v168, s[24:27], s0 offen offset:0 lds
    buffer_load_dwordx4 v169, s[24:27], s0 offen offset:1024 lds
    buffer_load_dwordx4 v170, s[24:27], s0 offen offset:2048 lds
    buffer_load_dwordx4 v171, s[24:27], s0 offen offset:3072 lds
    s_add_u32 m0, s43, 81920
    s_add_u32 s1, s1, 245760
    s_cmp_ge_u32 s1, s41
    s_cselect_b32 s3, 2457600, 0
    s_sub_u32 s1, s1, s3
    buffer_load_dwordx4 v176, s[32:35], s1 offen offset:0 lds
    buffer_load_dwordx4 v177, s[32:35], s1 offen offset:1024 lds
    buffer_load_dwordx4 v178, s[32:35], s1 offen offset:2048 lds
    buffer_load_dwordx4 v179, s[32:35], s1 offen offset:3072 lds
    v_and_b32 v188, 19, v2
    v_bfe_u32 v189, v2, 2, 1
    v_lshl_add_u32 v188, v189, 3, v188
    v_bfe_u32 v189, v2, 3, 1
    v_lshl_add_u32 v188, v189, 2, v188
    v_mul_u32_u24 v189, 20, v3
    v_add_u32 v189, v189, v2
    v_lshlrev_b32 v189, 4, v189
    v_lshlrev_b32 v5, 3, v188
    v_add_u32 v5, 4096, v5
    v_lshlrev_b32 v4, 4, v188
    v_lshl_add_u32 v4, v3, 9, v4
    v_add_u32 v6, 5120, v189
    v_mov_b32 v7, 0xdddddddd
    s_waitcnt vmcnt(16)
    ds_read_b128 v[40:43], v172 offset:49152
    ds_read_b128 v[44:47], v173 offset:49152
    ds_read_b128 v[48:51], v174 offset:49152
    ds_read_b128 v[52:55], v175 offset:49152
    s_waitcnt lgkmcnt(4)
    s_barrier
    s_add_u32 m0, s43, 0
    s_add_u32 s0, s0, 128
    s_cmp_ge_u32 s0, s40
    s_cselect_b32 s3, 1280, 0
    s_sub_u32 s0, s0, s3
    buffer_load_dwordx4 v168, s[24:27], s0 offen offset:0 lds
    buffer_load_dwordx4 v169, s[24:27], s0 offen offset:1024 lds
    buffer_load_dwordx4 v170, s[24:27], s0 offen offset:2048 lds
    buffer_load_dwordx4 v171, s[24:27], s0 offen offset:3072 lds
    s_add_u32 m0, s43, 65536
    s_add_u32 s1, s1, 245760
    s_cmp_ge_u32 s1, s41
    s_cselect_b32 s3, 2457600, 0
    s_sub_u32 s1, s1, s3
    buffer_load_dwordx4 v176, s[32:35], s1 offen offset:0 lds
    buffer_load_dwordx4 v177, s[32:35], s1 offen offset:1024 lds
    buffer_load_dwordx4 v178, s[32:35], s1 offen offset:2048 lds
    buffer_load_dwordx4 v179, s[32:35], s1 offen offset:3072 lds
    s_lshl_b32 s6, s21, 4
    s_add_u32 s6, s6, s82
    s_lshl_b32 s80, s6, 1
    s_add_u32 s80, s80, s23
    s_lshl_b32 s6, s6, 7
    s_add_u32 s6, s6, 22454272
    s_lshl_b32 s3, s82, 1
    s_add_u32 s3, s3, s23
    s_add_u32 s3, s3, 510
    s_cmp_eq_u32 s21, 15
    s_cselect_b32 s3, s3, 1023
    s_cmp_lt_u32 s23, 2
    s_cselect_b32 s80, s80, s3
    s_and_b32 s81, s80, 3
    s_lshr_b32 s80, s80, 2
    s_mul_i32 s93, s80, 20
    s_mul_i32 s3, s81, 5
    s_add_u32 s93, s93, s3
    s_lshl_b32 s93, s93, 10
    s_add_u32 s93, s93, 19398656
    s_cmp_lt_u32 s80, 136
    s_cselect_b32 s93, s93, 0x7ff00000
    v_bfe_u32 v188, v1, 2, 2
    v_lshl_add_u32 v188, v3, 2, v188
    v_mul_u32_u24 v188, 320, v188
    v_bfe_u32 v189, v1, 4, 1
    v_lshl_add_u32 v188, v189, 5, v188
    v_and_b32 v189, 3, v1
    v_lshl_add_u32 v188, v189, 3, v188
    s_mul_i32 s3, s23, 5120
    s_add_u32 s3, s3, 131072
    v_add_u32 v187, s3, v188
    s_waitcnt vmcnt(16)
    ds_read_b128 v[56:59], v172 offset:32768
    ds_read_b128 v[60:63], v173 offset:32768
    ds_read_b128 v[64:67], v174 offset:32768
    ds_read_b128 v[68:71], v175 offset:32768
    s_waitcnt lgkmcnt(4)
    s_barrier
    s_add_u32 m0, s43, 49152
    s_add_u32 s0, s0, 128
    s_cmp_ge_u32 s0, s40
    s_cselect_b32 s3, 1280, 0
    s_sub_u32 s0, s0, s3
    buffer_load_dwordx4 v168, s[24:27], s0 offen offset:0 lds
    buffer_load_dwordx4 v169, s[24:27], s0 offen offset:1024 lds
    buffer_load_dwordx4 v170, s[24:27], s0 offen offset:2048 lds
    buffer_load_dwordx4 v171, s[24:27], s0 offen offset:3072 lds
    s_add_u32 m0, s43, 114688
    s_add_u32 s1, s1, 245760
    s_cmp_ge_u32 s1, s41
    s_cselect_b32 s3, 2457600, 0
    s_sub_u32 s1, s1, s3
    buffer_load_dwordx4 v176, s[32:35], s1 offen offset:0 lds
    buffer_load_dwordx4 v177, s[32:35], s1 offen offset:1024 lds
    buffer_load_dwordx4 v178, s[32:35], s1 offen offset:2048 lds
    buffer_load_dwordx4 v179, s[32:35], s1 offen offset:3072 lds
    v_add_u32 v188, 0, v1
    v_mul_u32_u24 v189, 5462, v188
    v_lshrrev_b32 v189, 16, v189
    v_mul_u32_u24 v189, 2880, v189
    v_add_u32 v184, v189, v0
    v_add_u32 v188, 64, v1
    v_mul_u32_u24 v189, 5462, v188
    v_lshrrev_b32 v189, 16, v189
    v_mul_u32_u24 v189, 2880, v189
    v_add_u32 v185, v189, v0
    v_add_u32 v188, 128, v1
    v_mul_u32_u24 v189, 5462, v188
    v_lshrrev_b32 v189, 16, v189
    v_mul_u32_u24 v189, 2880, v189
    v_add_u32 v186, v189, v0
    s_mul_i32 s96, s23, 49152
    s_mul_i32 s3, s21, 192
    s_add_u32 s96, s96, s3
    s_add_u32 s92, s96, 1966080
    s_mul_i32 s3, s42, 196608
    s_add_u32 s96, s96, s3
    s_mul_i32 s45, s23, 3072
    s_waitcnt vmcnt(16)
    ds_read_b128 v[72:75], v172 offset:16384
    ds_read_b128 v[76:79], v173 offset:16384
    ds_read_b128 v[80:83], v174 offset:16384
    ds_read_b128 v[84:87], v175 offset:16384
    s_waitcnt lgkmcnt(4)
    s_barrier
    v_mov_b32 v194, 0
    s_add_u32 m0, s43, 32768
    s_add_u32 s0, s0, 128
    s_cmp_ge_u32 s0, s40
    s_cselect_b32 s3, 1280, 0
    s_sub_u32 s0, s0, s3
    buffer_load_dwordx4 v168, s[24:27], s0 offen offset:0 lds
    buffer_load_dwordx4 v169, s[24:27], s0 offen offset:1024 lds
    buffer_load_dwordx4 v170, s[24:27], s0 offen offset:2048 lds
    buffer_load_dwordx4 v171, s[24:27], s0 offen offset:3072 lds
    s_add_u32 m0, s43, 98304
    s_add_u32 s1, s1, 245760
    s_cmp_ge_u32 s1, s41
    s_cselect_b32 s3, 2457600, 0
    s_sub_u32 s1, s1, s3
    buffer_load_dwordx4 v176, s[32:35], s1 offen offset:0 lds
    buffer_load_dwordx4 v177, s[32:35], s1 offen offset:1024 lds
    buffer_load_dwordx4 v178, s[32:35], s1 offen offset:2048 lds
    buffer_load_dwordx4 v179, s[32:35], s1 offen offset:3072 lds
    global_load_dwordx2 v[192:193], v194, s[84:85] sc1
    v_bfe_u32 v188, v1, 2, 2
    v_lshl_add_u32 v188, v3, 3, v188
    v_mul_u32_u24 v188, 192, v188
    v_bfe_u32 v189, v1, 4, 1
    v_lshl_add_u32 v188, v189, 5, v188
    v_and_b32 v189, 3, v1
    v_lshl_add_u32 v188, v189, 3, v188
    v_add_u32 v248, 32768, v188
    v_add_u32 v249, 94208, v188
    s_waitcnt vmcnt(17)
    ds_read_b128 v[88:91], v172 offset:0
    ds_read_b128 v[92:95], v173 offset:0
    ds_read_b128 v[96:99], v174 offset:0
    ds_read_b128 v[100:103], v175 offset:0
    s_waitcnt lgkmcnt(4)
    s_barrier
    ds_read_b64_tr_b16 v[196:197], v187 offset:0
    ds_read_b64_tr_b16 v[198:199], v187 offset:2560
    ds_read_b64_tr_b16 v[200:201], v187 offset:64
    ds_read_b64_tr_b16 v[202:203], v187 offset:2624
    ds_read_b64_tr_b16 v[204:205], v187 offset:128
    ds_read_b64_tr_b16 v[206:207], v187 offset:2688
    ds_read_b64_tr_b16 v[208:209], v187 offset:192
    ds_read_b64_tr_b16 v[210:211], v187 offset:2752
    ds_read_b64_tr_b16 v[212:213], v187 offset:256
    ds_read_b64_tr_b16 v[214:215], v187 offset:2816
    s_add_u32 m0, s43, 16384
    s_add_u32 s0, s0, 128
    s_cmp_ge_u32 s0, s40
    s_cselect_b32 s3, 1280, 0
    s_sub_u32 s0, s0, s3
    buffer_load_dwordx4 v168, s[24:27], s0 offen offset:0 lds
    buffer_load_dwordx4 v169, s[24:27], s0 offen offset:1024 lds
    buffer_load_dwordx4 v170, s[24:27], s0 offen offset:2048 lds
    buffer_load_dwordx4 v171, s[24:27], s0 offen offset:3072 lds
    s_add_u32 m0, s43, 81920
    s_add_u32 s1, s1, 245760
    s_cmp_ge_u32 s1, s41
    s_cselect_b32 s3, 2457600, 0
    s_sub_u32 s1, s1, s3
    buffer_load_dwordx4 v176, s[32:35], s1 offen offset:0 lds
    buffer_load_dwordx4 v177, s[32:35], s1 offen offset:1024 lds
    buffer_load_dwordx4 v178, s[32:35], s1 offen offset:2048 lds
    buffer_load_dwordx4 v179, s[32:35], s1 offen offset:3072 lds
    s_waitcnt lgkmcnt(0)
    s_waitcnt vmcnt(17)
    ds_read_b128 v[104:107], v172 offset:49152
    ds_read_b128 v[108:111], v173 offset:49152
    ds_read_b128 v[112:115], v174 offset:49152
    ds_read_b128 v[116:119], v175 offset:49152
    s_barrier
    s_add_u32 m0, s43, 0
    s_add_u32 s0, s0, 128
    s_cmp_ge_u32 s0, s40
    s_cselect_b32 s3, 1280, 0
    s_sub_u32 s0, s0, s3
    buffer_load_dwordx4 v168, s[24:27], s0 offen offset:0 lds
    buffer_load_dwordx4 v169, s[24:27], s0 offen offset:1024 lds
    buffer_load_dwordx4 v170, s[24:27], s0 offen offset:2048 lds
    buffer_load_dwordx4 v171, s[24:27], s0 offen offset:3072 lds
    s_add_u32 m0, s43, 65536
    s_add_u32 s1, s1, 245760
    s_cmp_ge_u32 s1, s41
    s_cselect_b32 s3, 2457600, 0
    s_sub_u32 s1, s1, s3
    buffer_load_dwordx4 v176, s[32:35], s1 offen offset:0 lds
    buffer_load_dwordx4 v177, s[32:35], s1 offen offset:1024 lds
    buffer_load_dwordx4 v178, s[32:35], s1 offen offset:2048 lds
    buffer_load_dwordx4 v179, s[32:35], s1 offen offset:3072 lds
    s_add_u32 m0, s45, 143360
    s_add_u32 s97, s96, 0
    s_cmp_ge_u32 s97, s92
    s_cselect_b32 s3, 1966080, 0
    s_sub_u32 s97, s97, s3
    buffer_load_dwordx4 v184, s[36:39], s97 offen offset:0 lds
    buffer_load_dwordx4 v185, s[36:39], s97 offen offset:1024 lds
    buffer_load_dwordx4 v186, s[36:39], s97 offen offset:2048 lds
    buffer_store_dwordx4 v[196:199], v0, s[28:31], s93 offen offset:0 sc1
    s_waitcnt vmcnt(21)
    ds_read_b128 v[120:123], v172 offset:32768
    ds_read_b128 v[124:127], v173 offset:32768
    ds_read_b128 v[128:131], v174 offset:32768
    ds_read_b128 v[132:135], v175 offset:32768
    s_waitcnt lgkmcnt(4)
    s_barrier
    s_add_u32 m0, s45, 131072
    s_add_u32 s97, s96, 196608
    s_cmp_ge_u32 s97, s92
    s_cselect_b32 s3, 1966080, 0
    s_sub_u32 s97, s97, s3
    buffer_load_dwordx4 v184, s[36:39], s97 offen offset:0 lds
    buffer_load_dwordx4 v185, s[36:39], s97 offen offset:1024 lds
    buffer_load_dwordx4 v186, s[36:39], s97 offen offset:2048 lds
    s_add_u32 m0, s45, 118784
    s_add_u32 s97, s96, 393216
    s_cmp_ge_u32 s97, s92
    s_cselect_b32 s3, 1966080, 0
    s_sub_u32 s97, s97, s3
    buffer_load_dwordx4 v184, s[36:39], s97 offen offset:0 lds
    buffer_load_dwordx4 v185, s[36:39], s97 offen offset:1024 lds
    buffer_load_dwordx4 v186, s[36:39], s97 offen offset:2048 lds
    buffer_store_dwordx4 v[200:203], v0, s[28:31], s93 offen offset:1024 sc1
    buffer_store_dwordx4 v[204:207], v0, s[28:31], s93 offen offset:2048 sc1
    s_lshl_b32 s16, s14, 2
    s_and_b32 s17, s15, 3
    s_add_u32 s16, s16, s17
    s_lshr_b32 s17, s15, 2
    s_lshl_b32 s40, s17, 3
    s_add_u32 s40, s40, s20
    s_mul_i32 s80, s16, 5
    s_lshr_b32 s80, s80, 1
    s_and_b32 s81, s16, 1
    s_add_u32 s44, s80, s81
    s_lshl_b32 s44, s44, 9
    s_xor_b32 s83, s81, 1
    s_lshl_b32 s83, s83, 1
    s_add_u32 s80, s80, s83
    s_lshl_b32 s80, s80, 9
    s_lshl_b32 s81, s81, 3
    s_add_u32 s55, s80, s81
    s_mul_i32 s80, s40, 81920
    s_add_u32 s100, s44, s80
    s_add_u32 s101, s55, s80
    s_add_u32 s98, s44, 40960
    s_add_u32 s99, s55, 40960
    s_add_u32 s41, s16, s22
    s_and_b32 s41, s41, 7
    s_mul_i32 s80, s22, 10240
    s_lshl_b32 s42, s23, 10
    s_add_u32 s42, s42, s80
    s_lshl_b32 s82, s23, 8
    s_add_u32 s82, s82, s80
    s_mul_i32 s43, s23, 1280
    s_add_u32 s43, s43, s80
    s_lshl_b32 s18, s14, 3
    s_and_b32 s19, s15, 7
    s_add_u32 s18, s18, s19
    s_lshr_b32 s19, s15, 3
    s_mul_i32 s48, s23, 24
    s_add_u32 s49, s48, s22
    s_sub_u32 s48, s48, s22
    s_add_u32 s48, s48, 1
    s_mul_i32 s50, s18, 96
    s_add_u32 s51, s50, s48
    s_add_u32 s50, s50, s49
    s_lshl_b32 s50, s50, 10
    s_lshl_b32 s51, s51, 10
    s_add_u32 s50, s50, 7864320
    s_add_u32 s51, s51, 7864320
    s_mul_i32 s52, s19, 5
    s_mul_i32 s49, s49, 20
    s_mul_i32 s48, s48, 20
    s_add_u32 s49, s49, s52
    s_waitcnt vmcnt(20)
    ds_read_b128 v[136:139], v172 offset:16384
    ds_read_b128 v[140:143], v173 offset:16384
    ds_read_b128 v[144:147], v174 offset:16384
    ds_read_b128 v[148:151], v175 offset:16384
    v_readfirstlane_b32 s90, v192
    v_readfirstlane_b32 s3, v193
    s_nop 3
    s_cmp_lg_u32 s3, 0
    s_cbranch_scc1 L_tag1_x
    s_mov_b32 s83, 0
    v_mov_b32 v194, 0
L_tag1:
    global_load_dwordx2 v[192:193], v194, s[84:85] sc1
    s_add_u32 s83, s83, 1
    s_waitcnt vmcnt(0)
    v_readfirstlane_b32 s90, v192
    v_readfirstlane_b32 s3, v193
    s_cmp_gt_u32 s83, 100000
    s_cbranch_scc1 L_tag1_x
    s_cmp_eq_u32 s3, 0
    s_cbranch_scc1 L_tag1
L_tag1_x:
    s_waitcnt lgkmcnt(4)
    s_barrier
    s_add_u32 m0, s45, 106496
    s_add_u32 s97, s96, 589824
    s_cmp_ge_u32 s97, s92
    s_cselect_b32 s3, 1966080, 0
    s_sub_u32 s97, s97, s3
    buffer_load_dwordx4 v184, s[36:39], s97 offen offset:0 lds
    buffer_load_dwordx4 v185, s[36:39], s97 offen offset:1024 lds
    buffer_load_dwordx4 v186, s[36:39], s97 offen offset:2048 lds
    s_add_u32 m0, s45, 45056
    s_add_u32 s97, s96, 786432
    s_cmp_ge_u32 s97, s92
    s_cselect_b32 s3, 1966080, 0
    s_sub_u32 s97, s97, s3
    buffer_load_dwordx4 v184, s[36:39], s97 offen offset:0 lds
    buffer_load_dwordx4 v185, s[36:39], s97 offen offset:1024 lds
    buffer_load_dwordx4 v186, s[36:39], s97 offen offset:2048 lds
    buffer_store_dwordx4 v[208:211], v0, s[28:31], s93 offen offset:3072 sc1
    s_add_u32 s93, s93, 4096
    buffer_store_dwordx4 v[212:215], v0, s[28:31], s93 offen sc1
    s_add_u32 s48, s48, s52
    s_lshl_b32 s49, s49, 10
    s_lshl_b32 s48, s48, 10
    s_add_u32 s52, s49, 19402752
    s_lshl_b32 s53, s22, 11
    s_add_u32 s53, s53, 19398656
    s_add_u32 s49, s49, s53
    s_add_u32 s48, s48, s53
    s_mul_i32 s53, s19, 5
    s_add_u32 s54, s53, s23
    s_mul_i32 s80, s23, 200
    s_add_u32 s80, s80, s53
    s_add_u32 s80, s80, 4
    s_cmp_eq_u32 s22, 0
    s_cselect_b32 s53, s54, s80
    s_mul_i32 s80, s22, 300
    s_add_u32 s80, s80, 200
    s_add_u32 s54, s54, s80
    s_lshl_b32 s53, s53, 10
    s_lshl_b32 s54, s54, 10
    s_add_u32 s53, s53, 21364736
    s_add_u32 s54, s54, 21364736
    s_mov_b32 s46, 0xfffff
    s_mov_b32 s47, 0xfffff
    s_lshl_b32 s4, s91, 4
    s_add_u32 s4, s4, s21
    s_lshl_b32 s4, s4, 7
    s_add_u32 s4, s4, 22487040
    s_lshl_b32 s5, s18, 2
    s_add_u32 s5, s5, s23
    s_lshl_b32 s5, s5, 9
    s_add_u32 s5, s5, 22487040
    s_and_b32 s7, s15, 7
    s_add_u32 s7, s7, 7
    s_mul_i32 s7, s7, 20480
    s_add_u32 s7, s7, s54
    v_mul_u32_u24 v188, 3277, v1
    v_lshrrev_b32 v188, 16, v188
    v_mul_u32_u24 v189, 20, v188
    v_sub_u32 v189, v1, v189
    s_mul_i32 s3, s16, 20
    v_add_u32 v189, s3, v189
    v_and_b32 v190, 31, v189
    v_lshrrev_b32 v189, 5, v189
    v_lshlrev_b32 v190, 4, v190
    v_lshl_add_u32 v190, v189, 11, v190
    v_and_b32 v189, 3, v188
    v_lshl_add_u32 v190, v189, 9, v190
    v_lshrrev_b32 v188, 2, v188
    v_mul_u32_u24 v188, 40960, v188
    v_add_u32 v250, v188, v190
    v_add_u32 v251, 64, v1
    v_mul_u32_u24 v188, 3277, v251
    v_lshrrev_b32 v188, 16, v188
    v_mul_u32_u24 v189, 20, v188
    v_sub_u32 v189, v251, v189
    s_mul_i32 s3, s16, 20
    v_add_u32 v189, s3, v189
    v_and_b32 v190, 31, v189
    v_lshrrev_b32 v189, 5, v189
    v_lshlrev_b32 v190, 4, v190
    v_lshl_add_u32 v190, v189, 11, v190
    v_and_b32 v189, 3, v188
    v_lshl_add_u32 v190, v189, 9, v190
    v_lshrrev_b32 v188, 2, v188
    v_mul_u32_u24 v188, 40960, v188
    v_add_u32 v251, v188, v190
    v_lshrrev_b32 v252, 1, v1
    v_lshlrev_b32 v252, 4, v252
    v_and_b32 v188, 1, v1
    v_lshl_add_u32 v252, v188, 2, v252
    s_waitcnt vmcnt(20)
    ds_read_b128 v[152:155], v172 offset:0
    ds_read_b128 v[156:159], v173 offset:0
    ds_read_b128 v[160:163], v174 offset:0
    ds_read_b128 v[164:167], v175 offset:0
    s_waitcnt lgkmcnt(4)
    s_waitcnt vmcnt(17)
    s_barrier
    s_add_u32 m0, s45, 32768
    s_add_u32 s97, s96, 983040
    s_cmp_ge_u32 s97, s92
    s_cselect_b32 s3, 1966080, 0
    s_sub_u32 s97, s97, s3
    buffer_load_dwordx4 v184, s[36:39], s97 offen offset:0 lds
    buffer_load_dwordx4 v185, s[36:39], s97 offen offset:1024 lds
    buffer_load_dwordx4 v186, s[36:39], s97 offen offset:2048 lds
    s_add_u32 m0, s45, 94208
    s_add_u32 s97, s96, 1179648
    s_cmp_ge_u32 s97, s92
    s_cselect_b32 s3, 1966080, 0
    s_sub_u32 s97, s97, s3
    buffer_load_dwordx4 v184, s[36:39], s97 offen offset:0 lds
    buffer_load_dwordx4 v185, s[36:39], s97 offen offset:1024 lds
    buffer_load_dwordx4 v186, s[36:39], s97 offen offset:2048 lds
    s_waitcnt vmcnt(6)
    v_mov_b32 v189, 163328
    v_mov_b32 v190, 1
    s_mov_b64 exec, 1
    ds_add_u32 v189, v190
    s_mov_b64 exec, -1
    s_mov_b32 s32, s94
    s_and_b32 s33, s95, 0xffff
    s_mov_b32 s34, 3072
    s_mov_b32 s35, 0x20000
    v_lshlrev_b32 v188, 1, v2
    v_lshl_add_u32 v188, v3, 31, v188
    s_mul_i32 s3, s21, 192
    buffer_load_ushort v253, v188, s[32:35], s3 offen offset:0
    buffer_load_ushort v254, v188, s[32:35], s3 offen offset:64
    buffer_load_ushort v255, v188, s[32:35], s3 offen offset:128
    s_waitcnt lgkmcnt(1)
    s_waitcnt lgkmcnt(0)
    s_mul_i32 s96, s91, 96
    s_mul_i32 s3, s21, 6
    s_add_u32 s96, s96, s3
    s_lshl_b32 s96, s96, 10
    s_add_u32 s96, s96, 7864320
    s_add_u32 s92, s96, 4096
    s_lshl_b32 s97, s91, 7
    s_add_u32 s97, s97, 22183936
    s_cmp_eq_u32 s21, 0
    s_cselect_b32 s97, s97, 0x7ff00000
    ds_read_b64_tr_b16 v[216:217], v249 offset:49152
    ds_read_b64_tr_b16 v[218:219], v249 offset:49920
    ds_read_b64_tr_b16 v[220:221], v249 offset:49216
    ds_read_b64_tr_b16 v[222:223], v249 offset:49984
    ds_read_b64_tr_b16 v[224:225], v249 offset:49280
    ds_read_b64_tr_b16 v[226:227], v249 offset:50048
    ds_read_b64_tr_b16 v[228:229], v249 offset:52224
    ds_read_b64_tr_b16 v[230:231], v249 offset:52992
    ds_read_b64_tr_b16 v[232:233], v249 offset:52288
    ds_read_b64_tr_b16 v[234:235], v249 offset:53056
    ds_read_b64_tr_b16 v[236:237], v249 offset:52352
    ds_read_b64_tr_b16 v[238:239], v249 offset:53120
    s_barrier
    s_setprio 0
    s_waitcnt lgkmcnt(6)
    v_mfma_f32_32x32x16_bf16 v[168:183], v[216:219], v[8:11], 0
    ds_read_b64_tr_b16 v[240:241], v249 offset:55296
    ds_read_b64_tr_b16 v[242:243], v249 offset:56064
    v_mfma_f32_32x32x16_bf16 v[184:199], v[220:223], v[8:11], 0
    ds_read_b64_tr_b16 v[244:245], v249 offset:55360
    ds_read_b64_tr_b16 v[246:247], v249 offset:56128
    v_mfma_f32_32x32x16_bf16 v[200:215], v[224:227], v[8:11], 0
    ds_read_b64_tr_b16 v[216:217], v249 offset:55424
    ds_read_b64_tr_b16 v[218:219], v249 offset:56192
    s_waitcnt lgkmcnt(6)
    v_mfma_f32_32x32x16_bf16 v[168:183], v[228:231], v[12:15], v[168:183]
    ds_read_b64_tr_b16 v[220:221], v249 offset:58368
    ds_read_b64_tr_b16 v[222:223], v249 offset:59136
    v_mfma_f32_32x32x16_bf16 v[184:199], v[232:235], v[12:15], v[184:199]
    ds_read_b64_tr_b16 v[224:225], v249 offset:58432
    ds_read_b64_tr_b16 v[226:227], v249 offset:59200
    v_mfma_f32_32x32x16_bf16 v[200:215], v[236:239], v[12:15], v[200:215]
    ds_read_b64_tr_b16 v[228:229], v249 offset:58496
    ds_read_b64_tr_b16 v[230:231], v249 offset:59264
    s_waitcnt lgkmcnt(6)
    v_mfma_f32_32x32x16_bf16 v[168:183], v[240:243], v[16:19], v[168:183]
    ds_read_b64_tr_b16 v[232:233], v249 offset:36864
    ds_read_b64_tr_b16 v[234:235], v249 offset:37632
    v_mfma_f32_32x32x16_bf16 v[184:199], v[244:247], v[16:19], v[184:199]
    ds_read_b64_tr_b16 v[236:237], v249 offset:36928
    ds_read_b64_tr_b16 v[238:239], v249 offset:37696
    v_mfma_f32_32x32x16_bf16 v[200:215], v[216:219], v[16:19], v[200:215]
    ds_read_b64_tr_b16 v[240:241], v249 offset:36992
    ds_read_b64_tr_b16 v[242:243], v249 offset:37760
    s_waitcnt lgkmcnt(6)
    v_mfma_f32_32x32x16_bf16 v[168:183], v[220:223], v[20:23], v[168:183]
    ds_read_b64_tr_b16 v[244:245], v249 offset:39936
    ds_read_b64_tr_b16 v[246:247], v249 offset:40704
    v_mov_b32 v8, 0x3f803f80
    v_mov_b32 v9, 0x3f803f80
    v_add_u32 v10, s45, v248
    v_mfma_f32_32x32x16_bf16 v[184:199], v[224:227], v[20:23], v[184:199]
    ds_read_b64_tr_b16 v[216:217], v249 offset:40000
    ds_read_b64_tr_b16 v[218:219], v249 offset:40768
    v_add_u32 v11, s45, v249
    v_add_u32 v13, 159744, v0
    s_lshl_b32 s3, s23, 2
    v_add_u32 v12, s3, v13
    v_mfma_f32_32x32x16_bf16 v[200:215], v[228:231], v[20:23], v[200:215]
    ds_read_b64_tr_b16 v[220:221], v249 offset:40064
    ds_read_b64_tr_b16 v[222:223], v249 offset:40832
    s_lshl_b32 s3, s23, 9
    s_add_u32 s3, s3, 30720
    v_lshl_add_u32 v16, v2, 4, s3
    s_waitcnt lgkmcnt(6)
    v_mfma_f32_32x32x16_bf16 v[168:183], v[232:235], v[24:27], v[168:183]
    ds_read_b64_tr_b16 v[224:225], v249 offset:43008
    ds_read_b64_tr_b16 v[226:227], v249 offset:43776
    v_mov_b32 v14, 163328
    v_mov_b32 v15, 1
    s_mul_i32 s3, s20, 1280
    s_add_u32 s3, s3, 20480
    v_add_u32 v17, s3, v0
    v_mfma_f32_32x32x16_bf16 v[184:199], v[236:239], v[24:27], v[184:199]
    ds_read_b64_tr_b16 v[228:229], v249 offset:43072
    ds_read_b64_tr_b16 v[230:231], v249 offset:43840
    v_lshlrev_b32 v19, 2, v2
    v_lshl_add_u32 v19, v3, 31, v19
    v_mfma_f32_32x32x16_bf16 v[200:215], v[240:243], v[24:27], v[200:215]
    ds_read_b64_tr_b16 v[232:233], v249 offset:43136
    ds_read_b64_tr_b16 v[234:235], v249 offset:43904
    s_waitcnt lgkmcnt(6)
    v_mfma_f32_32x32x16_bf16 v[168:183], v[244:247], v[28:31], v[168:183]
    ds_read_b64_tr_b16 v[236:237], v249 offset:46080
    ds_read_b64_tr_b16 v[238:239], v249 offset:46848
    v_mfma_f32_32x32x16_bf16 v[184:199], v[216:219], v[28:31], v[184:199]
    ds_read_b64_tr_b16 v[240:241], v249 offset:46144
    ds_read_b64_tr_b16 v[242:243], v249 offset:46912
    v_mfma_f32_32x32x16_bf16 v[200:215], v[220:223], v[28:31], v[200:215]
    ds_read_b64_tr_b16 v[244:245], v249 offset:46208
    ds_read_b64_tr_b16 v[246:247], v249 offset:46976
    s_waitcnt lgkmcnt(6)
    v_mfma_f32_32x32x16_bf16 v[168:183], v[224:227], v[32:35], v[168:183]
    s_mov_b64 exec, 1
    ds_add_u32 v14, v15 offset:16
    s_mov_b64 exec, -1
    ds_read_b64_tr_b16 v[216:217], v249 offset:24576
    ds_read_b64_tr_b16 v[218:219], v249 offset:25344
    v_mfma_f32_32x32x16_bf16 v[184:199], v[228:231], v[32:35], v[184:199]
    ds_read_b64_tr_b16 v[220:221], v249 offset:24640
    ds_read_b64_tr_b16 v[222:223], v249 offset:25408
    v_mfma_f32_32x32x16_bf16 v[200:215], v[232:235], v[32:35], v[200:215]
    ds_read_b64_tr_b16 v[224:225], v249 offset:24704
    ds_read_b64_tr_b16 v[226:227], v249 offset:25472
    s_waitcnt lgkmcnt(7)
    v_mfma_f32_32x32x16_bf16 v[168:183], v[236:239], v[36:39], v[168:183]
    ds_read_b64_tr_b16 v[228:229], v249 offset:27648
    ds_read_b64_tr_b16 v[230:231], v249 offset:28416
    v_mfma_f32_32x32x16_bf16 v[184:199], v[240:243], v[36:39], v[184:199]
    ds_read_b64_tr_b16 v[232:233], v249 offset:27712
    ds_read_b64_tr_b16 v[234:235], v249 offset:28480
    v_mfma_f32_32x32x16_bf16 v[200:215], v[244:247], v[36:39], v[200:215]
    ds_read_b64_tr_b16 v[236:237], v249 offset:27776
    ds_read_b64_tr_b16 v[238:239], v249 offset:28544
    s_waitcnt lgkmcnt(6)
    v_mfma_f32_32x32x16_bf16 v[168:183], v[216:219], v[40:43], v[168:183]
    ds_read_b64_tr_b16 v[240:241], v249 offset:30720
    ds_read_b64_tr_b16 v[242:243], v249 offset:31488
    v_mfma_f32_32x32x16_bf16 v[184:199], v[220:223], v[40:43], v[184:199]
    ds_read_b32 v18, v14 offset:16
    ds_read_b64_tr_b16 v[244:245], v249 offset:30784
    ds_read_b64_tr_b16 v[246:247], v249 offset:31552
    v_mfma_f32_32x32x16_bf16 v[200:215], v[224:227], v[40:43], v[200:215]
    ds_read_b64_tr_b16 v[216:217], v249 offset:30848
    ds_read_b64_tr_b16 v[218:219], v249 offset:31616
    s_waitcnt lgkmcnt(7)
    v_mfma_f32_32x32x16_bf16 v[168:183], v[228:231], v[44:47], v[168:183]
    ds_read_b64_tr_b16 v[220:221], v249 offset:33792
    ds_read_b64_tr_b16 v[222:223], v249 offset:34560
    ds_read_b64_tr_b16 v[20:21], v11 offset:49152
    v_mfma_f32_32x32x16_bf16 v[184:199], v[232:235], v[44:47], v[184:199]
    ds_read_b64_tr_b16 v[224:225], v249 offset:33856
    ds_read_b64_tr_b16 v[226:227], v249 offset:34624
    ds_read_b64_tr_b16 v[22:23], v11 offset:49920
    v_mfma_f32_32x32x16_bf16 v[200:215], v[236:239], v[44:47], v[200:215]
    ds_read_b64_tr_b16 v[228:229], v249 offset:33920
    ds_read_b64_tr_b16 v[230:231], v249 offset:34688
    ds_read_b64_tr_b16 v[24:25], v11 offset:49216
    s_waitcnt lgkmcnt(13)
    v_cmp_gt_u32 vcc, 4, v18
    s_waitcnt lgkmcnt(9)
    v_mfma_f32_32x32x16_bf16 v[168:183], v[240:243], v[48:51], v[168:183]
    s_cbranch_vccnz L_cs16
L_cd16:
    ds_read_b64_tr_b16 v[232:233], v249 offset:12288
    ds_read_b64_tr_b16 v[234:235], v249 offset:13056
    ds_read_b64_tr_b16 v[26:27], v11 offset:49984
    v_mfma_f32_32x32x16_bf16 v[184:199], v[244:247], v[48:51], v[184:199]
    ds_read_b64_tr_b16 v[236:237], v249 offset:12352
    ds_read_b64_tr_b16 v[238:239], v249 offset:13120
    ds_read_b64_tr_b16 v[28:29], v11 offset:49280
    v_mfma_f32_32x32x16_bf16 v[200:215], v[216:219], v[48:51], v[200:215]
    ds_read_b64_tr_b16 v[240:241], v249 offset:12416
    ds_read_b64_tr_b16 v[242:243], v249 offset:13184
    ds_read_b64_tr_b16 v[30:31], v11 offset:50048
    s_waitcnt lgkmcnt(10)
    v_mfma_f32_32x32x16_bf16 v[168:183], v[220:223], v[52:55], v[168:183]
    ds_read_b64_tr_b16 v[244:245], v249 offset:15360
    ds_read_b64_tr_b16 v[246:247], v249 offset:16128
    ds_read_b64_tr_b16 v[32:33], v11 offset:36864
    v_mfma_f32_32x32x16_bf16 v[184:199], v[224:227], v[52:55], v[184:199]
    ds_read_b64_tr_b16 v[216:217], v249 offset:15424
    ds_read_b64_tr_b16 v[218:219], v249 offset:16192
    ds_read_b64_tr_b16 v[34:35], v11 offset:37632
    v_mfma_f32_32x32x16_bf16 v[200:215], v[228:231], v[52:55], v[200:215]
    ds_read_b64_tr_b16 v[220:221], v249 offset:15488
    ds_read_b64_tr_b16 v[222:223], v249 offset:16256
    ds_read_b64_tr_b16 v[36:37], v11 offset:36928
    s_waitcnt lgkmcnt(10)
    v_mfma_f32_32x32x16_bf16 v[168:183], v[232:235], v[56:59], v[168:183]
    ds_read_b64_tr_b16 v[224:225], v249 offset:18432
    ds_read_b64_tr_b16 v[226:227], v249 offset:19200
    ds_read_b64_tr_b16 v[38:39], v11 offset:37696
    v_mfma_f32_32x32x16_bf16 v[184:199], v[236:239], v[56:59], v[184:199]
    ds_read_b64_tr_b16 v[228:229], v249 offset:18496
    ds_read_b64_tr_b16 v[230:231], v249 offset:19264
    ds_read_b64_tr_b16 v[40:41], v11 offset:36992
    v_mfma_f32_32x32x16_bf16 v[200:215], v[240:243], v[56:59], v[200:215]
    ds_read_b64_tr_b16 v[232:233], v249 offset:18560
    ds_read_b64_tr_b16 v[234:235], v249 offset:19328
    ds_read_b64_tr_b16 v[42:43], v11 offset:37760
    s_waitcnt lgkmcnt(10)
    v_mfma_f32_32x32x16_bf16 v[168:183], v[244:247], v[60:63], v[168:183]
    ds_read_b64_tr_b16 v[236:237], v249 offset:21504
    ds_read_b64_tr_b16 v[238:239], v249 offset:22272
    v_mfma_f32_32x32x16_bf16 v[184:199], v[216:219], v[60:63], v[184:199]
    ds_read_b64_tr_b16 v[240:241], v249 offset:21568
    ds_read_b64_tr_b16 v[242:243], v249 offset:22336
    s_waitcnt lgkmcnt(4)
    v_mfma_f32_4x4x4_16b_bf16 v[44:47], v[8:9], v[20:21], 0
    v_mfma_f32_4x4x4_16b_bf16 v[48:51], v[8:9], v[24:25], 0
    v_mfma_f32_4x4x4_16b_bf16 v[52:55], v[8:9], v[28:29], 0
    v_mfma_f32_4x4x4_16b_bf16 v[44:47], v[8:9], v[22:23], v[44:47]
    v_mfma_f32_4x4x4_16b_bf16 v[48:51], v[8:9], v[26:27], v[48:51]
    v_mfma_f32_4x4x4_16b_bf16 v[52:55], v[8:9], v[30:31], v[52:55]
    v_mfma_f32_4x4x4_16b_bf16 v[44:47], v[8:9], v[32:33], v[44:47]
    v_mfma_f32_4x4x4_16b_bf16 v[48:51], v[8:9], v[36:37], v[48:51]
    v_mfma_f32_4x4x4_16b_bf16 v[52:55], v[8:9], v[40:41], v[52:55]
    v_mfma_f32_4x4x4_16b_bf16 v[44:47], v[8:9], v[34:35], v[44:47]
    v_mfma_f32_4x4x4_16b_bf16 v[48:51], v[8:9], v[38:39], v[48:51]
    v_mfma_f32_4x4x4_16b_bf16 v[52:55], v[8:9], v[42:43], v[52:55]
    v_mfma_f32_32x32x16_bf16 v[200:215], v[220:223], v[60:63], v[200:215]
    ds_read_b64_tr_b16 v[244:245], v249 offset:21632
    ds_read_b64_tr_b16 v[246:247], v249 offset:22400
    ds_read_b64_tr_b16 v[20:21], v11 offset:24576
    v_mfma_f32_32x32x16_bf16 v[168:183], v[224:227], v[64:67], v[168:183]
    ds_read_b64_tr_b16 v[216:217], v248 offset:12288
    ds_read_b64_tr_b16 v[218:219], v248 offset:13056
    ds_read_b64_tr_b16 v[22:23], v11 offset:25344
    v_mfma_f32_32x32x16_bf16 v[184:199], v[228:231], v[64:67], v[184:199]
    ds_read_b64_tr_b16 v[220:221], v248 offset:12352
    ds_read_b64_tr_b16 v[222:223], v248 offset:13120
    ds_read_b64_tr_b16 v[24:25], v11 offset:24640
    v_mfma_f32_32x32x16_bf16 v[200:215], v[232:235], v[64:67], v[200:215]
    s_waitcnt vmcnt(0)
    s_mov_b64 exec, 1
    ds_add_u32 v14, v15 offset:4
    s_mov_b64 exec, -1
    ds_read_b64_tr_b16 v[224:225], v248 offset:12416
    ds_read_b64_tr_b16 v[226:227], v248 offset:13184
    ds_read_b64_tr_b16 v[26:27], v11 offset:25408
    s_waitcnt lgkmcnt(11)
    v_mfma_f32_32x32x16_bf16 v[168:183], v[236:239], v[68:71], v[168:183]
    ds_read_b64_tr_b16 v[228:229], v248 offset:15360
    ds_read_b64_tr_b16 v[230:231], v248 offset:16128
    ds_read_b64_tr_b16 v[28:29], v11 offset:24704
    v_mfma_f32_32x32x16_bf16 v[184:199], v[240:243], v[68:71], v[184:199]
    ds_read_b64_tr_b16 v[232:233], v248 offset:15424
    ds_read_b64_tr_b16 v[234:235], v248 offset:16192
    ds_read_b64_tr_b16 v[30:31], v11 offset:25472
    v_mfma_f32_32x32x16_bf16 v[200:215], v[244:247], v[68:71], v[200:215]
    ds_read_b64_tr_b16 v[236:237], v248 offset:15488
    ds_read_b64_tr_b16 v[238:239], v248 offset:16256
    ds_read_b64_tr_b16 v[32:33], v11 offset:12288
    s_waitcnt lgkmcnt(10)
    v_mfma_f32_32x32x16_bf16 v[168:183], v[216:219], v[72:75], v[168:183]
    ds_read_b64_tr_b16 v[240:241], v248 offset:18432
    ds_read_b64_tr_b16 v[242:243], v248 offset:19200
    ds_read_b64_tr_b16 v[34:35], v11 offset:13056
    v_mfma_f32_32x32x16_bf16 v[184:199], v[220:223], v[72:75], v[184:199]
    ds_read_b32 v18, v14 offset:4
    ds_read_b64_tr_b16 v[244:245], v248 offset:18496
    ds_read_b64_tr_b16 v[246:247], v248 offset:19264
    ds_read_b64_tr_b16 v[36:37], v11 offset:12352
    v_mfma_f32_32x32x16_bf16 v[200:215], v[224:227], v[72:75], v[200:215]
    ds_read_b64_tr_b16 v[216:217], v248 offset:18560
    ds_read_b64_tr_b16 v[218:219], v248 offset:19328
    ds_read_b64_tr_b16 v[38:39], v11 offset:13120
    s_waitcnt lgkmcnt(11)
    v_mfma_f32_32x32x16_bf16 v[168:183], v[228:231], v[76:79], v[168:183]
    ds_read_b64_tr_b16 v[220:221], v248 offset:21504
    ds_read_b64_tr_b16 v[222:223], v248 offset:22272
    ds_read_b64_tr_b16 v[40:41], v11 offset:12416
    v_mfma_f32_32x32x16_bf16 v[184:199], v[232:235], v[76:79], v[184:199]
    ds_read_b64_tr_b16 v[224:225], v248 offset:21568
    ds_read_b64_tr_b16 v[226:227], v248 offset:22336
    ds_read_b64_tr_b16 v[42:43], v11 offset:13184
    v_mfma_f32_32x32x16_bf16 v[200:215], v[236:239], v[76:79], v[200:215]
    ds_read_b64_tr_b16 v[228:229], v248 offset:21632
    ds_read_b64_tr_b16 v[230:231], v248 offset:22400
    s_waitcnt lgkmcnt(14)
    v_cmp_gt_u32 vcc, 4, v18
    s_waitcnt lgkmcnt(9)
    v_mfma_f32_32x32x16_bf16 v[168:183], v[240:243], v[80:83], v[168:183]
    s_cbranch_vccnz L_cs4
L_cd4:
    ds_read_b64_tr_b16 v[232:233], v248 offset:0
    ds_read_b64_tr_b16 v[234:235], v248 offset:768
    s_waitcnt lgkmcnt(4)
    v_mfma_f32_4x4x4_16b_bf16 v[44:47], v[8:9], v[20:21], v[44:47]
    v_mfma_f32_4x4x4_16b_bf16 v[48:51], v[8:9], v[24:25], v[48:51]
    v_mfma_f32_4x4x4_16b_bf16 v[52:55], v[8:9], v[28:29], v[52:55]
    v_mfma_f32_4x4x4_16b_bf16 v[44:47], v[8:9], v[22:23], v[44:47]
    v_mfma_f32_4x4x4_16b_bf16 v[48:51], v[8:9], v[26:27], v[48:51]
    v_mfma_f32_4x4x4_16b_bf16 v[52:55], v[8:9], v[30:31], v[52:55]
    v_mfma_f32_4x4x4_16b_bf16 v[44:47], v[8:9], v[32:33], v[44:47]
    v_mfma_f32_4x4x4_16b_bf16 v[48:51], v[8:9], v[36:37], v[48:51]
    v_mfma_f32_4x4x4_16b_bf16 v[52:55], v[8:9], v[40:41], v[52:55]
    v_mfma_f32_4x4x4_16b_bf16 v[44:47], v[8:9], v[34:35], v[44:47]
    v_mfma_f32_4x4x4_16b_bf16 v[48:51], v[8:9], v[38:39], v[48:51]
    v_mfma_f32_4x4x4_16b_bf16 v[52:55], v[8:9], v[42:43], v[52:55]
    v_mfma_f32_32x32x16_bf16 v[184:199], v[244:247], v[80:83], v[184:199]
    ds_read_b64_tr_b16 v[236:237], v248 offset:64
    ds_read_b64_tr_b16 v[238:239], v248 offset:832
    ds_read_b64_tr_b16 v[20:21], v10 offset:12288
    v_mfma_f32_32x32x16_bf16 v[200:215], v[216:219], v[80:83], v[200:215]
    ds_read_b64_tr_b16 v[240:241], v248 offset:128
    ds_read_b64_tr_b16 v[242:243], v248 offset:896
    ds_read_b64_tr_b16 v[22:23], v10 offset:13056
    v_mov_b32 v57, v253
    v_mov_b32 v59, v254
    s_waitcnt lgkmcnt(8)
    v_mfma_f32_32x32x16_bf16 v[168:183], v[220:223], v[84:87], v[168:183]
    ds_read_b32 v18, v14 offset:8
    ds_read_b64_tr_b16 v[244:245], v248 offset:3072
    ds_read_b64_tr_b16 v[246:247], v248 offset:3840
    ds_read_b64_tr_b16 v[24:25], v10 offset:12352
    v_mov_b32 v61, v255
    v_mfma_f32_32x32x16_bf16 v[184:199], v[224:227], v[84:87], v[184:199]
    ds_read_b64_tr_b16 v[216:217], v248 offset:3136
    ds_read_b64_tr_b16 v[218:219], v248 offset:3904
    ds_read_b64_tr_b16 v[26:27], v10 offset:13120
    v_mfma_f32_32x32x16_bf16 v[200:215], v[228:231], v[84:87], v[200:215]
    ds_read_b64_tr_b16 v[220:221], v248 offset:3200
    ds_read_b64_tr_b16 v[222:223], v248 offset:3968
    ds_read_b64_tr_b16 v[28:29], v10 offset:12416
    s_waitcnt lgkmcnt(11)
    v_mfma_f32_32x32x16_bf16 v[168:183], v[232:235], v[88:91], v[168:183]
    ds_read_b64_tr_b16 v[224:225], v248 offset:6144
    ds_read_b64_tr_b16 v[226:227], v248 offset:6912
    ds_read_b64_tr_b16 v[30:31], v10 offset:13184
    v_mfma_f32_32x32x16_bf16 v[184:199], v[236:239], v[88:91], v[184:199]
    ds_read_b64_tr_b16 v[228:229], v248 offset:6208
    ds_read_b64_tr_b16 v[230:231], v248 offset:6976
    ds_read_b64_tr_b16 v[32:33], v10 offset:0
    s_waitcnt lgkmcnt(15)
    v_cmp_gt_u32 vcc, 4, v18
    v_mfma_f32_32x32x16_bf16 v[200:215], v[240:243], v[88:91], v[200:215]
    s_cbranch_vccnz L_cs8
L_cd8:
    ds_read_b64_tr_b16 v[232:233], v248 offset:6272
    ds_read_b64_tr_b16 v[234:235], v248 offset:7040
    ds_read_b64_tr_b16 v[34:35], v10 offset:768
    ds_read_b64_tr_b16 v[64:65], v11 offset:0
    s_waitcnt lgkmcnt(11)
    v_mfma_f32_32x32x16_bf16 v[168:183], v[244:247], v[92:95], v[168:183]
    ds_read_b64_tr_b16 v[236:237], v248 offset:9216
    ds_read_b64_tr_b16 v[238:239], v248 offset:9984
    ds_read_b64_tr_b16 v[36:37], v10 offset:64
    ds_read_b64_tr_b16 v[66:67], v11 offset:768
    v_mfma_f32_32x32x16_bf16 v[184:199], v[216:219], v[92:95], v[184:199]
    ds_read_b64_tr_b16 v[240:241], v248 offset:9280
    ds_read_b64_tr_b16 v[242:243], v248 offset:10048
    ds_read_b64_tr_b16 v[38:39], v10 offset:832
    ds_read_b64_tr_b16 v[68:69], v11 offset:64
    v_mfma_f32_32x32x16_bf16 v[200:215], v[220:223], v[92:95], v[200:215]
    ds_read_b64_tr_b16 v[244:245], v248 offset:9344
    ds_read_b64_tr_b16 v[246:247], v248 offset:10112
    ds_read_b64_tr_b16 v[40:41], v10 offset:128
    ds_read_b64_tr_b16 v[70:71], v11 offset:832
    s_waitcnt lgkmcnt(14)
    v_mfma_f32_32x32x16_bf16 v[168:183], v[224:227], v[96:99], v[168:183]
    ds_read_b64_tr_b16 v[216:217], v249 offset:0
    ds_read_b64_tr_b16 v[218:219], v249 offset:768
    ds_read_b64_tr_b16 v[42:43], v10 offset:896
    ds_read_b64_tr_b16 v[72:73], v11 offset:128
    v_mfma_f32_32x32x16_bf16 v[184:199], v[228:231], v[96:99], v[184:199]
    ds_read_b64_tr_b16 v[220:221], v249 offset:64
    ds_read_b64_tr_b16 v[222:223], v249 offset:832
    ds_read_b64_tr_b16 v[74:75], v11 offset:896
    v_mfma_f32_32x32x16_bf16 v[200:215], v[232:235], v[96:99], v[200:215]
    ds_read_b64_tr_b16 v[224:225], v249 offset:128
    ds_read_b64_tr_b16 v[226:227], v249 offset:896
    ds_read_b64_tr_b16 v[76:77], v10 offset:49152
    s_waitcnt lgkmcnt(7)
    v_mfma_f32_4x4x4_16b_bf16 v[44:47], v[8:9], v[20:21], v[44:47]
    v_mfma_f32_4x4x4_16b_bf16 v[48:51], v[8:9], v[24:25], v[48:51]
    v_mfma_f32_4x4x4_16b_bf16 v[52:55], v[8:9], v[28:29], v[52:55]
    v_mfma_f32_4x4x4_16b_bf16 v[44:47], v[8:9], v[22:23], v[44:47]
    v_mfma_f32_4x4x4_16b_bf16 v[48:51], v[8:9], v[26:27], v[48:51]
    v_mfma_f32_4x4x4_16b_bf16 v[52:55], v[8:9], v[30:31], v[52:55]
    v_mfma_f32_4x4x4_16b_bf16 v[44:47], v[8:9], v[32:33], v[44:47]
    v_mfma_f32_4x4x4_16b_bf16 v[48:51], v[8:9], v[36:37], v[48:51]
    v_mfma_f32_4x4x4_16b_bf16 v[52:55], v[8:9], v[40:41], v[52:55]
    v_mfma_f32_4x4x4_16b_bf16 v[44:47], v[8:9], v[34:35], v[44:47]
    v_mfma_f32_4x4x4_16b_bf16 v[48:51], v[8:9], v[38:39], v[48:51]
    v_mfma_f32_4x4x4_16b_bf16 v[52:55], v[8:9], v[42:43], v[52:55]
    v_mfma_f32_32x32x16_bf16 v[168:183], v[236:239], v[100:103], v[168:183]
    ds_read_b64_tr_b16 v[228:229], v249 offset:3072
    ds_read_b64_tr_b16 v[230:231], v249 offset:3840
    ds_read_b64_tr_b16 v[78:79], v10 offset:49920
    ds_read_b64_tr_b16 v[20:21], v10 offset:36864
    v_mfma_f32_32x32x16_bf16 v[184:199], v[240:243], v[100:103], v[184:199]
    ds_read_b64_tr_b16 v[232:233], v249 offset:3136
    ds_read_b64_tr_b16 v[234:235], v249 offset:3904
    ds_read_b64_tr_b16 v[80:81], v10 offset:49216
    ds_read_b64_tr_b16 v[22:23], v10 offset:37632
    v_mfma_f32_32x32x16_bf16 v[200:215], v[244:247], v[100:103], v[200:215]
    ds_read_b64_tr_b16 v[236:237], v249 offset:3200
    ds_read_b64_tr_b16 v[238:239], v249 offset:3968
    ds_read_b64_tr_b16 v[82:83], v10 offset:49984
    ds_read_b64_tr_b16 v[24:25], v10 offset:36928
    s_waitcnt lgkmcnt(13)
    v_mfma_f32_32x32x16_bf16 v[168:183], v[216:219], v[104:107], v[168:183]
    ds_read_b64_tr_b16 v[240:241], v249 offset:6144
    ds_read_b64_tr_b16 v[242:243], v249 offset:6912
    ds_read_b64_tr_b16 v[84:85], v10 offset:49280
    ds_read_b64_tr_b16 v[26:27], v10 offset:37696
    v_mfma_f32_32x32x16_bf16 v[184:199], v[220:223], v[104:107], v[184:199]
    ds_read_b64_tr_b16 v[244:245], v249 offset:6208
    ds_read_b64_tr_b16 v[246:247], v249 offset:6976
    ds_read_b64_tr_b16 v[86:87], v10 offset:50048
    ds_read_b64_tr_b16 v[28:29], v10 offset:36992
    v_mfma_f32_32x32x16_bf16 v[200:215], v[224:227], v[104:107], v[200:215]
    ds_read_b64_tr_b16 v[216:217], v249 offset:6272
    ds_read_b64_tr_b16 v[218:219], v249 offset:7040
    ds_read_b64_tr_b16 v[30:31], v10 offset:37760
    s_waitcnt lgkmcnt(13)
    v_mfma_f32_32x32x16_bf16 v[168:183], v[228:231], v[108:111], v[168:183]
    ds_read_b64_tr_b16 v[220:221], v249 offset:9216
    ds_read_b64_tr_b16 v[222:223], v249 offset:9984
    ds_read_b64_tr_b16 v[32:33], v10 offset:24576
    v_mfma_f32_32x32x16_bf16 v[184:199], v[232:235], v[108:111], v[184:199]
    ds_read_b64_tr_b16 v[224:225], v249 offset:9280
    ds_read_b64_tr_b16 v[226:227], v249 offset:10048
    ds_read_b64_tr_b16 v[34:35], v10 offset:25344
    v_mfma_f32_32x32x16_bf16 v[200:215], v[236:239], v[108:111], v[200:215]
    ds_read_b64_tr_b16 v[228:229], v249 offset:9344
    ds_read_b64_tr_b16 v[230:231], v249 offset:10112
    ds_read_b64_tr_b16 v[36:37], v10 offset:24640
    s_waitcnt lgkmcnt(10)
    v_mfma_f32_32x32x16_bf16 v[168:183], v[240:243], v[112:115], v[168:183]
    ds_read_b64_tr_b16 v[232:233], v248 offset:49152
    ds_read_b64_tr_b16 v[234:235], v248 offset:49920
    ds_read_b64_tr_b16 v[38:39], v10 offset:25408
    v_mfma_f32_32x32x16_bf16 v[184:199], v[244:247], v[112:115], v[184:199]
    ds_read_b64_tr_b16 v[236:237], v248 offset:52224
    ds_read_b64_tr_b16 v[238:239], v248 offset:52992
    ds_read_b64_tr_b16 v[40:41], v10 offset:24704
    v_mfma_f32_32x32x16_bf16 v[200:215], v[216:219], v[112:115], v[200:215]
    ds_read_b64_tr_b16 v[240:241], v248 offset:55296
    ds_read_b64_tr_b16 v[242:243], v248 offset:56064
    ds_read_b64_tr_b16 v[42:43], v10 offset:25472
    s_waitcnt lgkmcnt(10)
    v_mfma_f32_32x32x16_bf16 v[168:183], v[220:223], v[116:119], v[168:183]
    ds_read_b64_tr_b16 v[244:245], v248 offset:58368
    ds_read_b64_tr_b16 v[246:247], v248 offset:59136
    v_mfma_f32_32x32x16_bf16 v[184:199], v[224:227], v[116:119], v[184:199]
    ds_read_b64_tr_b16 v[216:217], v248 offset:36864
    ds_read_b64_tr_b16 v[218:219], v248 offset:37632
    s_waitcnt lgkmcnt(4)
    v_mfma_f32_4x4x4_16b_bf16 v[44:47], v[8:9], v[64:65], v[44:47]
    v_mfma_f32_4x4x4_16b_bf16 v[48:51], v[8:9], v[68:69], v[48:51]
    v_mfma_f32_4x4x4_16b_bf16 v[52:55], v[8:9], v[72:73], v[52:55]
    v_mfma_f32_4x4x4_16b_bf16 v[44:47], v[8:9], v[66:67], v[44:47]
    v_mfma_f32_4x4x4_16b_bf16 v[48:51], v[8:9], v[70:71], v[48:51]
    v_mfma_f32_4x4x4_16b_bf16 v[52:55], v[8:9], v[74:75], v[52:55]
    v_mfma_f32_4x4x4_16b_bf16 v[44:47], v[8:9], v[76:77], v[44:47]
    v_mfma_f32_4x4x4_16b_bf16 v[48:51], v[8:9], v[80:81], v[48:51]
    v_mfma_f32_4x4x4_16b_bf16 v[52:55], v[8:9], v[84:85], v[52:55]
    v_mfma_f32_4x4x4_16b_bf16 v[44:47], v[8:9], v[78:79], v[44:47]
    v_mfma_f32_4x4x4_16b_bf16 v[48:51], v[8:9], v[82:83], v[48:51]
    v_mfma_f32_4x4x4_16b_bf16 v[52:55], v[8:9], v[86:87], v[52:55]
    v_mfma_f32_4x4x4_16b_bf16 v[44:47], v[8:9], v[20:21], v[44:47]
    v_mfma_f32_4x4x4_16b_bf16 v[48:51], v[8:9], v[24:25], v[48:51]
    v_mfma_f32_4x4x4_16b_bf16 v[52:55], v[8:9], v[28:29], v[52:55]
    v_mfma_f32_4x4x4_16b_bf16 v[44:47], v[8:9], v[22:23], v[44:47]
    v_mfma_f32_4x4x4_16b_bf16 v[48:51], v[8:9], v[26:27], v[48:51]
    v_mfma_f32_4x4x4_16b_bf16 v[52:55], v[8:9], v[30:31], v[52:55]
    v_mfma_f32_4x4x4_16b_bf16 v[44:47], v[8:9], v[32:33], v[44:47]
    v_mfma_f32_4x4x4_16b_bf16 v[48:51], v[8:9], v[36:37], v[48:51]
    v_mfma_f32_4x4x4_16b_bf16 v[52:55], v[8:9], v[40:41], v[52:55]
    v_mfma_f32_4x4x4_16b_bf16 v[44:47], v[8:9], v[34:35], v[44:47]
    v_mfma_f32_4x4x4_16b_bf16 v[48:51], v[8:9], v[38:39], v[48:51]
    v_mfma_f32_4x4x4_16b_bf16 v[52:55], v[8:9], v[42:43], v[52:55]
    v_mfma_f32_32x32x16_bf16 v[200:215], v[228:231], v[116:119], v[200:215]
    ds_read_b64_tr_b16 v[220:221], v248 offset:39936
    ds_read_b64_tr_b16 v[222:223], v248 offset:40704
    v_mov_b32 v21, 0x3f803f80
    v_cmp_eq_u32 vcc, 20, v2
    s_nop 1
    v_cndmask_b32 v20, 0, v21, vcc
    v_mfma_f32_32x32x16_bf16 v[168:183], v[232:235], v[120:123], v[168:183]
    ds_read_b64_tr_b16 v[224:225], v248 offset:43008
    ds_read_b64_tr_b16 v[226:227], v248 offset:43776
    v_mov_b32 v21, v20
    v_mov_b32 v22, v20
    v_mov_b32 v23, v20
    ds_write_b32 v12, v44 offset:0
    ds_write_b32 v12, v48 offset:1024
    ds_write_b32 v12, v52 offset:2048
    s_mov_b64 exec, 1
    ds_add_u32 v14, v15 offset:12
    s_mov_b64 exec, -1
    v_mfma_f32_32x32x16_bf16 v[168:183], v[236:239], v[124:127], v[168:183]
    ds_read_b64_tr_b16 v[228:229], v248 offset:46080
    ds_read_b64_tr_b16 v[230:231], v248 offset:46848
    v_mov_b32 v24, v20
    v_mov_b32 v25, v20
    v_mov_b32 v26, v20
    v_mfma_f32_32x32x16_bf16 v[168:183], v[240:243], v[128:131], v[168:183]
    ds_read_b64_tr_b16 v[232:233], v248 offset:24576
    ds_read_b64_tr_b16 v[234:235], v248 offset:25344
    v_mov_b32 v27, v20
    v_mov_b32 v28, v20
    v_mov_b32 v29, v20
    s_waitcnt lgkmcnt(10)
    v_mfma_f32_32x32x16_bf16 v[168:183], v[244:247], v[132:135], v[168:183]
    ds_read_b32 v18, v14 offset:12
    ds_read_b64_tr_b16 v[236:237], v248 offset:27648
    ds_read_b64_tr_b16 v[238:239], v248 offset:28416
    v_mov_b32 v30, v20
    v_mov_b32 v31, v20
    v_mfma_f32_32x32x16_bf16 v[168:183], v[216:219], v[136:139], v[168:183]
    ds_read_b64_tr_b16 v[240:241], v248 offset:30720
    ds_read_b64_tr_b16 v[242:243], v248 offset:31488
    v_mov_b32 v32, v20
    v_mov_b32 v33, v20
    v_mov_b32 v34, v20
    v_mfma_f32_32x32x16_bf16 v[168:183], v[220:223], v[140:143], v[168:183]
    ds_read_b64_tr_b16 v[244:245], v248 offset:33792
    ds_read_b64_tr_b16 v[246:247], v248 offset:34560
    v_mov_b32 v35, v20
    v_mov_b32 v36, v20
    v_mov_b32 v37, v20
    s_waitcnt lgkmcnt(7)
    v_mfma_f32_32x32x16_bf16 v[168:183], v[224:227], v[144:147], v[168:183]
    ds_read_b64_tr_b16 v[216:217], v248 offset:49216
    ds_read_b64_tr_b16 v[218:219], v248 offset:49984
    v_mov_b32 v38, v20
    v_mov_b32 v39, v20
    v_and_b32 v118, 3, v1
    v_mfma_f32_32x32x16_bf16 v[168:183], v[228:231], v[148:151], v[168:183]
    ds_read_b64_tr_b16 v[220:221], v248 offset:52288
    ds_read_b64_tr_b16 v[222:223], v248 offset:53056
    v_lshlrev_b32 v118, 7, v118
    s_xor_b32 s3, s22, 1
    s_lshl_b32 s3, s3, 31
    v_mov_b32 v116, s3
    s_waitcnt lgkmcnt(10)
    v_cmp_gt_u32 vcc, 4, v18
    v_mfma_f32_32x32x16_bf16 v[168:183], v[232:235], v[152:155], v[168:183]
    s_cbranch_vccnz L_cs12
L_cd12:
    ds_read_b128 v[84:87], v16
    ds_read_b128 v[72:75], v13 offset:0
    ds_read_b128 v[76:79], v13 offset:1024
    ds_read_b128 v[80:83], v13 offset:2048
    ds_read_b64_tr_b16 v[224:225], v248 offset:55360
    ds_read_b64_tr_b16 v[226:227], v248 offset:56128
    s_waitcnt lgkmcnt(10)
    v_mfma_f32_32x32x16_bf16 v[168:183], v[236:239], v[156:159], v[168:183]
    ds_read_b64_tr_b16 v[228:229], v248 offset:58432
    ds_read_b64_tr_b16 v[230:231], v248 offset:59200
    v_mov_b32 v119, s6
    v_mfma_f32_32x32x16_bf16 v[168:183], v[240:243], v[160:163], v[168:183]
    ds_read_b64_tr_b16 v[232:233], v248 offset:36928
    ds_read_b64_tr_b16 v[234:235], v248 offset:37696
    v_mfma_f32_32x32x16_bf16 v[168:183], v[244:247], v[164:167], v[168:183]
    ds_read_b64_tr_b16 v[236:237], v248 offset:40000
    ds_read_b64_tr_b16 v[238:239], v248 offset:40768
    s_waitcnt lgkmcnt(6)
    v_mfma_f32_32x32x16_bf16 v[184:199], v[216:219], v[120:123], v[184:199]
    ds_read_b64_tr_b16 v[240:241], v248 offset:43072
    ds_read_b64_tr_b16 v[242:243], v248 offset:43840
    v_add_f32 v72, v72, v73
    v_add_f32 v74, v74, v75
    v_add_f32 v72, v72, v74
    v_and_b32 v73, 0xffff0000, v72
    v_mfma_f32_32x32x16_bf16 v[184:199], v[220:223], v[124:127], v[184:199]
    ds_read_b64_tr_b16 v[244:245], v248 offset:46144
    ds_read_b64_tr_b16 v[246:247], v248 offset:46912
    v_sub_f32 v72, v72, v73
    v_cvt_pk_bf16_f32 v56, v73, v72
    v_add_f32 v76, v76, v77
    v_add_f32 v78, v78, v79
    v_mfma_f32_32x32x16_bf16 v[184:199], v[224:227], v[128:131], v[184:199]
    ds_read_b64_tr_b16 v[216:217], v248 offset:24640
    ds_read_b64_tr_b16 v[218:219], v248 offset:25408
    v_mfma_f32_32x32x8_bf16 v[168:183], v[56:57], v[84:85], v[168:183]
    v_add_f32 v76, v76, v78
    v_and_b32 v77, 0xffff0000, v76
    v_sub_f32 v76, v76, v77
    v_cvt_pk_bf16_f32 v58, v77, v76
    s_waitcnt lgkmcnt(6)
    v_mfma_f32_32x32x16_bf16 v[184:199], v[228:231], v[132:135], v[184:199]
    ds_read_b64_tr_b16 v[220:221], v248 offset:27712
    ds_read_b64_tr_b16 v[222:223], v248 offset:28480
    v_add_f32 v80, v80, v81
    v_add_f32 v82, v82, v83
    v_mfma_f32_32x32x8_bf16 v[184:199], v[58:59], v[84:85], v[184:199]
    v_add_f32 v80, v80, v82
    v_and_b32 v81, 0xffff0000, v80
    v_sub_f32 v80, v80, v81
    v_cvt_pk_bf16_f32 v60, v81, v80
    v_mfma_f32_32x32x16_bf16 v[184:199], v[232:235], v[136:139], v[184:199]
    ds_read_b64_tr_b16 v[224:225], v248 offset:30784
    ds_read_b64_tr_b16 v[226:227], v248 offset:31552
    buffer_store_dword v86, v19, s[28:31], s97 offen sc1
    v_mul_f32 v168, v168, |v168|
    v_mul_f32 v169, v169, |v169|
    v_mfma_f32_32x32x8_bf16 v[200:215], v[60:61], v[84:85], v[200:215]
    v_cvt_pk_bf16_f32 v168, v168, v169
    v_pk_max_i16 v168, v168, 0
    v_mul_f32 v170, v170, |v170|
    v_mul_f32 v171, v171, |v171|
    v_mfma_f32_32x32x16_bf16 v[184:199], v[236:239], v[140:143], v[184:199]
    ds_read_b64_tr_b16 v[228:229], v248 offset:33856
    ds_read_b64_tr_b16 v[230:231], v248 offset:34624
    v_cvt_pk_bf16_f32 v169, v170, v171
    v_pk_max_i16 v169, v169, 0
    v_mul_f32 v172, v172, |v172|
    v_mul_f32 v173, v173, |v173|
    s_waitcnt lgkmcnt(6)
    v_mfma_f32_32x32x16_bf16 v[184:199], v[240:243], v[144:147], v[184:199]
    ds_read_b64_tr_b16 v[232:233], v248 offset:49280
    ds_read_b64_tr_b16 v[234:235], v248 offset:50048
    v_cvt_pk_bf16_f32 v170, v172, v173
    v_pk_max_i16 v170, v170, 0
    v_mul_f32 v174, v174, |v174|
    v_mul_f32 v175, v175, |v175|
    v_mfma_f32_32x32x16_bf16 v[184:199], v[244:247], v[148:151], v[184:199]
    ds_read_b64_tr_b16 v[236:237], v248 offset:52352
    ds_read_b64_tr_b16 v[238:239], v248 offset:53120
    v_cvt_pk_bf16_f32 v171, v174, v175
    v_pk_max_i16 v171, v171, 0
    buffer_store_dwordx4 v[168:171], v0, s[28:31], s96 offen offset:0 sc1
    v_mul_f32 v176, v176, |v176|
    v_mfma_f32_32x32x16_bf16 v[184:199], v[216:219], v[152:155], v[184:199]
    ds_read_b64_tr_b16 v[240:241], v248 offset:55424
    ds_read_b64_tr_b16 v[242:243], v248 offset:56192
    v_mul_f32 v177, v177, |v177|
    v_cvt_pk_bf16_f32 v172, v176, v177
    v_pk_max_i16 v172, v172, 0
    v_mul_f32 v178, v178, |v178|
    s_waitcnt lgkmcnt(6)
    v_mfma_f32_32x32x16_bf16 v[184:199], v[220:223], v[156:159], v[184:199]
    ds_read_b64_tr_b16 v[244:245], v248 offset:58496
    ds_read_b64_tr_b16 v[246:247], v248 offset:59264
    v_mul_f32 v179, v179, |v179|
    v_cvt_pk_bf16_f32 v173, v178, v179
    v_pk_max_i16 v173, v173, 0
    v_mul_f32 v180, v180, |v180|
    v_mfma_f32_32x32x16_bf16 v[184:199], v[224:227], v[160:163], v[184:199]
    ds_read_b64_tr_b16 v[216:217], v248 offset:36992
    ds_read_b64_tr_b16 v[218:219], v248 offset:37760
    v_mul_f32 v181, v181, |v181|
    v_cvt_pk_bf16_f32 v174, v180, v181
    v_pk_max_i16 v174, v174, 0
    v_mul_f32 v182, v182, |v182|
    v_mfma_f32_32x32x16_bf16 v[184:199], v[228:231], v[164:167], v[184:199]
    ds_read_b64_tr_b16 v[220:221], v248 offset:40064
    ds_read_b64_tr_b16 v[222:223], v248 offset:40832
    v_mul_f32 v183, v183, |v183|
    v_cvt_pk_bf16_f32 v175, v182, v183
    v_pk_max_i16 v175, v175, 0
    buffer_store_dwordx4 v[172:175], v0, s[28:31], s96 offen offset:1024 sc1
    s_waitcnt lgkmcnt(6)
    v_mfma_f32_32x32x16_bf16 v[200:215], v[232:235], v[120:123], v[200:215]
    ds_read_b64_tr_b16 v[224:225], v248 offset:43136
    ds_read_b64_tr_b16 v[226:227], v248 offset:43904
    v_mfma_f32_32x32x16_bf16 v[200:215], v[236:239], v[124:127], v[200:215]
    ds_read_b64_tr_b16 v[228:229], v248 offset:46208
    ds_read_b64_tr_b16 v[230:231], v248 offset:46976
    v_mfma_f32_32x32x16_bf16 v[200:215], v[240:243], v[128:131], v[200:215]
    ds_read_b64_tr_b16 v[232:233], v248 offset:24704
    ds_read_b64_tr_b16 v[234:235], v248 offset:25472
    s_waitcnt lgkmcnt(6)
    v_mfma_f32_32x32x16_bf16 v[200:215], v[244:247], v[132:135], v[200:215]
    ds_read_b64_tr_b16 v[236:237], v248 offset:27776
    ds_read_b64_tr_b16 v[238:239], v248 offset:28544
    v_mul_f32 v184, v184, |v184|
    v_mul_f32 v185, v185, |v185|
    v_cvt_pk_bf16_f32 v184, v184, v185
    v_pk_max_i16 v184, v184, 0
    v_mfma_f32_32x32x16_bf16 v[200:215], v[216:219], v[136:139], v[200:215]
    ds_read_b64_tr_b16 v[240:241], v248 offset:30848
    ds_read_b64_tr_b16 v[242:243], v248 offset:31616
    v_mul_f32 v186, v186, |v186|
    v_mul_f32 v187, v187, |v187|
    v_cvt_pk_bf16_f32 v185, v186, v187
    v_pk_max_i16 v185, v185, 0
    v_mfma_f32_32x32x16_bf16 v[200:215], v[220:223], v[140:143], v[200:215]
    ds_read_b64_tr_b16 v[244:245], v248 offset:33920
    ds_read_b64_tr_b16 v[246:247], v248 offset:34688
    v_mul_f32 v188, v188, |v188|
    v_mul_f32 v189, v189, |v189|
    v_cvt_pk_bf16_f32 v186, v188, v189
    v_pk_max_i16 v186, v186, 0
    s_waitcnt lgkmcnt(6)
    v_mfma_f32_32x32x16_bf16 v[200:215], v[224:227], v[144:147], v[200:215]
    v_mul_f32 v190, v190, |v190|
    v_mul_f32 v191, v191, |v191|
    v_cvt_pk_bf16_f32 v187, v190, v191
    v_pk_max_i16 v187, v187, 0
    buffer_store_dwordx4 v[184:187], v0, s[28:31], s96 offen offset:2048 sc1
    v_mfma_f32_32x32x16_bf16 v[200:215], v[228:231], v[148:151], v[200:215]
    v_mul_f32 v192, v192, |v192|
    v_mul_f32 v193, v193, |v193|
    v_cvt_pk_bf16_f32 v188, v192, v193
    v_pk_max_i16 v188, v188, 0
    v_mul_f32 v194, v194, |v194|
    v_mfma_f32_32x32x16_bf16 v[200:215], v[232:235], v[152:155], v[200:215]
    v_mul_f32 v195, v195, |v195|
    v_cvt_pk_bf16_f32 v189, v194, v195
    v_pk_max_i16 v189, v189, 0
    v_mul_f32 v196, v196, |v196|
    v_mul_f32 v197, v197, |v197|
    s_waitcnt lgkmcnt(0)
    v_mfma_f32_32x32x16_bf16 v[200:215], v[236:239], v[156:159], v[200:215]
    v_cvt_pk_bf16_f32 v190, v196, v197
    v_pk_max_i16 v190, v190, 0
    v_mul_f32 v198, v198, |v198|
    v_mul_f32 v199, v199, |v199|
    v_cvt_pk_bf16_f32 v191, v198, v199
    v_mfma_f32_32x32x16_bf16 v[200:215], v[240:243], v[160:163], v[200:215]
    v_pk_max_i16 v191, v191, 0
    buffer_store_dwordx4 v[188:191], v0, s[28:31], s96 offen offset:3072 sc1
    v_mfma_f32_32x32x16_bf16 v[200:215], v[244:247], v[164:167], v[200:215]
    s_nop 11
    v_mul_f32 v200, v200, |v200|
    v_mul_f32 v201, v201, |v201|
    v_cvt_pk_bf16_f32 v200, v200, v201
    v_pk_max_i16 v200, v200, 0
    v_mul_f32 v202, v202, |v202|
    v_mul_f32 v203, v203, |v203|
    v_cvt_pk_bf16_f32 v201, v202, v203
    v_pk_max_i16 v201, v201, 0
    v_mul_f32 v204, v204, |v204|
    v_mul_f32 v205, v205, |v205|
    v_cvt_pk_bf16_f32 v202, v204, v205
    v_pk_max_i16 v202, v202, 0
    v_mul_f32 v206, v206, |v206|
    v_mul_f32 v207, v207, |v207|
    v_cvt_pk_bf16_f32 v203, v206, v207
    v_pk_max_i16 v203, v203, 0
    buffer_store_dwordx4 v[200:203], v0, s[28:31], s92 offen offset:0 sc1
    v_mul_f32 v208, v208, |v208|
    v_mul_f32 v209, v209, |v209|
    v_cvt_pk_bf16_f32 v204, v208, v209
    v_pk_max_i16 v204, v204, 0
    v_mul_f32 v210, v210, |v210|
    v_mul_f32 v211, v211, |v211|
    v_cvt_pk_bf16_f32 v205, v210, v211
    v_pk_max_i16 v205, v205, 0
    v_mul_f32 v212, v212, |v212|
    v_mul_f32 v213, v213, |v213|
    v_cvt_pk_bf16_f32 v206, v212, v213
    v_pk_max_i16 v206, v206, 0
    v_mul_f32 v214, v214, |v214|
    v_mul_f32 v215, v215, |v215|
    v_cvt_pk_bf16_f32 v207, v214, v215
    v_pk_max_i16 v207, v207, 0
    buffer_store_dwordx4 v[204:207], v0, s[28:31], s92 offen offset:1024 sc1
    s_setprio 0
L_att:
    v_mov_b32 v40, s90
    v_mov_b32 v12, 0
    v_mov_b32 v13, 0
    v_mov_b32 v14, 0x3f803f80
    v_mov_b32 v15, 0x3f80
    s_mov_b32 s94, -1
    s_mov_b32 s95, 0
    v_lshlrev_b32 v18, 3, v1
    v_sub_u32 v18, v17, v18
    s_barrier
    ds_read_b128 v[8:11], v17
    s_mov_b32 exec_hi, 0
    ds_read_b64 v[12:13], v18 offset:1024
    s_mov_b64 exec, s[46:47]
    ds_read_b128 v[20:23], v6 offset:0
    ds_read_b128 v[28:31], v6 offset:640
    s_mov_b64 exec, s[94:95]
    ds_read_b64 v[14:15], v5 offset:0
    s_mov_b64 exec, -1
    ds_read_b128 v[16:19], v4 offset:0
    s_waitcnt lgkmcnt(0)
    v_mfma_f32_32x32x16_bf16 v[52:67], v[16:19], v[8:11], 0
    v_mfma_f32_32x32x8_bf16 v[52:67], v[14:15], v[12:13], v[52:67]
    v_mov_b32 v84, 0
    v_mov_b32 v85, 0
    v_mov_b32 v86, 0
    v_mov_b32 v87, 0
    v_mov_b32 v88, 0
    v_mov_b32 v89, 0
    v_mov_b32 v90, 0
    v_mov_b32 v91, 0
    v_mov_b32 v92, 0
    v_mov_b32 v93, 0
    v_mov_b32 v94, 0
    v_mov_b32 v95, 0
    v_mov_b32 v96, 0
    v_mov_b32 v97, 0
    v_mov_b32 v98, 0
    v_mov_b32 v99, 0
    v_max3_f32 v72, v52, v53, v54
    v_max3_f32 v72, v72, v55, v56
    v_max3_f32 v72, v72, v57, v58
    v_max3_f32 v72, v72, v59, v60
    v_max3_f32 v72, v72, v61, v62
    v_max3_f32 v72, v72, v63, v64
    v_max3_f32 v72, v72, v65, v66
    v_max_f32 v72, v72, v67
    v_mov_b32 v73, v72
    s_nop 1
    v_permlane32_swap_b32 v72, v73
    s_nop 1
    v_max_f32 v72, v72, v73
    v_sub_f32 v72, 0, v72
    v_and_b32 v73, 0xffff0000, v72
    v_sub_f32 v74, v72, v73
    v_and_b32 v75, 0xffff0000, v74
    v_sub_f32 v74, v74, v75
    s_mov_b32 exec_lo, 0
    v_cvt_pk_bf16_f32 v12, v73, v75
    v_cvt_pk_bf16_f32 v13, v74, 0
    s_mov_b32 exec_lo, -1
    v_add_f32 v52, v52, v72
    v_add_f32 v53, v53, v72
    v_add_f32 v54, v54, v72
    v_add_f32 v55, v55, v72
    v_add_f32 v56, v56, v72
    v_add_f32 v57, v57, v72
    v_add_f32 v58, v58, v72
    v_add_f32 v59, v59, v72
    v_add_f32 v60, v60, v72
    v_add_f32 v61, v61, v72
    v_add_f32 v62, v62, v72
    v_add_f32 v63, v63, v72
    v_add_f32 v64, v64, v72
    v_add_f32 v65, v65, v72
    v_add_f32 v66, v66, v72
    v_add_f32 v67, v67, v72
    s_cmp_eq_u32 s22, 1
    s_cbranch_scc1 L_kok
    s_mov_b32 s83, 0
    s_mov_b32 exec_hi, 0
L_kpoll:
    s_waitcnt vmcnt(0)
    v_cmp_ne_u32 vcc, s90, v41
    s_add_u32 s83, s83, 1
    s_cmp_gt_u32 s83, 100000
    s_cbranch_scc1 L_kok0
    s_nop 1
    s_cbranch_vccz L_kok0
    buffer_load_dword v41, v42, s[28:31], 0 offen sc1
    s_branch L_kpoll
L_kok0:
    s_mov_b32 exec_hi, -1
L_kok:
    s_barrier
    s_mov_b64 exec, s[46:47]
    ds_read_b128 v[24:27], v6 offset:1280
    ds_read_b128 v[32:35], v6 offset:1920
    s_mov_b64 exec, s[94:95]
    ds_read_b64 v[14:15], v5 offset:256
    s_mov_b64 exec, -1
    ds_read_b128 v[16:19], v4 offset:1024
    s_lshl_b32 s44, s41, 3
    s_add_u32 s44, s44, s20
    s_mul_i32 s44, s44, 81920
    s_add_u32 m0, s42, 20480
    s_add_u32 s3, s98, s44
    buffer_load_dwordx4 v0, s[28:31], s3 offen sc1 lds
    s_add_u32 m0, s82, 24576
    s_add_u32 s3, s99, s44
    buffer_load_dword v252, s[28:31], s3 offen sc1 lds
    v_exp_f32 v52, v52
    s_setprio 1
    s_waitcnt lgkmcnt(0)
    v_exp_f32 v53, v53
    v_exp_f32 v54, v54
    v_exp_f32 v55, v55
    v_exp_f32 v56, v56
    v_mfma_f32_32x32x16_bf16 v[68:83], v[16:19], v[8:11], 0
    s_setprio 2
    v_exp_f32 v57, v57
    v_exp_f32 v58, v58
    v_exp_f32 v59, v59
    v_exp_f32 v60, v60
    v_mfma_f32_32x32x8_bf16 v[68:83], v[14:15], v[12:13], v[68:83]
    v_exp_f32 v61, v61
    v_exp_f32 v62, v62
    v_exp_f32 v63, v63
    v_exp_f32 v64, v64
    v_smfmac_f32_32x32x32_bf16 v[84:99], v[20:23], v[52:59], v7
    v_exp_f32 v65, v65
    v_exp_f32 v66, v66
    v_exp_f32 v67, v67
    s_setprio 0
    s_mov_b64 exec, s[46:47]
    ds_read_b128 v[20:23], v6 offset:2560
    ds_read_b128 v[36:39], v6 offset:3200
    s_mov_b64 exec, s[94:95]
    ds_read_b64 v[14:15], v5 offset:512
    s_mov_b64 exec, -1
    ds_read_b128 v[16:19], v4 offset:2048
    s_waitcnt vmcnt(2)
    s_mov_b64 exec, 1
    buffer_store_dword v40, v116, s[28:31], s4 offen sc1
    s_mov_b64 exec, -1
    buffer_load_dword v41, v119, s[28:31], 0 offen sc1
    s_lshr_b32 s55, s44, 1
    s_add_u32 m0, s43, 25600
    s_add_u32 s55, s55, 5242880
    buffer_load_dwordx4 v250, s[28:31], s55 offen sc1 lds
    s_add_u32 m0, s43, 26624
    s_mov_b64 exec, 0xffff
    buffer_load_dwordx4 v251, s[28:31], s55 offen sc1 lds
    s_mov_b64 exec, -1
    s_add_u32 s41, s41, 1
    s_and_b32 s41, s41, 7
    v_exp_f32 v68, v68
    v_smfmac_f32_32x32x32_bf16 v[84:99], v[28:31], v[60:67], v7
    s_setprio 1
    s_waitcnt lgkmcnt(0)
    v_exp_f32 v69, v69
    v_exp_f32 v70, v70
    v_exp_f32 v71, v71
    v_exp_f32 v72, v72
    v_mfma_f32_32x32x16_bf16 v[52:67], v[16:19], v[8:11], 0
    s_setprio 2
    v_exp_f32 v73, v73
    v_exp_f32 v74, v74
    v_exp_f32 v75, v75
    v_exp_f32 v76, v76
    v_mfma_f32_32x32x8_bf16 v[52:67], v[14:15], v[12:13], v[52:67]
    v_exp_f32 v77, v77
    v_exp_f32 v78, v78
    v_exp_f32 v79, v79
    v_exp_f32 v80, v80
    v_smfmac_f32_32x32x32_bf16 v[84:99], v[24:27], v[68:75], v7
    v_exp_f32 v81, v81
    v_exp_f32 v82, v82
    v_exp_f32 v83, v83
    s_setprio 0
    s_mov_b64 exec, s[46:47]
    ds_read_b128 v[24:27], v6 offset:3840
    ds_read_b128 v[28:31], v6 offset:4480
    s_mov_b64 exec, s[94:95]
    ds_read_b64 v[14:15], v5 offset:768
    s_mov_b64 exec, -1
    ds_read_b128 v[16:19], v4 offset:3072
    s_lshl_b32 s44, s41, 3
    s_add_u32 s44, s44, s20
    s_mul_i32 s44, s44, 81920
    s_add_u32 m0, s42, 40960
    s_add_u32 s3, s98, s44
    buffer_load_dwordx4 v0, s[28:31], s3 offen sc1 lds
    s_add_u32 m0, s82, 45056
    s_add_u32 s3, s99, s44
    buffer_load_dword v252, s[28:31], s3 offen sc1 lds
    v_exp_f32 v52, v52
    v_smfmac_f32_32x32x32_bf16 v[84:99], v[32:35], v[76:83], v7
    s_setprio 1
    s_waitcnt lgkmcnt(0)
    v_exp_f32 v53, v53
    v_exp_f32 v54, v54
    v_exp_f32 v55, v55
    v_exp_f32 v56, v56
    v_mfma_f32_32x32x16_bf16 v[68:83], v[16:19], v[8:11], 0
    s_setprio 2
    v_exp_f32 v57, v57
    v_exp_f32 v58, v58
    v_exp_f32 v59, v59
    v_exp_f32 v60, v60
    v_mfma_f32_32x32x8_bf16 v[68:83], v[14:15], v[12:13], v[68:83]
    v_exp_f32 v61, v61
    v_exp_f32 v62, v62
    v_exp_f32 v63, v63
    v_exp_f32 v64, v64
    v_smfmac_f32_32x32x32_bf16 v[84:99], v[20:23], v[52:59], v7
    v_exp_f32 v65, v65
    v_exp_f32 v66, v66
    v_exp_f32 v67, v67
    s_setprio 0
    s_mov_b64 exec, s[46:47]
    ds_read_b128 v[20:23], v6 offset:10240
    ds_read_b128 v[32:35], v6 offset:10880
    s_mov_b64 exec, s[94:95]
    ds_read_b64 v[14:15], v5 offset:10240
    s_mov_b64 exec, -1
    ds_read_b128 v[16:19], v4 offset:10240
    s_lshr_b32 s55, s44, 1
    s_add_u32 m0, s43, 46080
    s_add_u32 s55, s55, 5242880
    buffer_load_dwordx4 v250, s[28:31], s55 offen sc1 lds
    s_add_u32 m0, s43, 47104
    s_mov_b64 exec, 0xffff
    buffer_load_dwordx4 v251, s[28:31], s55 offen sc1 lds
    s_mov_b64 exec, -1
    s_add_u32 s41, s41, 1
    s_and_b32 s41, s41, 7
    v_exp_f32 v68, v68
    v_smfmac_f32_32x32x32_bf16 v[84:99], v[36:39], v[60:67], v7
    s_setprio 1
    s_waitcnt lgkmcnt(0)
    v_exp_f32 v69, v69
    v_exp_f32 v70, v70
    v_exp_f32 v71, v71
    v_exp_f32 v72, v72
    v_mfma_f32_32x32x16_bf16 v[52:67], v[16:19], v[8:11], 0
    s_setprio 2
    v_exp_f32 v73, v73
    v_exp_f32 v74, v74
    v_exp_f32 v75, v75
    v_exp_f32 v76, v76
    v_mfma_f32_32x32x8_bf16 v[52:67], v[14:15], v[12:13], v[52:67]
    v_exp_f32 v77, v77
    v_exp_f32 v78, v78
    v_exp_f32 v79, v79
    v_exp_f32 v80, v80
    v_smfmac_f32_32x32x32_bf16 v[84:99], v[24:27], v[68:75], v7
    v_exp_f32 v81, v81
    v_exp_f32 v82, v82
    v_exp_f32 v83, v83
    s_waitcnt vmcnt(6)
    v_cmp_ne_u32 vcc, s90, v41
    s_setprio 0
    s_mov_b64 exec, s[46:47]
    ds_read_b128 v[24:27], v6 offset:11520
    ds_read_b128 v[36:39], v6 offset:12160
    s_mov_b64 exec, s[94:95]
    ds_read_b64 v[14:15], v5 offset:10496
    s_mov_b64 exec, -1
    ds_read_b128 v[16:19], v4 offset:11264
    s_cbranch_vccz L_hok4
    s_mov_b32 s83, 0
L_hpoll4:
    buffer_load_dword v41, v119, s[28:31], 0 offen sc1
    s_add_u32 s83, s83, 1
    s_waitcnt vmcnt(0)
    v_cmp_ne_u32 vcc, s90, v41
    s_cmp_gt_u32 s83, 100000
    s_cbranch_scc1 L_hok4
    s_nop 2
    s_cbranch_vccnz L_hpoll4
L_hok4:
    s_lshl_b32 s44, s41, 3
    s_add_u32 s44, s44, s20
    s_mul_i32 s44, s44, 81920
    s_add_u32 m0, s42, 61440
    s_add_u32 s3, s98, s44
    buffer_load_dwordx4 v0, s[28:31], s3 offen sc1 lds
    s_add_u32 m0, s82, 65536
    s_add_u32 s3, s99, s44
    buffer_load_dword v252, s[28:31], s3 offen sc1 lds
    v_exp_f32 v52, v52
    v_smfmac_f32_32x32x32_bf16 v[84:99], v[28:31], v[76:83], v7
    s_setprio 1
    s_waitcnt lgkmcnt(0)
    v_exp_f32 v53, v53
    v_exp_f32 v54, v54
    v_exp_f32 v55, v55
    v_exp_f32 v56, v56
    v_mfma_f32_32x32x16_bf16 v[68:83], v[16:19], v[8:11], 0
    s_setprio 2
    v_exp_f32 v57, v57
    v_exp_f32 v58, v58
    v_exp_f32 v59, v59
    v_exp_f32 v60, v60
    v_mfma_f32_32x32x8_bf16 v[68:83], v[14:15], v[12:13], v[68:83]
    v_exp_f32 v61, v61
    v_exp_f32 v62, v62
    v_exp_f32 v63, v63
    v_exp_f32 v64, v64
    v_smfmac_f32_32x32x32_bf16 v[84:99], v[20:23], v[52:59], v7
    v_exp_f32 v65, v65
    v_exp_f32 v66, v66
    v_exp_f32 v67, v67
    s_setprio 0
    s_mov_b64 exec, s[46:47]
    ds_read_b128 v[20:23], v6 offset:12800
    ds_read_b128 v[28:31], v6 offset:13440
    s_mov_b64 exec, s[94:95]
    ds_read_b64 v[14:15], v5 offset:10752
    s_mov_b64 exec, -1
    ds_read_b128 v[16:19], v4 offset:12288
    s_lshr_b32 s55, s44, 1
    s_add_u32 m0, s43, 66560
    s_add_u32 s55, s55, 5242880
    buffer_load_dwordx4 v250, s[28:31], s55 offen sc1 lds
    s_add_u32 m0, s43, 67584
    s_mov_b64 exec, 0xffff
    buffer_load_dwordx4 v251, s[28:31], s55 offen sc1 lds
    s_mov_b64 exec, -1
    s_add_u32 s41, s41, 1
    s_and_b32 s41, s41, 7
    v_exp_f32 v68, v68
    v_smfmac_f32_32x32x32_bf16 v[84:99], v[32:35], v[60:67], v7
    s_setprio 1
    s_waitcnt lgkmcnt(0)
    v_exp_f32 v69, v69
    v_exp_f32 v70, v70
    v_exp_f32 v71, v71
    v_exp_f32 v72, v72
    v_mfma_f32_32x32x16_bf16 v[52:67], v[16:19], v[8:11], 0
    s_setprio 2
    v_exp_f32 v73, v73
    v_exp_f32 v74, v74
    v_exp_f32 v75, v75
    v_exp_f32 v76, v76
    v_mfma_f32_32x32x8_bf16 v[52:67], v[14:15], v[12:13], v[52:67]
    v_exp_f32 v77, v77
    v_exp_f32 v78, v78
    v_exp_f32 v79, v79
    v_exp_f32 v80, v80
    v_smfmac_f32_32x32x32_bf16 v[84:99], v[24:27], v[68:75], v7
    v_exp_f32 v81, v81
    v_exp_f32 v82, v82
    v_exp_f32 v83, v83
    s_setprio 0
    s_waitcnt vmcnt(4)
    s_cmp_eq_u32 s22, 0
    s_cbranch_scc1 L_ba6
    s_barrier
L_ba6:
    s_mov_b64 exec, s[46:47]
    ds_read_b128 v[24:27], v6 offset:14080
    ds_read_b128 v[32:35], v6 offset:14720
    s_mov_b64 exec, s[94:95]
    ds_read_b64 v[14:15], v5 offset:11008
    s_mov_b64 exec, -1
    ds_read_b128 v[16:19], v4 offset:13312
    buffer_load_dword v41, v118, s[28:31], s5 offen sc1
    s_lshl_b32 s44, s41, 3
    s_add_u32 s44, s44, s20
    s_mul_i32 s44, s44, 81920
    s_add_u32 m0, s42, 81920
    s_add_u32 s3, s98, s44
    buffer_load_dwordx4 v0, s[28:31], s3 offen sc1 lds
    s_add_u32 m0, s82, 86016
    s_add_u32 s3, s99, s44
    buffer_load_dword v252, s[28:31], s3 offen sc1 lds
    s_cmp_eq_u32 s22, 1
    s_cbranch_scc1 L_bb6
    s_barrier
L_bb6:
    v_exp_f32 v52, v52
    v_smfmac_f32_32x32x32_bf16 v[84:99], v[36:39], v[76:83], v7
    s_setprio 1
    s_waitcnt lgkmcnt(0)
    v_exp_f32 v53, v53
    v_exp_f32 v54, v54
    v_exp_f32 v55, v55
    v_exp_f32 v56, v56
    v_mfma_f32_32x32x16_bf16 v[68:83], v[16:19], v[8:11], 0
    s_setprio 2
    v_exp_f32 v57, v57
    v_exp_f32 v58, v58
    v_exp_f32 v59, v59
    v_exp_f32 v60, v60
    v_mfma_f32_32x32x8_bf16 v[68:83], v[14:15], v[12:13], v[68:83]
    v_exp_f32 v61, v61
    v_exp_f32 v62, v62
    v_exp_f32 v63, v63
    v_exp_f32 v64, v64
    v_smfmac_f32_32x32x32_bf16 v[84:99], v[20:23], v[52:59], v7
    v_exp_f32 v65, v65
    v_exp_f32 v66, v66
    v_exp_f32 v67, v67
    s_setprio 0
    s_mov_b64 exec, s[46:47]
    ds_read_b128 v[20:23], v6 offset:20480
    ds_read_b128 v[36:39], v6 offset:21120
    s_mov_b64 exec, s[94:95]
    ds_read_b64 v[14:15], v5 offset:20480
    s_mov_b64 exec, -1
    ds_read_b128 v[16:19], v4 offset:20480
    s_lshr_b32 s55, s44, 1
    s_add_u32 m0, s43, 87040
    s_add_u32 s55, s55, 5242880
    buffer_load_dwordx4 v250, s[28:31], s55 offen sc1 lds
    s_add_u32 m0, s43, 88064
    s_mov_b64 exec, 0xffff
    buffer_load_dwordx4 v251, s[28:31], s55 offen sc1 lds
    s_mov_b64 exec, -1
    s_add_u32 s41, s41, 1
    s_and_b32 s41, s41, 7
    v_exp_f32 v68, v68
    v_smfmac_f32_32x32x32_bf16 v[84:99], v[28:31], v[60:67], v7
    s_setprio 1
    s_waitcnt lgkmcnt(0)
    v_exp_f32 v69, v69
    v_exp_f32 v70, v70
    v_exp_f32 v71, v71
    v_exp_f32 v72, v72
    v_mfma_f32_32x32x16_bf16 v[52:67], v[16:19], v[8:11], 0
    s_setprio 2
    v_exp_f32 v73, v73
    v_exp_f32 v74, v74
    v_exp_f32 v75, v75
    v_exp_f32 v76, v76
    v_mfma_f32_32x32x8_bf16 v[52:67], v[14:15], v[12:13], v[52:67]
    v_exp_f32 v77, v77
    v_exp_f32 v78, v78
    v_exp_f32 v79, v79
    v_exp_f32 v80, v80
    v_smfmac_f32_32x32x32_bf16 v[84:99], v[24:27], v[68:75], v7
    v_exp_f32 v81, v81
    v_exp_f32 v82, v82
    v_exp_f32 v83, v83
    s_waitcnt vmcnt(4)
    v_cmp_ne_u32 vcc, s90, v41
    s_setprio 0
    s_mov_b64 exec, s[46:47]
    ds_read_b128 v[24:27], v6 offset:21760
    ds_read_b128 v[28:31], v6 offset:22400
    s_mov_b64 exec, s[94:95]
    ds_read_b64 v[14:15], v5 offset:20736
    s_mov_b64 exec, -1
    ds_read_b128 v[16:19], v4 offset:21504
    s_cbranch_vccz L_hok8
    s_mov_b32 s83, 0
L_hpoll8:
    buffer_load_dword v41, v118, s[28:31], s5 offen sc1
    s_add_u32 s83, s83, 1
    s_waitcnt vmcnt(0)
    v_cmp_ne_u32 vcc, s90, v41
    s_cmp_gt_u32 s83, 100000
    s_cbranch_scc1 L_hok8
    s_nop 2
    s_cbranch_vccnz L_hpoll8
L_hok8:
    s_lshl_b32 s44, s41, 3
    s_add_u32 s44, s44, s20
    s_mul_i32 s44, s44, 81920
    s_add_u32 m0, s42, 102400
    s_add_u32 s3, s98, s44
    buffer_load_dwordx4 v0, s[28:31], s3 offen sc1 lds
    buffer_load_dwordx4 v[200:203], v0, s[28:31], s50 offen sc1
    s_add_u32 s50, s50, 2048
    buffer_load_dwordx4 v[168:171], v0, s[28:31], s49 offen sc1
    v_exp_f32 v52, v52
    v_smfmac_f32_32x32x32_bf16 v[84:99], v[32:35], v[76:83], v7
    s_setprio 1
    s_waitcnt lgkmcnt(0)
    v_exp_f32 v53, v53
    v_exp_f32 v54, v54
    v_exp_f32 v55, v55
    v_exp_f32 v56, v56
    v_mfma_f32_32x32x16_bf16 v[68:83], v[16:19], v[8:11], 0
    s_setprio 2
    v_exp_f32 v57, v57
    v_exp_f32 v58, v58
    v_exp_f32 v59, v59
    v_exp_f32 v60, v60
    v_mfma_f32_32x32x8_bf16 v[68:83], v[14:15], v[12:13], v[68:83]
    v_exp_f32 v61, v61
    v_exp_f32 v62, v62
    v_exp_f32 v63, v63
    v_exp_f32 v64, v64
    v_smfmac_f32_32x32x32_bf16 v[84:99], v[20:23], v[52:59], v7
    v_exp_f32 v65, v65
    v_exp_f32 v66, v66
    v_exp_f32 v67, v67
    s_setprio 0
    s_mov_b64 exec, s[46:47]
    ds_read_b128 v[20:23], v6 offset:23040
    ds_read_b128 v[32:35], v6 offset:23680
    s_mov_b64 exec, s[94:95]
    ds_read_b64 v[14:15], v5 offset:20992
    s_mov_b64 exec, -1
    ds_read_b128 v[16:19], v4 offset:22528
    s_add_u32 m0, s82, 106496
    s_add_u32 s3, s99, s44
    buffer_load_dword v252, s[28:31], s3 offen sc1 lds
    buffer_load_dwordx4 v[172:175], v0, s[28:31], s49 offen offset:1024 sc1
    s_add_u32 s49, s49, 40960
    v_exp_f32 v68, v68
    v_smfmac_f32_32x32x32_bf16 v[84:99], v[36:39], v[60:67], v7
    s_setprio 1
    s_waitcnt lgkmcnt(0)
    v_exp_f32 v69, v69
    v_exp_f32 v70, v70
    v_exp_f32 v71, v71
    v_exp_f32 v72, v72
    v_mfma_f32_32x32x16_bf16 v[52:67], v[16:19], v[8:11], 0
    s_setprio 2
    v_exp_f32 v73, v73
    v_exp_f32 v74, v74
    v_exp_f32 v75, v75
    v_exp_f32 v76, v76
    v_mfma_f32_32x32x8_bf16 v[52:67], v[14:15], v[12:13], v[52:67]
    v_exp_f32 v77, v77
    v_exp_f32 v78, v78
    v_exp_f32 v79, v79
    v_exp_f32 v80, v80
    v_smfmac_f32_32x32x32_bf16 v[84:99], v[24:27], v[68:75], v7
    v_exp_f32 v81, v81
    v_exp_f32 v82, v82
    v_exp_f32 v83, v83
    s_setprio 0
    s_mov_b64 exec, s[46:47]
    ds_read_b128 v[24:27], v6 offset:24320
    ds_read_b128 v[36:39], v6 offset:24960
    s_mov_b64 exec, s[94:95]
    ds_read_b64 v[14:15], v5 offset:21248
    s_mov_b64 exec, -1
    ds_read_b128 v[16:19], v4 offset:23552
    s_lshr_b32 s55, s44, 1
    s_add_u32 m0, s43, 107520
    s_add_u32 s55, s55, 5242880
    buffer_load_dwordx4 v250, s[28:31], s55 offen sc1 lds
    buffer_load_dwordx4 v[176:179], v0, s[28:31], s52 offen sc1
    s_add_u32 s52, s52, 40960
    v_exp_f32 v52, v52
    v_smfmac_f32_32x32x32_bf16 v[84:99], v[28:31], v[76:83], v7
    s_setprio 1
    s_waitcnt lgkmcnt(0)
    v_exp_f32 v53, v53
    v_exp_f32 v54, v54
    v_exp_f32 v55, v55
    v_exp_f32 v56, v56
    v_mfma_f32_32x32x16_bf16 v[68:83], v[16:19], v[8:11], 0
    s_setprio 2
    v_exp_f32 v57, v57
    v_exp_f32 v58, v58
    v_exp_f32 v59, v59
    v_exp_f32 v60, v60
    v_mfma_f32_32x32x8_bf16 v[68:83], v[14:15], v[12:13], v[68:83]
    v_exp_f32 v61, v61
    v_exp_f32 v62, v62
    v_exp_f32 v63, v63
    v_exp_f32 v64, v64
    v_smfmac_f32_32x32x32_bf16 v[84:99], v[20:23], v[52:59], v7
    v_exp_f32 v65, v65
    v_exp_f32 v66, v66
    v_exp_f32 v67, v67
    s_setprio 0
    s_mov_b64 exec, s[46:47]
    ds_read_b128 v[20:23], v6 offset:30720
    ds_read_b128 v[28:31], v6 offset:31360
    s_mov_b64 exec, s[94:95]
    ds_read_b64 v[14:15], v5 offset:30720
    s_mov_b64 exec, -1
    ds_read_b128 v[16:19], v4 offset:30720
    s_add_u32 m0, s43, 108544
    s_mov_b64 exec, 0xffff
    buffer_load_dwordx4 v251, s[28:31], s55 offen sc1 lds
    s_mov_b64 exec, -1
    s_add_u32 s41, s41, 1
    s_and_b32 s41, s41, 7
    buffer_load_dwordx4 v[204:207], v0, s[28:31], s51 offen sc1
    s_add_u32 s51, s51, 2048
    buffer_load_dwordx4 v[180:183], v0, s[28:31], s48 offen sc1
    v_exp_f32 v68, v68
    v_smfmac_f32_32x32x32_bf16 v[84:99], v[32:35], v[60:67], v7
    s_setprio 1
    s_waitcnt vmcnt(7) lgkmcnt(0)
    v_exp_f32 v69, v69
    v_exp_f32 v70, v70
    v_exp_f32 v71, v71
    v_mfma_f32_32x32x16_bf16 v[52:67], v[16:19], v[8:11], 0
    s_setprio 2
    v_exp_f32 v72, v72
    v_exp_f32 v73, v73
    v_exp_f32 v74, v74
    v_mfma_f32_32x32x16_bf16 v[120:135], v[168:171], v[200:203], 0
    v_exp_f32 v75, v75
    v_exp_f32 v76, v76
    v_exp_f32 v77, v77
    v_smfmac_f32_32x32x32_bf16 v[84:99], v[24:27], v[68:75], v7
    v_exp_f32 v78, v78
    v_exp_f32 v79, v79
    v_exp_f32 v80, v80
    v_mfma_f32_32x32x8_bf16 v[52:67], v[14:15], v[12:13], v[52:67]
    v_exp_f32 v81, v81
    v_exp_f32 v82, v82
    v_exp_f32 v83, v83
    s_setprio 0
    s_mov_b64 exec, s[46:47]
    ds_read_b128 v[24:27], v6 offset:32000
    ds_read_b128 v[32:35], v6 offset:32640
    s_mov_b64 exec, s[94:95]
    ds_read_b64 v[14:15], v5 offset:30976
    s_mov_b64 exec, -1
    ds_read_b128 v[16:19], v4 offset:31744
    s_lshl_b32 s44, s41, 3
    s_add_u32 s44, s44, s20
    s_mul_i32 s44, s44, 81920
    s_add_u32 m0, s42, 122880
    s_add_u32 s3, s98, s44
    buffer_load_dwordx4 v0, s[28:31], s3 offen sc1 lds
    buffer_load_dwordx4 v[184:187], v0, s[28:31], s48 offen offset:1024 sc1
    s_add_u32 s48, s48, 40960
    v_exp_f32 v52, v52
    v_smfmac_f32_32x32x32_bf16 v[84:99], v[36:39], v[76:83], v7
    s_setprio 1
    s_waitcnt vmcnt(7) lgkmcnt(0)
    v_exp_f32 v53, v53
    v_exp_f32 v54, v54
    v_exp_f32 v55, v55
    v_mfma_f32_32x32x16_bf16 v[68:83], v[16:19], v[8:11], 0
    s_setprio 2
    v_exp_f32 v56, v56
    v_exp_f32 v57, v57
    v_exp_f32 v58, v58
    v_mfma_f32_32x32x16_bf16 v[136:151], v[172:175], v[200:203], 0
    v_exp_f32 v59, v59
    v_exp_f32 v60, v60
    v_exp_f32 v61, v61
    v_smfmac_f32_32x32x32_bf16 v[84:99], v[20:23], v[52:59], v7
    v_exp_f32 v62, v62
    v_exp_f32 v63, v63
    v_exp_f32 v64, v64
    v_mfma_f32_32x32x8_bf16 v[68:83], v[14:15], v[12:13], v[68:83]
    v_exp_f32 v65, v65
    v_exp_f32 v66, v66
    v_exp_f32 v67, v67
    s_setprio 0
    s_mov_b64 exec, s[46:47]
    ds_read_b128 v[20:23], v6 offset:33280
    ds_read_b128 v[36:39], v6 offset:33920
    s_mov_b64 exec, s[94:95]
    ds_read_b64 v[14:15], v5 offset:31232
    s_mov_b64 exec, -1
    ds_read_b128 v[16:19], v4 offset:32768
    s_add_u32 m0, s82, 126976
    s_add_u32 s3, s99, s44
    buffer_load_dword v252, s[28:31], s3 offen sc1 lds
    buffer_load_dwordx4 v[208:211], v0, s[28:31], s50 offen sc1
    s_add_u32 s50, s50, 2048
    buffer_load_dwordx4 v[188:191], v0, s[28:31], s49 offen sc1
    v_exp_f32 v68, v68
    v_smfmac_f32_32x32x32_bf16 v[84:99], v[28:31], v[60:67], v7
    s_setprio 1
    s_waitcnt vmcnt(8) lgkmcnt(0)
    v_exp_f32 v69, v69
    v_exp_f32 v70, v70
    v_exp_f32 v71, v71
    v_mfma_f32_32x32x16_bf16 v[52:67], v[16:19], v[8:11], 0
    s_setprio 2
    v_exp_f32 v72, v72
    v_exp_f32 v73, v73
    v_exp_f32 v74, v74
    v_mfma_f32_32x32x16_bf16 v[152:167], v[176:179], v[200:203], 0
    v_exp_f32 v75, v75
    v_exp_f32 v76, v76
    v_exp_f32 v77, v77
    v_smfmac_f32_32x32x32_bf16 v[84:99], v[24:27], v[68:75], v7
    v_exp_f32 v78, v78
    v_exp_f32 v79, v79
    v_exp_f32 v80, v80
    v_mfma_f32_32x32x8_bf16 v[52:67], v[14:15], v[12:13], v[52:67]
    v_exp_f32 v81, v81
    v_exp_f32 v82, v82
    v_exp_f32 v83, v83
    s_setprio 0
    s_mov_b64 exec, s[46:47]
    ds_read_b128 v[24:27], v6 offset:34560
    ds_read_b128 v[28:31], v6 offset:35200
    s_mov_b64 exec, s[94:95]
    ds_read_b64 v[14:15], v5 offset:31488
    s_mov_b64 exec, -1
    ds_read_b128 v[16:19], v4 offset:33792
    s_lshr_b32 s55, s44, 1
    s_add_u32 m0, s43, 128000
    s_add_u32 s55, s55, 5242880
    buffer_load_dwordx4 v250, s[28:31], s55 offen sc1 lds
    buffer_load_dwordx4 v[192:195], v0, s[28:31], s49 offen offset:1024 sc1
    s_add_u32 s49, s49, 40960
    v_exp_f32 v52, v52
    v_smfmac_f32_32x32x32_bf16 v[84:99], v[32:35], v[76:83], v7
    s_setprio 1
    s_waitcnt vmcnt(7) lgkmcnt(0)
    v_exp_f32 v53, v53
    v_exp_f32 v54, v54
    v_exp_f32 v55, v55
    v_mfma_f32_32x32x16_bf16 v[68:83], v[16:19], v[8:11], 0
    s_setprio 2
    v_exp_f32 v56, v56
    v_exp_f32 v57, v57
    v_exp_f32 v58, v58
    v_mfma_f32_32x32x16_bf16 v[120:135], v[180:183], v[204:207], v[120:135]
    v_exp_f32 v59, v59
    v_exp_f32 v60, v60
    v_exp_f32 v61, v61
    v_smfmac_f32_32x32x32_bf16 v[84:99], v[20:23], v[52:59], v7
    v_exp_f32 v62, v62
    v_exp_f32 v63, v63
    v_exp_f32 v64, v64
    v_mfma_f32_32x32x8_bf16 v[68:83], v[14:15], v[12:13], v[68:83]
    v_exp_f32 v65, v65
    v_exp_f32 v66, v66
    v_exp_f32 v67, v67
    s_setprio 0
    s_mov_b64 exec, s[46:47]
    ds_read_b128 v[20:23], v6 offset:40960
    ds_read_b128 v[32:35], v6 offset:41600
    s_mov_b64 exec, s[94:95]
    ds_read_b64 v[14:15], v5 offset:40960
    s_mov_b64 exec, -1
    ds_read_b128 v[16:19], v4 offset:40960
    s_add_u32 m0, s43, 129024
    s_mov_b64 exec, 0xffff
    buffer_load_dwordx4 v251, s[28:31], s55 offen sc1 lds
    s_mov_b64 exec, -1
    s_add_u32 s41, s41, 1
    s_and_b32 s41, s41, 7
    buffer_load_dwordx4 v[196:199], v0, s[28:31], s52 offen sc1
    s_add_u32 s52, s52, 40960
    v_exp_f32 v68, v68
    v_smfmac_f32_32x32x32_bf16 v[84:99], v[36:39], v[60:67], v7
    s_setprio 1
    s_waitcnt vmcnt(7) lgkmcnt(0)
    v_exp_f32 v69, v69
    v_exp_f32 v70, v70
    v_exp_f32 v71, v71
    v_mfma_f32_32x32x16_bf16 v[52:67], v[16:19], v[8:11], 0
    s_setprio 2
    v_exp_f32 v72, v72
    v_exp_f32 v73, v73
    v_exp_f32 v74, v74
    v_mfma_f32_32x32x16_bf16 v[136:151], v[184:187], v[204:207], v[136:151]
    v_exp_f32 v75, v75
    v_exp_f32 v76, v76
    v_exp_f32 v77, v77
    v_smfmac_f32_32x32x32_bf16 v[84:99], v[24:27], v[68:75], v7
    v_exp_f32 v78, v78
    v_exp_f32 v79, v79
    v_exp_f32 v80, v80
    v_mfma_f32_32x32x8_bf16 v[52:67], v[14:15], v[12:13], v[52:67]
    v_exp_f32 v81, v81
    v_exp_f32 v82, v82
    v_exp_f32 v83, v83
    s_setprio 0
    s_mov_b64 exec, s[46:47]
    ds_read_b128 v[24:27], v6 offset:42240
    ds_read_b128 v[36:39], v6 offset:42880
    s_mov_b64 exec, s[94:95]
    ds_read_b64 v[14:15], v5 offset:41216
    s_mov_b64 exec, -1
    ds_read_b128 v[16:19], v4 offset:41984
    s_lshl_b32 s44, s41, 3
    s_add_u32 s44, s44, s20
    s_mul_i32 s44, s44, 81920
    s_add_u32 m0, s42, 143360
    s_add_u32 s3, s98, s44
    buffer_load_dwordx4 v0, s[28:31], s3 offen sc1 lds
    buffer_load_dwordx4 v[212:215], v0, s[28:31], s51 offen sc1
    s_add_u32 s51, s51, 2048
    buffer_load_dwordx4 v[168:171], v0, s[28:31], s48 offen sc1
    v_exp_f32 v52, v52
    v_smfmac_f32_32x32x32_bf16 v[84:99], v[28:31], v[76:83], v7
    s_setprio 1
    s_waitcnt vmcnt(7) lgkmcnt(0)
    v_exp_f32 v53, v53
    v_exp_f32 v54, v54
    v_exp_f32 v55, v55
    v_mfma_f32_32x32x16_bf16 v[68:83], v[16:19], v[8:11], 0
    s_setprio 2
    v_exp_f32 v56, v56
    v_exp_f32 v57, v57
    v_exp_f32 v58, v58
    v_mfma_f32_32x32x16_bf16 v[120:135], v[188:191], v[208:211], v[120:135]
    v_exp_f32 v59, v59
    v_exp_f32 v60, v60
    v_exp_f32 v61, v61
    v_smfmac_f32_32x32x32_bf16 v[84:99], v[20:23], v[52:59], v7
    v_exp_f32 v62, v62
    v_exp_f32 v63, v63
    v_exp_f32 v64, v64
    v_mfma_f32_32x32x8_bf16 v[68:83], v[14:15], v[12:13], v[68:83]
    v_exp_f32 v65, v65
    v_exp_f32 v66, v66
    v_exp_f32 v67, v67
    s_setprio 0
    s_mov_b64 exec, s[46:47]
    ds_read_b128 v[20:23], v6 offset:43520
    ds_read_b128 v[28:31], v6 offset:44160
    s_mov_b64 exec, s[94:95]
    ds_read_b64 v[14:15], v5 offset:41472
    s_mov_b64 exec, -1
    ds_read_b128 v[16:19], v4 offset:43008
    s_add_u32 m0, s82, 147456
    s_add_u32 s3, s99, s44
    buffer_load_dword v252, s[28:31], s3 offen sc1 lds
    buffer_load_dwordx4 v[172:175], v0, s[28:31], s48 offen offset:1024 sc1
    s_add_u32 s48, s48, 40960
    v_exp_f32 v68, v68
    v_smfmac_f32_32x32x32_bf16 v[84:99], v[32:35], v[60:67], v7
    s_setprio 1
    s_waitcnt vmcnt(7) lgkmcnt(0)
    v_exp_f32 v69, v69
    v_exp_f32 v70, v70
    v_exp_f32 v71, v71
    v_mfma_f32_32x32x16_bf16 v[52:67], v[16:19], v[8:11], 0
    s_setprio 2
    v_exp_f32 v72, v72
    v_exp_f32 v73, v73
    v_exp_f32 v74, v74
    v_mfma_f32_32x32x16_bf16 v[136:151], v[192:195], v[208:211], v[136:151]
    v_exp_f32 v75, v75
    v_exp_f32 v76, v76
    v_exp_f32 v77, v77
    v_smfmac_f32_32x32x32_bf16 v[84:99], v[24:27], v[68:75], v7
    v_exp_f32 v78, v78
    v_exp_f32 v79, v79
    v_exp_f32 v80, v80
    v_mfma_f32_32x32x8_bf16 v[52:67], v[14:15], v[12:13], v[52:67]
    v_exp_f32 v81, v81
    v_exp_f32 v82, v82
    v_exp_f32 v83, v83
    s_setprio 0
    s_mov_b64 exec, s[46:47]
    ds_read_b128 v[24:27], v6 offset:44800
    ds_read_b128 v[32:35], v6 offset:45440
    s_mov_b64 exec, s[94:95]
    ds_read_b64 v[14:15], v5 offset:41728
    s_mov_b64 exec, -1
    ds_read_b128 v[16:19], v4 offset:44032
    s_lshr_b32 s55, s44, 1
    s_add_u32 m0, s43, 148480
    s_add_u32 s55, s55, 5242880
    buffer_load_dwordx4 v250, s[28:31], s55 offen sc1 lds
    buffer_load_dwordx4 v[200:203], v0, s[28:31], s50 offen sc1
    s_add_u32 s50, s50, 2048
    buffer_load_dwordx4 v[176:179], v0, s[28:31], s49 offen sc1
    v_exp_f32 v52, v52
    v_smfmac_f32_32x32x32_bf16 v[84:99], v[36:39], v[76:83], v7
    s_setprio 1
    s_waitcnt vmcnt(8) lgkmcnt(0)
    v_exp_f32 v53, v53
    v_exp_f32 v54, v54
    v_exp_f32 v55, v55
    v_mfma_f32_32x32x16_bf16 v[68:83], v[16:19], v[8:11], 0
    s_setprio 2
    v_exp_f32 v56, v56
    v_exp_f32 v57, v57
    v_exp_f32 v58, v58
    v_mfma_f32_32x32x16_bf16 v[152:167], v[196:199], v[208:211], v[152:167]
    v_exp_f32 v59, v59
    v_exp_f32 v60, v60
    v_exp_f32 v61, v61
    v_smfmac_f32_32x32x32_bf16 v[84:99], v[20:23], v[52:59], v7
    v_exp_f32 v62, v62
    v_exp_f32 v63, v63
    v_exp_f32 v64, v64
    v_mfma_f32_32x32x8_bf16 v[68:83], v[14:15], v[12:13], v[68:83]
    v_exp_f32 v65, v65
    v_exp_f32 v66, v66
    v_exp_f32 v67, v67
    s_setprio 0
    s_mov_b64 exec, s[46:47]
    ds_read_b128 v[20:23], v6 offset:51200
    ds_read_b128 v[36:39], v6 offset:51840
    s_mov_b64 exec, s[94:95]
    ds_read_b64 v[14:15], v5 offset:51200
    s_mov_b64 exec, -1
    ds_read_b128 v[16:19], v4 offset:51200
    s_add_u32 m0, s43, 149504
    s_mov_b64 exec, 0xffff
    buffer_load_dwordx4 v251, s[28:31], s55 offen sc1 lds
    s_mov_b64 exec, -1
    s_add_u32 s41, s41, 1
    s_and_b32 s41, s41, 7
    buffer_load_dwordx4 v[180:183], v0, s[28:31], s49 offen offset:1024 sc1
    s_add_u32 s49, s49, 40960
    v_exp_f32 v68, v68
    v_smfmac_f32_32x32x32_bf16 v[84:99], v[28:31], v[60:67], v7
    s_setprio 1
    s_waitcnt vmcnt(7) lgkmcnt(0)
    v_exp_f32 v69, v69
    v_exp_f32 v70, v70
    v_exp_f32 v71, v71
    v_mfma_f32_32x32x16_bf16 v[52:67], v[16:19], v[8:11], 0
    s_setprio 2
    v_exp_f32 v72, v72
    v_exp_f32 v73, v73
    v_exp_f32 v74, v74
    v_mfma_f32_32x32x16_bf16 v[120:135], v[168:171], v[212:215], v[120:135]
    v_exp_f32 v75, v75
    v_exp_f32 v76, v76
    v_exp_f32 v77, v77
    v_smfmac_f32_32x32x32_bf16 v[84:99], v[24:27], v[68:75], v7
    v_exp_f32 v78, v78
    v_exp_f32 v79, v79
    v_exp_f32 v80, v80
    v_mfma_f32_32x32x8_bf16 v[52:67], v[14:15], v[12:13], v[52:67]
    v_exp_f32 v81, v81
    v_exp_f32 v82, v82
    v_exp_f32 v83, v83
    s_setprio 0
    s_mov_b64 exec, s[46:47]
    ds_read_b128 v[24:27], v6 offset:52480
    ds_read_b128 v[28:31], v6 offset:53120
    s_mov_b64 exec, s[94:95]
    ds_read_b64 v[14:15], v5 offset:51456
    s_mov_b64 exec, -1
    ds_read_b128 v[16:19], v4 offset:52224
    buffer_load_dwordx4 v[184:187], v0, s[28:31], s52 offen sc1
    s_add_u32 s52, s52, 40960
    v_exp_f32 v52, v52
    v_smfmac_f32_32x32x32_bf16 v[84:99], v[32:35], v[76:83], v7
    s_setprio 1
    s_waitcnt vmcnt(6) lgkmcnt(0)
    v_exp_f32 v53, v53
    v_exp_f32 v54, v54
    v_exp_f32 v55, v55
    v_mfma_f32_32x32x16_bf16 v[68:83], v[16:19], v[8:11], 0
    s_setprio 2
    v_exp_f32 v56, v56
    v_exp_f32 v57, v57
    v_exp_f32 v58, v58
    v_mfma_f32_32x32x16_bf16 v[136:151], v[172:175], v[212:215], v[136:151]
    v_exp_f32 v59, v59
    v_exp_f32 v60, v60
    v_exp_f32 v61, v61
    v_smfmac_f32_32x32x32_bf16 v[84:99], v[20:23], v[52:59], v7
    v_exp_f32 v62, v62
    v_exp_f32 v63, v63
    v_exp_f32 v64, v64
    v_mfma_f32_32x32x8_bf16 v[68:83], v[14:15], v[12:13], v[68:83]
    v_exp_f32 v65, v65
    v_exp_f32 v66, v66
    v_exp_f32 v67, v67
    v_lshrrev_b32 v117, 4, v1
    v_mul_u32_u24 v117, 1280, v117
    v_add_u32 v117, v117, v118
    v_lshlrev_b32 v119, 2, v2
    s_setprio 0
    s_mov_b64 exec, s[46:47]
    ds_read_b128 v[20:23], v6 offset:53760
    ds_read_b128 v[32:35], v6 offset:54400
    s_mov_b64 exec, s[94:95]
    ds_read_b64 v[14:15], v5 offset:51712
    s_mov_b64 exec, -1
    ds_read_b128 v[16:19], v4 offset:53248
    buffer_load_dwordx4 v[204:207], v0, s[28:31], s51 offen sc1
    s_add_u32 s51, s51, 2048
    buffer_load_dwordx4 v[188:191], v0, s[28:31], s48 offen sc1
    buffer_load_dwordx4 v[192:195], v0, s[28:31], s48 offen offset:1024 sc1
    s_add_u32 s48, s48, 40960
    v_exp_f32 v68, v68
    v_smfmac_f32_32x32x32_bf16 v[84:99], v[36:39], v[60:67], v7
    s_setprio 1
    s_waitcnt vmcnt(6) lgkmcnt(0)
    v_exp_f32 v69, v69
    v_exp_f32 v70, v70
    v_exp_f32 v71, v71
    v_mfma_f32_32x32x16_bf16 v[52:67], v[16:19], v[8:11], 0
    s_setprio 2
    v_exp_f32 v72, v72
    v_exp_f32 v73, v73
    v_exp_f32 v74, v74
    v_mfma_f32_32x32x16_bf16 v[120:135], v[176:179], v[200:203], v[120:135]
    v_exp_f32 v75, v75
    v_exp_f32 v76, v76
    v_exp_f32 v77, v77
    v_smfmac_f32_32x32x32_bf16 v[84:99], v[24:27], v[68:75], v7
    v_exp_f32 v78, v78
    v_exp_f32 v79, v79
    v_exp_f32 v80, v80
    v_mfma_f32_32x32x8_bf16 v[52:67], v[14:15], v[12:13], v[52:67]
    v_exp_f32 v81, v81
    v_exp_f32 v82, v82
    v_exp_f32 v83, v83
    s_setprio 0
    s_waitcnt vmcnt(5)
    s_cmp_eq_u32 s22, 0
    s_cbranch_scc1 L_ba22
    s_barrier
L_ba22:
    s_mov_b64 exec, s[46:47]
    ds_read_b128 v[24:27], v6 offset:55040
    ds_read_b128 v[36:39], v6 offset:55680
    s_mov_b64 exec, s[94:95]
    ds_read_b64 v[14:15], v5 offset:51968
    s_mov_b64 exec, -1
    ds_read_b128 v[16:19], v4 offset:54272
    buffer_load_dwordx4 v[208:211], v0, s[28:31], s50 offen sc1
    s_add_u32 s50, s50, 2048
    buffer_load_dwordx4 v[196:199], v0, s[28:31], s49 offen sc1
    s_mov_b32 s32, s8
    s_and_b32 s33, s9, 0xffff
    s_mov_b32 s34, 1280
    s_mov_b32 s35, 0x20000
    s_mov_b32 s36, s10
    s_and_b32 s37, s11, 0xffff
    s_mov_b32 s38, 2621440
    s_mov_b32 s39, 0x20000
    s_lshl_b32 s0, s18, 3
    s_add_u32 s0, s0, s20
    s_mul_i32 s0, s0, 5120
    s_mul_i32 s1, s19, 320
    s_add_u32 s0, s0, s1
    buffer_load_dword v221, v118, s[32:35], s1 offen
    s_cmp_eq_u32 s22, 1
    s_cbranch_scc1 L_bb22
    s_barrier
L_bb22:
    v_exp_f32 v52, v52
    v_smfmac_f32_32x32x32_bf16 v[84:99], v[28:31], v[76:83], v7
    s_setprio 1
    s_waitcnt vmcnt(7) lgkmcnt(0)
    v_exp_f32 v53, v53
    v_exp_f32 v54, v54
    v_exp_f32 v55, v55
    v_mfma_f32_32x32x16_bf16 v[68:83], v[16:19], v[8:11], 0
    s_setprio 2
    v_exp_f32 v56, v56
    v_exp_f32 v57, v57
    v_exp_f32 v58, v58
    v_mfma_f32_32x32x16_bf16 v[136:151], v[180:183], v[200:203], v[136:151]
    v_exp_f32 v59, v59
    v_exp_f32 v60, v60
    v_exp_f32 v61, v61
    v_smfmac_f32_32x32x32_bf16 v[84:99], v[20:23], v[52:59], v7
    v_exp_f32 v62, v62
    v_exp_f32 v63, v63
    v_exp_f32 v64, v64
    v_mfma_f32_32x32x8_bf16 v[68:83], v[14:15], v[12:13], v[68:83]
    v_exp_f32 v65, v65
    v_exp_f32 v66, v66
    v_exp_f32 v67, v67
    v_add_u32 v4, 61440, v4
    v_add_u32 v5, 61440, v5
    v_add_u32 v6, 61440, v6
    s_setprio 0
    s_mov_b64 exec, s[46:47]
    ds_read_b128 v[20:23], v6 offset:0
    ds_read_b128 v[28:31], v6 offset:640
    s_mov_b64 exec, s[94:95]
    ds_read_b64 v[14:15], v5 offset:0
    s_mov_b64 exec, -1
    ds_read_b128 v[16:19], v4 offset:0
    buffer_load_dwordx4 v[168:171], v0, s[28:31], s49 offen offset:1024 sc1
    s_add_u32 s49, s49, 40960
    buffer_load_dword v222, v117, s[24:27], s0 offen
    v_exp_f32 v68, v68
    v_smfmac_f32_32x32x32_bf16 v[84:99], v[32:35], v[60:67], v7
    s_setprio 1
    s_waitcnt vmcnt(8) lgkmcnt(0)
    v_exp_f32 v69, v69
    v_exp_f32 v70, v70
    v_exp_f32 v71, v71
    v_mfma_f32_32x32x16_bf16 v[52:67], v[16:19], v[8:11], 0
    s_setprio 2
    v_exp_f32 v72, v72
    v_exp_f32 v73, v73
    v_exp_f32 v74, v74
    v_mfma_f32_32x32x16_bf16 v[152:167], v[184:187], v[200:203], v[152:167]
    v_exp_f32 v75, v75
    v_exp_f32 v76, v76
    v_exp_f32 v77, v77
    v_smfmac_f32_32x32x32_bf16 v[84:99], v[24:27], v[68:75], v7
    v_exp_f32 v78, v78
    v_exp_f32 v79, v79
    v_exp_f32 v80, v80
    v_mfma_f32_32x32x8_bf16 v[52:67], v[14:15], v[12:13], v[52:67]
    v_exp_f32 v81, v81
    v_exp_f32 v82, v82
    v_exp_f32 v83, v83
    s_setprio 0
    s_mov_b64 exec, s[46:47]
    ds_read_b128 v[24:27], v6 offset:1280
    ds_read_b128 v[32:35], v6 offset:1920
    s_mov_b64 exec, s[94:95]
    ds_read_b64 v[14:15], v5 offset:256
    s_mov_b64 exec, -1
    ds_read_b128 v[16:19], v4 offset:1024
    buffer_load_dwordx4 v[172:175], v0, s[28:31], s52 offen sc1
    s_add_u32 s52, s52, 40960
    buffer_load_dwordx4 v[216:219], v0, s[28:31], s7 offen sc1
    v_exp_f32 v52, v52
    v_smfmac_f32_32x32x32_bf16 v[84:99], v[36:39], v[76:83], v7
    s_setprio 1
    s_waitcnt vmcnt(8) lgkmcnt(0)
    v_exp_f32 v53, v53
    v_exp_f32 v54, v54
    v_exp_f32 v55, v55
    v_mfma_f32_32x32x16_bf16 v[68:83], v[16:19], v[8:11], 0
    s_setprio 2
    v_exp_f32 v56, v56
    v_exp_f32 v57, v57
    v_exp_f32 v58, v58
    v_mfma_f32_32x32x16_bf16 v[120:135], v[188:191], v[204:207], v[120:135]
    v_exp_f32 v59, v59
    v_exp_f32 v60, v60
    v_exp_f32 v61, v61
    v_smfmac_f32_32x32x32_bf16 v[84:99], v[20:23], v[52:59], v7
    v_exp_f32 v62, v62
    v_exp_f32 v63, v63
    v_exp_f32 v64, v64
    v_mfma_f32_32x32x8_bf16 v[68:83], v[14:15], v[12:13], v[68:83]
    v_exp_f32 v65, v65
    v_exp_f32 v66, v66
    v_exp_f32 v67, v67
    s_setprio 0
    s_mov_b64 exec, s[46:47]
    ds_read_b128 v[20:23], v6 offset:2560
    ds_read_b128 v[36:39], v6 offset:3200
    s_mov_b64 exec, s[94:95]
    ds_read_b64 v[14:15], v5 offset:512
    s_mov_b64 exec, -1
    ds_read_b128 v[16:19], v4 offset:2048
    buffer_load_dwordx4 v[212:215], v0, s[28:31], s51 offen sc1
    s_add_u32 s51, s51, 2048
    buffer_load_dwordx4 v[176:179], v0, s[28:31], s48 offen sc1
    s_lshl_b32 s3, s18, 7
    s_add_u32 s3, s3, 22183936
    buffer_load_dword v119, v119, s[28:31], s3 offen sc1
    v_exp_f32 v68, v68
    v_smfmac_f32_32x32x32_bf16 v[84:99], v[28:31], v[60:67], v7
    s_setprio 1
    s_waitcnt vmcnt(10) lgkmcnt(0)
    v_exp_f32 v69, v69
    v_exp_f32 v70, v70
    v_exp_f32 v71, v71
    v_mfma_f32_32x32x16_bf16 v[52:67], v[16:19], v[8:11], 0
    s_setprio 2
    v_exp_f32 v72, v72
    v_exp_f32 v73, v73
    v_exp_f32 v74, v74
    v_mfma_f32_32x32x16_bf16 v[136:151], v[192:195], v[204:207], v[136:151]
    v_exp_f32 v75, v75
    v_exp_f32 v76, v76
    v_exp_f32 v77, v77
    v_smfmac_f32_32x32x32_bf16 v[84:99], v[24:27], v[68:75], v7
    v_exp_f32 v78, v78
    v_exp_f32 v79, v79
    v_exp_f32 v80, v80
    v_mfma_f32_32x32x8_bf16 v[52:67], v[14:15], v[12:13], v[52:67]
    v_exp_f32 v81, v81
    v_exp_f32 v82, v82
    v_exp_f32 v83, v83
    s_setprio 0
    s_mov_b64 exec, s[46:47]
    ds_read_b128 v[24:27], v6 offset:3840
    ds_read_b128 v[28:31], v6 offset:4480
    s_mov_b64 exec, s[94:95]
    ds_read_b64 v[14:15], v5 offset:768
    s_mov_b64 exec, -1
    ds_read_b128 v[16:19], v4 offset:3072
    buffer_load_dwordx4 v[180:183], v0, s[28:31], s48 offen offset:1024 sc1
    s_add_u32 s48, s48, 40960
    buffer_load_dwordx4 v[200:203], v0, s[28:31], s50 offen sc1
    s_add_u32 s50, s50, 2048
    buffer_load_dwordx4 v[184:187], v0, s[28:31], s49 offen sc1
    v_exp_f32 v52, v52
    v_smfmac_f32_32x32x32_bf16 v[84:99], v[32:35], v[76:83], v7
    s_setprio 1
    s_waitcnt vmcnt(11) lgkmcnt(0)
    v_exp_f32 v53, v53
    v_exp_f32 v54, v54
    v_exp_f32 v55, v55
    v_mfma_f32_32x32x16_bf16 v[68:83], v[16:19], v[8:11], 0
    s_setprio 2
    v_exp_f32 v56, v56
    v_exp_f32 v57, v57
    v_exp_f32 v58, v58
    v_mfma_f32_32x32x16_bf16 v[120:135], v[196:199], v[208:211], v[120:135]
    v_exp_f32 v59, v59
    v_exp_f32 v60, v60
    v_exp_f32 v61, v61
    v_smfmac_f32_32x32x32_bf16 v[84:99], v[20:23], v[52:59], v7
    v_exp_f32 v62, v62
    v_exp_f32 v63, v63
    v_exp_f32 v64, v64
    v_mfma_f32_32x32x8_bf16 v[68:83], v[14:15], v[12:13], v[68:83]
    v_exp_f32 v65, v65
    v_exp_f32 v66, v66
    v_exp_f32 v67, v67
    s_setprio 0
    s_mov_b64 exec, s[46:47]
    ds_read_b128 v[20:23], v6 offset:10240
    ds_read_b128 v[32:35], v6 offset:10880
    s_mov_b64 exec, s[94:95]
    ds_read_b64 v[14:15], v5 offset:10240
    s_mov_b64 exec, -1
    ds_read_b128 v[16:19], v4 offset:10240
    buffer_load_dwordx4 v[188:191], v0, s[28:31], s49 offen offset:1024 sc1
    s_add_u32 s49, s49, 40960
    buffer_load_dwordx4 v[216:219], v0, s[28:31], s53 offen sc1
    s_add_u32 s53, s53, 20480
    v_exp_f32 v68, v68
    v_smfmac_f32_32x32x32_bf16 v[84:99], v[36:39], v[60:67], v7
    s_setprio 1
    s_waitcnt vmcnt(11) lgkmcnt(0)
    v_exp_f32 v69, v69
    v_exp_f32 v70, v70
    v_exp_f32 v71, v71
    v_mfma_f32_32x32x16_bf16 v[52:67], v[16:19], v[8:11], 0
    s_setprio 2
    v_exp_f32 v72, v72
    v_exp_f32 v73, v73
    v_exp_f32 v74, v74
    v_mfma_f32_32x32x16_bf16 v[136:151], v[168:171], v[208:211], v[136:151]
    v_exp_f32 v75, v75
    v_exp_f32 v76, v76
    v_exp_f32 v77, v77
    v_smfmac_f32_32x32x32_bf16 v[84:99], v[24:27], v[68:75], v7
    v_exp_f32 v78, v78
    v_exp_f32 v79, v79
    v_exp_f32 v80, v80
    v_mfma_f32_32x32x8_bf16 v[52:67], v[14:15], v[12:13], v[52:67]
    v_exp_f32 v81, v81
    v_exp_f32 v82, v82
    v_exp_f32 v83, v83
    s_setprio 0
    s_mov_b64 exec, s[46:47]
    ds_read_b128 v[24:27], v6 offset:11520
    ds_read_b128 v[36:39], v6 offset:12160
    s_mov_b64 exec, s[94:95]
    ds_read_b64 v[14:15], v5 offset:10496
    s_mov_b64 exec, -1
    ds_read_b128 v[16:19], v4 offset:11264
    buffer_load_dwordx4 v[192:195], v0, s[28:31], s52 offen sc1
    s_add_u32 s52, s52, 40960
    v_exp_f32 v52, v52
    v_smfmac_f32_32x32x32_bf16 v[84:99], v[28:31], v[76:83], v7
    s_setprio 1
    s_waitcnt vmcnt(10) lgkmcnt(0)
    v_exp_f32 v53, v53
    v_exp_f32 v54, v54
    v_exp_f32 v55, v55
    v_mfma_f32_32x32x16_bf16 v[68:83], v[16:19], v[8:11], 0
    s_setprio 2
    v_exp_f32 v56, v56
    v_exp_f32 v57, v57
    v_exp_f32 v58, v58
    v_mfma_f32_32x32x16_bf16 v[152:167], v[172:175], v[208:211], v[152:167]
    v_exp_f32 v59, v59
    v_exp_f32 v60, v60
    v_exp_f32 v61, v61
    v_smfmac_f32_32x32x32_bf16 v[84:99], v[20:23], v[52:59], v7
    v_exp_f32 v62, v62
    v_exp_f32 v63, v63
    v_exp_f32 v64, v64
    v_mfma_f32_32x32x8_bf16 v[68:83], v[14:15], v[12:13], v[68:83]
    v_exp_f32 v65, v65
    v_exp_f32 v66, v66
    v_exp_f32 v67, v67
    s_setprio 0
    s_mov_b64 exec, s[46:47]
    ds_read_b128 v[20:23], v6 offset:12800
    ds_read_b128 v[28:31], v6 offset:13440
    s_mov_b64 exec, s[94:95]
    ds_read_b64 v[14:15], v5 offset:10752
    s_mov_b64 exec, -1
    ds_read_b128 v[16:19], v4 offset:12288
    buffer_load_dwordx4 v[204:207], v0, s[28:31], s51 offen sc1
    s_add_u32 s51, s51, 2048
    buffer_load_dwordx4 v[196:199], v0, s[28:31], s48 offen sc1
    buffer_load_dwordx4 v[220:223], v0, s[28:31], s53 offen sc1
    s_add_u32 s53, s53, 20480
    v_exp_f32 v68, v68
    v_smfmac_f32_32x32x32_bf16 v[84:99], v[32:35], v[60:67], v7
    s_setprio 1
    s_waitcnt vmcnt(10) lgkmcnt(0)
    v_exp_f32 v69, v69
    v_exp_f32 v70, v70
    v_exp_f32 v71, v71
    v_mfma_f32_32x32x16_bf16 v[52:67], v[16:19], v[8:11], 0
    s_setprio 2
    v_exp_f32 v72, v72
    v_exp_f32 v73, v73
    v_exp_f32 v74, v74
    v_mfma_f32_32x32x16_bf16 v[120:135], v[176:179], v[212:215], v[120:135]
    v_exp_f32 v75, v75
    v_exp_f32 v76, v76
    v_exp_f32 v77, v77
    v_smfmac_f32_32x32x32_bf16 v[84:99], v[24:27], v[68:75], v7
    v_exp_f32 v78, v78
    v_exp_f32 v79, v79
    v_exp_f32 v80, v80
    v_mfma_f32_32x32x8_bf16 v[52:67], v[14:15], v[12:13], v[52:67]
    v_exp_f32 v81, v81
    v_exp_f32 v82, v82
    v_exp_f32 v83, v83
    s_setprio 0
    s_mov_b64 exec, s[46:47]
    ds_read_b128 v[24:27], v6 offset:14080
    ds_read_b128 v[32:35], v6 offset:14720
    s_mov_b64 exec, s[94:95]
    ds_read_b64 v[14:15], v5 offset:11008
    s_mov_b64 exec, -1
    ds_read_b128 v[16:19], v4 offset:13312
    buffer_load_dwordx4 v[168:171], v0, s[28:31], s48 offen offset:1024 sc1
    s_add_u32 s48, s48, 40960
    v_exp_f32 v52, v52
    v_smfmac_f32_32x32x32_bf16 v[84:99], v[36:39], v[76:83], v7
    s_setprio 1
    s_waitcnt vmcnt(9) lgkmcnt(0)
    v_exp_f32 v53, v53
    v_exp_f32 v54, v54
    v_exp_f32 v55, v55
    v_mfma_f32_32x32x16_bf16 v[68:83], v[16:19], v[8:11], 0
    s_setprio 2
    v_exp_f32 v56, v56
    v_exp_f32 v57, v57
    v_exp_f32 v58, v58
    v_mfma_f32_32x32x16_bf16 v[136:151], v[180:183], v[212:215], v[136:151]
    v_exp_f32 v59, v59
    v_exp_f32 v60, v60
    v_exp_f32 v61, v61
    v_smfmac_f32_32x32x32_bf16 v[84:99], v[20:23], v[52:59], v7
    v_exp_f32 v62, v62
    v_exp_f32 v63, v63
    v_exp_f32 v64, v64
    v_mfma_f32_32x32x8_bf16 v[68:83], v[14:15], v[12:13], v[68:83]
    v_exp_f32 v65, v65
    v_exp_f32 v66, v66
    v_exp_f32 v67, v67
    s_setprio 0
    s_mov_b64 exec, s[46:47]
    ds_read_b128 v[20:23], v6 offset:20480
    ds_read_b128 v[36:39], v6 offset:21120
    s_mov_b64 exec, s[94:95]
    ds_read_b64 v[14:15], v5 offset:20480
    s_mov_b64 exec, -1
    ds_read_b128 v[16:19], v4 offset:20480
    buffer_load_dwordx4 v[208:211], v0, s[28:31], s50 offen sc1
    s_add_u32 s50, s50, 2048
    buffer_load_dwordx4 v[172:175], v0, s[28:31], s49 offen sc1
    buffer_load_dwordx4 v[176:179], v0, s[28:31], s49 offen offset:1024 sc1
    s_add_u32 s49, s49, 40960
    buffer_load_dwordx4 v[224:227], v0, s[28:31], s53 offen sc1
    s_add_u32 s53, s53, 20480
    v_exp_f32 v68, v68
    v_smfmac_f32_32x32x32_bf16 v[84:99], v[28:31], v[60:67], v7
    s_setprio 1
    s_waitcnt vmcnt(11) lgkmcnt(0)
    v_exp_f32 v69, v69
    v_exp_f32 v70, v70
    v_exp_f32 v71, v71
    v_mfma_f32_32x32x16_bf16 v[52:67], v[16:19], v[8:11], 0
    s_setprio 2
    v_exp_f32 v72, v72
    v_exp_f32 v73, v73
    v_exp_f32 v74, v74
    v_mfma_f32_32x32x16_bf16 v[120:135], v[184:187], v[200:203], v[120:135]
    v_exp_f32 v75, v75
    v_exp_f32 v76, v76
    v_exp_f32 v77, v77
    v_smfmac_f32_32x32x32_bf16 v[84:99], v[24:27], v[68:75], v7
    v_exp_f32 v78, v78
    v_exp_f32 v79, v79
    v_exp_f32 v80, v80
    v_mfma_f32_32x32x8_bf16 v[52:67], v[14:15], v[12:13], v[52:67]
    v_exp_f32 v81, v81
    v_exp_f32 v82, v82
    v_exp_f32 v83, v83
    s_setprio 0
    s_mov_b64 exec, s[46:47]
    ds_read_b128 v[24:27], v6 offset:21760
    ds_read_b128 v[28:31], v6 offset:22400
    s_mov_b64 exec, s[94:95]
    ds_read_b64 v[14:15], v5 offset:20736
    s_mov_b64 exec, -1
    ds_read_b128 v[16:19], v4 offset:21504
    buffer_load_dwordx4 v[180:183], v0, s[28:31], s52 offen sc1
    s_add_u32 s52, s52, 40960
    v_exp_f32 v52, v52
    v_smfmac_f32_32x32x32_bf16 v[84:99], v[32:35], v[76:83], v7
    s_setprio 1
    s_waitcnt vmcnt(11) lgkmcnt(0)
    v_exp_f32 v53, v53
    v_exp_f32 v54, v54
    v_exp_f32 v55, v55
    v_mfma_f32_32x32x16_bf16 v[68:83], v[16:19], v[8:11], 0
    s_setprio 2
    v_exp_f32 v56, v56
    v_exp_f32 v57, v57
    v_exp_f32 v58, v58
    v_mfma_f32_32x32x16_bf16 v[136:151], v[188:191], v[200:203], v[136:151]
    v_exp_f32 v59, v59
    v_exp_f32 v60, v60
    v_exp_f32 v61, v61
    v_smfmac_f32_32x32x32_bf16 v[84:99], v[20:23], v[52:59], v7
    v_exp_f32 v62, v62
    v_exp_f32 v63, v63
    v_exp_f32 v64, v64
    v_mfma_f32_32x32x8_bf16 v[68:83], v[14:15], v[12:13], v[68:83]
    v_exp_f32 v65, v65
    v_exp_f32 v66, v66
    v_exp_f32 v67, v67
    s_setprio 0
    s_mov_b64 exec, s[46:47]
    ds_read_b128 v[20:23], v6 offset:23040
    ds_read_b128 v[32:35], v6 offset:23680
    s_mov_b64 exec, s[94:95]
    ds_read_b64 v[14:15], v5 offset:20992
    s_mov_b64 exec, -1
    ds_read_b128 v[16:19], v4 offset:22528
    buffer_load_dwordx4 v[212:215], v0, s[28:31], s51 offen sc1
    s_add_u32 s51, s51, 2048
    buffer_load_dwordx4 v[184:187], v0, s[28:31], s48 offen sc1
    buffer_load_dwordx4 v[228:231], v0, s[28:31], s53 offen sc1
    s_add_u32 s53, s53, 20480
    v_exp_f32 v68, v68
    v_smfmac_f32_32x32x32_bf16 v[84:99], v[36:39], v[60:67], v7
    s_setprio 1
    s_waitcnt vmcnt(12) lgkmcnt(0)
    v_exp_f32 v69, v69
    v_exp_f32 v70, v70
    v_exp_f32 v71, v71
    v_mfma_f32_32x32x16_bf16 v[52:67], v[16:19], v[8:11], 0
    s_setprio 2
    v_exp_f32 v72, v72
    v_exp_f32 v73, v73
    v_exp_f32 v74, v74
    v_mfma_f32_32x32x16_bf16 v[152:167], v[192:195], v[200:203], v[152:167]
    v_exp_f32 v75, v75
    v_exp_f32 v76, v76
    v_exp_f32 v77, v77
    v_smfmac_f32_32x32x32_bf16 v[84:99], v[24:27], v[68:75], v7
    v_exp_f32 v78, v78
    v_exp_f32 v79, v79
    v_exp_f32 v80, v80
    v_mfma_f32_32x32x8_bf16 v[52:67], v[14:15], v[12:13], v[52:67]
    v_exp_f32 v81, v81
    v_exp_f32 v82, v82
    v_exp_f32 v83, v83
    s_setprio 0
    s_mov_b64 exec, s[46:47]
    ds_read_b128 v[24:27], v6 offset:24320
    ds_read_b128 v[36:39], v6 offset:24960
    s_mov_b64 exec, s[94:95]
    ds_read_b64 v[14:15], v5 offset:21248
    s_mov_b64 exec, -1
    ds_read_b128 v[16:19], v4 offset:23552
    buffer_load_dwordx4 v[188:191], v0, s[28:31], s48 offen offset:1024 sc1
    s_add_u32 s48, s48, 40960
    v_exp_f32 v52, v52
    v_smfmac_f32_32x32x32_bf16 v[84:99], v[28:31], v[76:83], v7
    s_setprio 1
    s_waitcnt vmcnt(11) lgkmcnt(0)
    v_exp_f32 v53, v53
    v_exp_f32 v54, v54
    v_exp_f32 v55, v55
    v_mfma_f32_32x32x16_bf16 v[68:83], v[16:19], v[8:11], 0
    s_setprio 2
    v_exp_f32 v56, v56
    v_exp_f32 v57, v57
    v_exp_f32 v58, v58
    v_mfma_f32_32x32x16_bf16 v[120:135], v[196:199], v[204:207], v[120:135]
    v_exp_f32 v59, v59
    v_exp_f32 v60, v60
    v_exp_f32 v61, v61
    v_smfmac_f32_32x32x32_bf16 v[84:99], v[20:23], v[52:59], v7
    v_exp_f32 v62, v62
    v_exp_f32 v63, v63
    v_exp_f32 v64, v64
    v_mfma_f32_32x32x8_bf16 v[68:83], v[14:15], v[12:13], v[68:83]
    v_exp_f32 v65, v65
    v_exp_f32 v66, v66
    v_exp_f32 v67, v67
    s_setprio 0
    s_mov_b64 exec, s[46:47]
    ds_read_b128 v[20:23], v6 offset:30720
    ds_read_b128 v[28:31], v6 offset:31360
    s_mov_b64 exec, s[94:95]
    ds_read_b64 v[14:15], v5 offset:30720
    s_mov_b64 exec, -1
    ds_read_b128 v[16:19], v4 offset:30720
    buffer_load_dwordx4 v[200:203], v0, s[28:31], s50 offen sc1
    s_add_u32 s50, s50, 2048
    buffer_load_dwordx4 v[192:195], v0, s[28:31], s49 offen sc1
    buffer_load_dwordx4 v[232:235], v0, s[28:31], s53 offen sc1
    s_add_u32 s53, s53, 20480
    v_exp_f32 v68, v68
    v_smfmac_f32_32x32x32_bf16 v[84:99], v[32:35], v[60:67], v7
    s_setprio 1
    s_waitcnt vmcnt(12) lgkmcnt(0)
    v_exp_f32 v69, v69
    v_exp_f32 v70, v70
    v_exp_f32 v71, v71
    v_mfma_f32_32x32x16_bf16 v[52:67], v[16:19], v[8:11], 0
    s_setprio 2
    v_exp_f32 v72, v72
    v_exp_f32 v73, v73
    v_exp_f32 v74, v74
    v_mfma_f32_32x32x16_bf16 v[136:151], v[168:171], v[204:207], v[136:151]
    v_exp_f32 v75, v75
    v_exp_f32 v76, v76
    v_exp_f32 v77, v77
    v_smfmac_f32_32x32x32_bf16 v[84:99], v[24:27], v[68:75], v7
    v_exp_f32 v78, v78
    v_exp_f32 v79, v79
    v_exp_f32 v80, v80
    v_mfma_f32_32x32x8_bf16 v[52:67], v[14:15], v[12:13], v[52:67]
    v_exp_f32 v81, v81
    v_exp_f32 v82, v82
    v_exp_f32 v83, v83
    s_setprio 0
    s_mov_b64 exec, s[46:47]
    ds_read_b128 v[24:27], v6 offset:32000
    ds_read_b128 v[32:35], v6 offset:32640
    s_mov_b64 exec, s[94:95]
    ds_read_b64 v[14:15], v5 offset:30976
    s_mov_b64 exec, -1
    ds_read_b128 v[16:19], v4 offset:31744
    buffer_load_dwordx4 v[196:199], v0, s[28:31], s49 offen offset:1024 sc1
    s_add_u32 s49, s49, 40960
    buffer_load_dwordx4 v[168:171], v0, s[28:31], s52 offen sc1
    s_add_u32 s52, s52, 40960
    v_exp_f32 v52, v52
    v_smfmac_f32_32x32x32_bf16 v[84:99], v[36:39], v[76:83], v7
    s_setprio 1
    s_waitcnt vmcnt(12) lgkmcnt(0)
    v_exp_f32 v53, v53
    v_exp_f32 v54, v54
    v_exp_f32 v55, v55
    v_mfma_f32_32x32x16_bf16 v[68:83], v[16:19], v[8:11], 0
    s_setprio 2
    v_exp_f32 v56, v56
    v_exp_f32 v57, v57
    v_exp_f32 v58, v58
    v_mfma_f32_32x32x16_bf16 v[120:135], v[172:175], v[208:211], v[120:135]
    v_exp_f32 v59, v59
    v_exp_f32 v60, v60
    v_exp_f32 v61, v61
    v_smfmac_f32_32x32x32_bf16 v[84:99], v[20:23], v[52:59], v7
    v_exp_f32 v62, v62
    v_exp_f32 v63, v63
    v_exp_f32 v64, v64
    v_mfma_f32_32x32x8_bf16 v[68:83], v[14:15], v[12:13], v[68:83]
    v_exp_f32 v65, v65
    v_exp_f32 v66, v66
    v_exp_f32 v67, v67
    s_setprio 0
    s_mov_b64 exec, s[46:47]
    ds_read_b128 v[20:23], v6 offset:33280
    ds_read_b128 v[36:39], v6 offset:33920
    s_mov_b64 exec, s[94:95]
    ds_read_b64 v[14:15], v5 offset:31232
    s_mov_b64 exec, -1
    ds_read_b128 v[16:19], v4 offset:32768
    buffer_load_dwordx4 v[204:207], v0, s[28:31], s51 offen sc1
    s_add_u32 s51, s51, 2048
    buffer_load_dwordx4 v[172:175], v0, s[28:31], s48 offen sc1
    buffer_load_dwordx4 v[236:239], v0, s[28:31], s53 offen sc1
    s_add_u32 s53, s53, 20480
    v_exp_f32 v68, v68
    v_smfmac_f32_32x32x32_bf16 v[84:99], v[28:31], v[60:67], v7
    s_setprio 1
    s_waitcnt vmcnt(14) lgkmcnt(0)
    v_exp_f32 v69, v69
    v_exp_f32 v70, v70
    v_exp_f32 v71, v71
    v_mfma_f32_32x32x16_bf16 v[52:67], v[16:19], v[8:11], 0
    s_setprio 2
    v_exp_f32 v72, v72
    v_exp_f32 v73, v73
    v_exp_f32 v74, v74
    v_mfma_f32_32x32x16_bf16 v[136:151], v[176:179], v[208:211], v[136:151]
    v_exp_f32 v75, v75
    v_exp_f32 v76, v76
    v_exp_f32 v77, v77
    v_smfmac_f32_32x32x32_bf16 v[84:99], v[24:27], v[68:75], v7
    v_exp_f32 v78, v78
    v_exp_f32 v79, v79
    v_exp_f32 v80, v80
    v_mfma_f32_32x32x8_bf16 v[52:67], v[14:15], v[12:13], v[52:67]
    v_exp_f32 v81, v81
    v_exp_f32 v82, v82
    v_exp_f32 v83, v83
    s_setprio 0
    s_mov_b64 exec, s[46:47]
    ds_read_b128 v[24:27], v6 offset:34560
    ds_read_b128 v[28:31], v6 offset:35200
    s_mov_b64 exec, s[94:95]
    ds_read_b64 v[14:15], v5 offset:31488
    s_mov_b64 exec, -1
    ds_read_b128 v[16:19], v4 offset:33792
    buffer_load_dwordx4 v[176:179], v0, s[28:31], s48 offen offset:1024 sc1
    s_add_u32 s48, s48, 40960
    v_exp_f32 v52, v52
    v_smfmac_f32_32x32x32_bf16 v[84:99], v[32:35], v[76:83], v7
    s_setprio 1
    s_waitcnt vmcnt(13) lgkmcnt(0)
    v_exp_f32 v53, v53
    v_exp_f32 v54, v54
    v_exp_f32 v55, v55
    v_mfma_f32_32x32x16_bf16 v[68:83], v[16:19], v[8:11], 0
    s_setprio 2
    v_exp_f32 v56, v56
    v_exp_f32 v57, v57
    v_exp_f32 v58, v58
    v_mfma_f32_32x32x16_bf16 v[152:167], v[180:183], v[208:211], v[152:167]
    v_exp_f32 v59, v59
    v_exp_f32 v60, v60
    v_exp_f32 v61, v61
    v_smfmac_f32_32x32x32_bf16 v[84:99], v[20:23], v[52:59], v7
    v_exp_f32 v62, v62
    v_exp_f32 v63, v63
    v_exp_f32 v64, v64
    v_mfma_f32_32x32x8_bf16 v[68:83], v[14:15], v[12:13], v[68:83]
    v_exp_f32 v65, v65
    v_exp_f32 v66, v66
    v_exp_f32 v67, v67
    s_setprio 0
    s_mov_b64 exec, s[46:47]
    ds_read_b128 v[20:23], v6 offset:40960
    ds_read_b128 v[32:35], v6 offset:41600
    s_mov_b64 exec, s[94:95]
    ds_read_b64 v[14:15], v5 offset:40960
    s_mov_b64 exec, -1
    ds_read_b128 v[16:19], v4 offset:40960
    buffer_load_dwordx4 v[208:211], v0, s[28:31], s50 offen sc1
    s_add_u32 s50, s50, 2048
    buffer_load_dwordx4 v[180:183], v0, s[28:31], s49 offen sc1
    buffer_load_dwordx4 v[240:243], v0, s[28:31], s53 offen sc1
    s_add_u32 s53, s53, 20480
    v_exp_f32 v68, v68
    v_smfmac_f32_32x32x32_bf16 v[84:99], v[36:39], v[60:67], v7
    s_setprio 1
    s_waitcnt vmcnt(14) lgkmcnt(0)
    v_exp_f32 v69, v69
    v_exp_f32 v70, v70
    v_exp_f32 v71, v71
    v_mfma_f32_32x32x16_bf16 v[52:67], v[16:19], v[8:11], 0
    s_setprio 2
    v_exp_f32 v72, v72
    v_exp_f32 v73, v73
    v_exp_f32 v74, v74
    v_mfma_f32_32x32x16_bf16 v[120:135], v[184:187], v[212:215], v[120:135]
    v_exp_f32 v75, v75
    v_exp_f32 v76, v76
    v_exp_f32 v77, v77
    v_smfmac_f32_32x32x32_bf16 v[84:99], v[24:27], v[68:75], v7
    v_exp_f32 v78, v78
    v_exp_f32 v79, v79
    v_exp_f32 v80, v80
    v_mfma_f32_32x32x8_bf16 v[52:67], v[14:15], v[12:13], v[52:67]
    v_exp_f32 v81, v81
    v_exp_f32 v82, v82
    v_exp_f32 v83, v83
    s_setprio 0
    s_mov_b64 exec, s[46:47]
    ds_read_b128 v[24:27], v6 offset:42240
    ds_read_b128 v[36:39], v6 offset:42880
    s_mov_b64 exec, s[94:95]
    ds_read_b64 v[14:15], v5 offset:41216
    s_mov_b64 exec, -1
    ds_read_b128 v[16:19], v4 offset:41984
    buffer_load_dwordx4 v[184:187], v0, s[28:31], s49 offen offset:1024 sc1
    s_add_u32 s49, s49, 40960
    v_exp_f32 v52, v52
    v_smfmac_f32_32x32x32_bf16 v[84:99], v[28:31], v[76:83], v7
    s_setprio 1
    s_waitcnt vmcnt(13) lgkmcnt(0)
    v_exp_f32 v53, v53
    v_exp_f32 v54, v54
    v_exp_f32 v55, v55
    v_mfma_f32_32x32x16_bf16 v[68:83], v[16:19], v[8:11], 0
    s_setprio 2
    v_exp_f32 v56, v56
    v_exp_f32 v57, v57
    v_exp_f32 v58, v58
    v_mfma_f32_32x32x16_bf16 v[136:151], v[188:191], v[212:215], v[136:151]
    v_exp_f32 v59, v59
    v_exp_f32 v60, v60
    v_exp_f32 v61, v61
    v_smfmac_f32_32x32x32_bf16 v[84:99], v[20:23], v[52:59], v7
    v_exp_f32 v62, v62
    v_exp_f32 v63, v63
    v_exp_f32 v64, v64
    v_mfma_f32_32x32x8_bf16 v[68:83], v[14:15], v[12:13], v[68:83]
    v_exp_f32 v65, v65
    v_exp_f32 v66, v66
    v_exp_f32 v67, v67
    s_setprio 0
    s_mov_b64 exec, s[46:47]
    ds_read_b128 v[20:23], v6 offset:43520
    ds_read_b128 v[28:31], v6 offset:44160
    s_mov_b64 exec, s[94:95]
    ds_read_b64 v[14:15], v5 offset:41472
    s_mov_b64 exec, -1
    ds_read_b128 v[16:19], v4 offset:43008
    buffer_load_dwordx4 v[188:191], v0, s[28:31], s52 offen sc1
    s_add_u32 s52, s52, 40960
    buffer_load_dwordx4 v[244:247], v0, s[28:31], s53 offen sc1
    s_add_u32 s53, s53, 20480
    v_exp_f32 v68, v68
    v_smfmac_f32_32x32x32_bf16 v[84:99], v[32:35], v[60:67], v7
    s_setprio 1
    s_waitcnt vmcnt(13) lgkmcnt(0)
    v_exp_f32 v69, v69
    v_exp_f32 v70, v70
    v_exp_f32 v71, v71
    v_mfma_f32_32x32x16_bf16 v[52:67], v[16:19], v[8:11], 0
    s_setprio 2
    v_exp_f32 v72, v72
    v_exp_f32 v73, v73
    v_exp_f32 v74, v74
    v_mfma_f32_32x32x16_bf16 v[120:135], v[192:195], v[200:203], v[120:135]
    v_exp_f32 v75, v75
    v_exp_f32 v76, v76
    v_exp_f32 v77, v77
    v_smfmac_f32_32x32x32_bf16 v[84:99], v[24:27], v[68:75], v7
    v_exp_f32 v78, v78
    v_exp_f32 v79, v79
    v_exp_f32 v80, v80
    v_mfma_f32_32x32x8_bf16 v[52:67], v[14:15], v[12:13], v[52:67]
    v_exp_f32 v81, v81
    v_exp_f32 v82, v82
    v_exp_f32 v83, v83
    s_setprio 0
    s_mov_b64 exec, s[46:47]
    ds_read_b128 v[24:27], v6 offset:44800
    ds_read_b128 v[32:35], v6 offset:45440
    s_mov_b64 exec, s[94:95]
    ds_read_b64 v[14:15], v5 offset:41728
    s_mov_b64 exec, -1
    ds_read_b128 v[16:19], v4 offset:44032
    buffer_load_dwordx4 v[212:215], v0, s[28:31], s51 offen sc1
    s_add_u32 s51, s51, 2048
    buffer_load_dwordx4 v[192:195], v0, s[28:31], s48 offen sc1
    v_exp_f32 v52, v52
    v_smfmac_f32_32x32x32_bf16 v[84:99], v[36:39], v[76:83], v7
    s_setprio 1
    s_waitcnt vmcnt(13) lgkmcnt(0)
    v_exp_f32 v53, v53
    v_exp_f32 v54, v54
    v_exp_f32 v55, v55
    v_mfma_f32_32x32x16_bf16 v[68:83], v[16:19], v[8:11], 0
    s_setprio 2
    v_exp_f32 v56, v56
    v_exp_f32 v57, v57
    v_exp_f32 v58, v58
    v_mfma_f32_32x32x16_bf16 v[136:151], v[196:199], v[200:203], v[136:151]
    v_exp_f32 v59, v59
    v_exp_f32 v60, v60
    v_exp_f32 v61, v61
    v_smfmac_f32_32x32x32_bf16 v[84:99], v[20:23], v[52:59], v7
    v_exp_f32 v62, v62
    v_exp_f32 v63, v63
    v_exp_f32 v64, v64
    v_mfma_f32_32x32x8_bf16 v[68:83], v[14:15], v[12:13], v[68:83]
    v_exp_f32 v65, v65
    v_exp_f32 v66, v66
    v_exp_f32 v67, v67
    s_setprio 0
    s_mov_b64 exec, s[46:47]
    ds_read_b128 v[20:23], v6 offset:51200
    ds_read_b128 v[36:39], v6 offset:51840
    s_mov_b64 exec, s[94:95]
    ds_read_b64 v[14:15], v5 offset:51200
    s_mov_b64 exec, -1
    ds_read_b128 v[16:19], v4 offset:51200
    buffer_load_dwordx4 v[196:199], v0, s[28:31], s48 offen offset:1024 sc1
    s_add_u32 s48, s48, 40960
    buffer_load_dwordx4 v[248:251], v0, s[28:31], s53 offen sc1
    s_add_u32 s53, s53, 20480
    v_exp_f32 v68, v68
    v_smfmac_f32_32x32x32_bf16 v[84:99], v[28:31], v[60:67], v7
    s_setprio 1
    s_waitcnt vmcnt(14) lgkmcnt(0)
    v_exp_f32 v69, v69
    v_exp_f32 v70, v70
    v_exp_f32 v71, v71
    v_mfma_f32_32x32x16_bf16 v[52:67], v[16:19], v[8:11], 0
    s_setprio 2
    v_exp_f32 v72, v72
    v_exp_f32 v73, v73
    v_exp_f32 v74, v74
    v_mfma_f32_32x32x16_bf16 v[152:167], v[168:171], v[200:203], v[152:167]
    v_exp_f32 v75, v75
    v_exp_f32 v76, v76
    v_exp_f32 v77, v77
    v_smfmac_f32_32x32x32_bf16 v[84:99], v[24:27], v[68:75], v7
    v_exp_f32 v78, v78
    v_exp_f32 v79, v79
    v_exp_f32 v80, v80
    v_mfma_f32_32x32x8_bf16 v[52:67], v[14:15], v[12:13], v[52:67]
    v_exp_f32 v81, v81
    v_exp_f32 v82, v82
    v_exp_f32 v83, v83
    s_setprio 0
    s_mov_b64 exec, s[46:47]
    ds_read_b128 v[24:27], v6 offset:52480
    ds_read_b128 v[28:31], v6 offset:53120
    s_mov_b64 exec, s[94:95]
    ds_read_b64 v[14:15], v5 offset:51456
    s_mov_b64 exec, -1
    ds_read_b128 v[16:19], v4 offset:52224
    buffer_load_dwordx4 v[200:203], v0, s[28:31], s50 offen sc1
    s_add_u32 s50, s50, 2048
    buffer_load_dwordx4 v[168:171], v0, s[28:31], s49 offen sc1
    v_exp_f32 v52, v52
    v_smfmac_f32_32x32x32_bf16 v[84:99], v[32:35], v[76:83], v7
    s_setprio 1
    s_waitcnt vmcnt(14) lgkmcnt(0)
    v_exp_f32 v53, v53
    v_exp_f32 v54, v54
    v_exp_f32 v55, v55
    v_mfma_f32_32x32x16_bf16 v[68:83], v[16:19], v[8:11], 0
    s_setprio 2
    v_exp_f32 v56, v56
    v_exp_f32 v57, v57
    v_exp_f32 v58, v58
    v_mfma_f32_32x32x16_bf16 v[120:135], v[172:175], v[204:207], v[120:135]
    v_exp_f32 v59, v59
    v_exp_f32 v60, v60
    v_exp_f32 v61, v61
    v_smfmac_f32_32x32x32_bf16 v[84:99], v[20:23], v[52:59], v7
    v_exp_f32 v62, v62
    v_exp_f32 v63, v63
    v_exp_f32 v64, v64
    v_mfma_f32_32x32x8_bf16 v[68:83], v[14:15], v[12:13], v[68:83]
    v_exp_f32 v65, v65
    v_exp_f32 v66, v66
    v_exp_f32 v67, v67
    s_setprio 0
    s_mov_b64 exec, s[46:47]
    ds_read_b128 v[20:23], v6 offset:53760
    ds_read_b128 v[32:35], v6 offset:54400
    s_mov_b64 exec, s[94:95]
    ds_read_b64 v[14:15], v5 offset:51712
    s_mov_b64 exec, -1
    ds_read_b128 v[16:19], v4 offset:53248
    buffer_load_dwordx4 v[172:175], v0, s[28:31], s49 offen offset:1024 sc1
    s_add_u32 s49, s49, 40960
    buffer_load_dwordx4 v[252:255], v0, s[28:31], s53 offen sc1
    s_add_u32 s53, s53, 20480
    v_exp_f32 v68, v68
    v_smfmac_f32_32x32x32_bf16 v[84:99], v[36:39], v[60:67], v7
    s_setprio 1
    s_waitcnt vmcnt(14) lgkmcnt(0)
    v_exp_f32 v69, v69
    v_exp_f32 v70, v70
    v_exp_f32 v71, v71
    v_mfma_f32_32x32x16_bf16 v[52:67], v[16:19], v[8:11], 0
    s_setprio 2
    v_exp_f32 v72, v72
    v_exp_f32 v73, v73
    v_exp_f32 v74, v74
    v_mfma_f32_32x32x16_bf16 v[136:151], v[176:179], v[204:207], v[136:151]
    v_exp_f32 v75, v75
    v_exp_f32 v76, v76
    v_exp_f32 v77, v77
    v_smfmac_f32_32x32x32_bf16 v[84:99], v[24:27], v[68:75], v7
    v_exp_f32 v78, v78
    v_exp_f32 v79, v79
    v_exp_f32 v80, v80
    v_mfma_f32_32x32x8_bf16 v[52:67], v[14:15], v[12:13], v[52:67]
    v_exp_f32 v81, v81
    v_exp_f32 v82, v82
    v_exp_f32 v83, v83
    s_setprio 0
    s_mov_b64 exec, s[46:47]
    ds_read_b128 v[24:27], v6 offset:55040
    ds_read_b128 v[36:39], v6 offset:55680
    s_mov_b64 exec, s[94:95]
    ds_read_b64 v[14:15], v5 offset:51968
    s_mov_b64 exec, -1
    ds_read_b128 v[16:19], v4 offset:54272
    buffer_load_dwordx4 v[176:179], v0, s[28:31], s52 offen sc1
    s_add_u32 s52, s52, 40960
    v_exp_f32 v52, v52
    v_smfmac_f32_32x32x32_bf16 v[84:99], v[28:31], v[76:83], v7
    s_setprio 1
    s_waitcnt vmcnt(13) lgkmcnt(0)
    v_exp_f32 v53, v53
    v_exp_f32 v54, v54
    v_exp_f32 v55, v55
    v_mfma_f32_32x32x16_bf16 v[68:83], v[16:19], v[8:11], 0
    s_setprio 2
    v_exp_f32 v56, v56
    v_exp_f32 v57, v57
    v_exp_f32 v58, v58
    v_mfma_f32_32x32x16_bf16 v[120:135], v[180:183], v[208:211], v[120:135]
    v_exp_f32 v59, v59
    v_exp_f32 v60, v60
    v_exp_f32 v61, v61
    v_smfmac_f32_32x32x32_bf16 v[84:99], v[20:23], v[52:59], v7
    v_exp_f32 v62, v62
    v_exp_f32 v63, v63
    v_exp_f32 v64, v64
    v_mfma_f32_32x32x8_bf16 v[68:83], v[14:15], v[12:13], v[68:83]
    v_exp_f32 v65, v65
    v_exp_f32 v66, v66
    v_exp_f32 v67, v67
    v_add_u32 v4, 61440, v4
    v_add_u32 v5, 61440, v5
    v_add_u32 v6, 61440, v6
    s_setprio 0
    s_mov_b64 exec, s[46:47]
    ds_read_b128 v[20:23], v6 offset:0
    ds_read_b128 v[28:31], v6 offset:640
    s_mov_b64 exec, s[94:95]
    ds_read_b64 v[14:15], v5 offset:0
    s_mov_b64 exec, -1
    ds_read_b128 v[16:19], v4 offset:0
    buffer_load_dwordx4 v[204:207], v0, s[28:31], s51 offen sc1
    s_add_u32 s51, s51, 2048
    buffer_load_dwordx4 v[180:183], v0, s[28:31], s48 offen sc1
    buffer_load_dwordx4 v[100:103], v0, s[28:31], s54 offen sc1
    s_add_u32 s54, s54, 20480
    v_exp_f32 v68, v68
    v_smfmac_f32_32x32x32_bf16 v[84:99], v[32:35], v[60:67], v7
    s_setprio 1
    s_waitcnt vmcnt(14) lgkmcnt(0)
    v_exp_f32 v69, v69
    v_exp_f32 v70, v70
    v_exp_f32 v71, v71
    v_mfma_f32_32x32x16_bf16 v[52:67], v[16:19], v[8:11], 0
    s_setprio 2
    v_exp_f32 v72, v72
    v_exp_f32 v73, v73
    v_exp_f32 v74, v74
    v_mfma_f32_32x32x16_bf16 v[136:151], v[184:187], v[208:211], v[136:151]
    v_exp_f32 v75, v75
    v_exp_f32 v76, v76
    v_exp_f32 v77, v77
    v_smfmac_f32_32x32x32_bf16 v[84:99], v[24:27], v[68:75], v7
    v_exp_f32 v78, v78
    v_exp_f32 v79, v79
    v_exp_f32 v80, v80
    v_mfma_f32_32x32x8_bf16 v[52:67], v[14:15], v[12:13], v[52:67]
    v_exp_f32 v81, v81
    v_exp_f32 v82, v82
    v_exp_f32 v83, v83
    s_setprio 0
    s_mov_b64 exec, s[46:47]
    ds_read_b128 v[24:27], v6 offset:1280
    ds_read_b128 v[32:35], v6 offset:1920
    s_mov_b64 exec, s[94:95]
    ds_read_b64 v[14:15], v5 offset:256
    s_mov_b64 exec, -1
    ds_read_b128 v[16:19], v4 offset:1024
    buffer_load_dwordx4 v[184:187], v0, s[28:31], s48 offen offset:1024 sc1
    s_add_u32 s48, s48, 40960
    v_exp_f32 v52, v52
    v_smfmac_f32_32x32x32_bf16 v[84:99], v[36:39], v[76:83], v7
    s_setprio 1
    s_waitcnt vmcnt(14) lgkmcnt(0)
    v_exp_f32 v53, v53
    v_exp_f32 v54, v54
    v_exp_f32 v55, v55
    v_mfma_f32_32x32x16_bf16 v[68:83], v[16:19], v[8:11], 0
    s_setprio 2
    v_exp_f32 v56, v56
    v_exp_f32 v57, v57
    v_exp_f32 v58, v58
    v_mfma_f32_32x32x16_bf16 v[152:167], v[188:191], v[208:211], v[152:167]
    v_exp_f32 v59, v59
    v_exp_f32 v60, v60
    v_exp_f32 v61, v61
    v_smfmac_f32_32x32x32_bf16 v[84:99], v[20:23], v[52:59], v7
    v_exp_f32 v62, v62
    v_exp_f32 v63, v63
    v_exp_f32 v64, v64
    v_mfma_f32_32x32x8_bf16 v[68:83], v[14:15], v[12:13], v[68:83]
    v_exp_f32 v65, v65
    v_exp_f32 v66, v66
    v_exp_f32 v67, v67
    s_setprio 0
    s_mov_b64 exec, s[46:47]
    ds_read_b128 v[20:23], v6 offset:2560
    ds_read_b128 v[36:39], v6 offset:3200
    s_mov_b64 exec, s[94:95]
    ds_read_b64 v[14:15], v5 offset:512
    s_mov_b64 exec, -1
    ds_read_b128 v[16:19], v4 offset:2048
    buffer_load_dwordx4 v[208:211], v0, s[28:31], s50 offen sc1
    s_add_u32 s50, s50, 2048
    buffer_load_dwordx4 v[188:191], v0, s[28:31], s49 offen sc1
    buffer_load_dwordx4 v[104:107], v0, s[28:31], s54 offen sc1
    s_add_u32 s54, s54, 20480
    v_exp_f32 v68, v68
    v_smfmac_f32_32x32x32_bf16 v[84:99], v[28:31], v[60:67], v7
    s_setprio 1
    s_waitcnt vmcnt(14) lgkmcnt(0)
    v_exp_f32 v69, v69
    v_exp_f32 v70, v70
    v_exp_f32 v71, v71
    v_mfma_f32_32x32x16_bf16 v[52:67], v[16:19], v[8:11], 0
    s_setprio 2
    v_exp_f32 v72, v72
    v_exp_f32 v73, v73
    v_exp_f32 v74, v74
    v_mfma_f32_32x32x16_bf16 v[120:135], v[192:195], v[212:215], v[120:135]
    v_exp_f32 v75, v75
    v_exp_f32 v76, v76
    v_exp_f32 v77, v77
    v_smfmac_f32_32x32x32_bf16 v[84:99], v[24:27], v[68:75], v7
    v_exp_f32 v78, v78
    v_exp_f32 v79, v79
    v_exp_f32 v80, v80
    v_mfma_f32_32x32x8_bf16 v[52:67], v[14:15], v[12:13], v[52:67]
    v_exp_f32 v81, v81
    v_exp_f32 v82, v82
    v_exp_f32 v83, v83
    s_setprio 0
    s_mov_b64 exec, s[46:47]
    ds_read_b128 v[24:27], v6 offset:3840
    ds_read_b128 v[28:31], v6 offset:4480
    s_mov_b64 exec, s[94:95]
    ds_read_b64 v[14:15], v5 offset:768
    s_mov_b64 exec, -1
    ds_read_b128 v[16:19], v4 offset:3072
    buffer_load_dwordx4 v[192:195], v0, s[28:31], s49 offen offset:1024 sc1
    s_add_u32 s49, s49, 40960
    v_exp_f32 v52, v52
    v_smfmac_f32_32x32x32_bf16 v[84:99], v[32:35], v[76:83], v7
    s_setprio 1
    s_waitcnt vmcnt(14) lgkmcnt(0)
    v_exp_f32 v53, v53
    v_exp_f32 v54, v54
    v_exp_f32 v55, v55
    v_mfma_f32_32x32x16_bf16 v[68:83], v[16:19], v[8:11], 0
    s_setprio 2
    v_exp_f32 v56, v56
    v_exp_f32 v57, v57
    v_exp_f32 v58, v58
    v_mfma_f32_32x32x16_bf16 v[136:151], v[196:199], v[212:215], v[136:151]
    v_exp_f32 v59, v59
    v_exp_f32 v60, v60
    v_exp_f32 v61, v61
    v_smfmac_f32_32x32x32_bf16 v[84:99], v[20:23], v[52:59], v7
    v_exp_f32 v62, v62
    v_exp_f32 v63, v63
    v_exp_f32 v64, v64
    v_mfma_f32_32x32x8_bf16 v[68:83], v[14:15], v[12:13], v[68:83]
    v_exp_f32 v65, v65
    v_exp_f32 v66, v66
    v_exp_f32 v67, v67
    s_setprio 0
    s_mov_b64 exec, s[46:47]
    ds_read_b128 v[20:23], v6 offset:10240
    ds_read_b128 v[32:35], v6 offset:10880
    s_mov_b64 exec, s[94:95]
    ds_read_b64 v[14:15], v5 offset:10240
    s_mov_b64 exec, -1
    ds_read_b128 v[16:19], v4 offset:10240
    buffer_load_dwordx4 v[196:199], v0, s[28:31], s52 offen sc1
    s_add_u32 s52, s52, 40960
    buffer_load_dwordx4 v[108:111], v0, s[28:31], s54 offen sc1
    s_add_u32 s54, s54, 20480
    v_exp_f32 v68, v68
    v_smfmac_f32_32x32x32_bf16 v[84:99], v[36:39], v[60:67], v7
    s_setprio 1
    s_waitcnt vmcnt(13) lgkmcnt(0)
    v_exp_f32 v69, v69
    v_exp_f32 v70, v70
    v_exp_f32 v71, v71
    v_mfma_f32_32x32x16_bf16 v[52:67], v[16:19], v[8:11], 0
    s_setprio 2
    v_exp_f32 v72, v72
    v_exp_f32 v73, v73
    v_exp_f32 v74, v74
    v_mfma_f32_32x32x16_bf16 v[120:135], v[168:171], v[200:203], v[120:135]
    v_exp_f32 v75, v75
    v_exp_f32 v76, v76
    v_exp_f32 v77, v77
    v_smfmac_f32_32x32x32_bf16 v[84:99], v[24:27], v[68:75], v7
    v_exp_f32 v78, v78
    v_exp_f32 v79, v79
    v_exp_f32 v80, v80
    v_mfma_f32_32x32x8_bf16 v[52:67], v[14:15], v[12:13], v[52:67]
    v_exp_f32 v81, v81
    v_exp_f32 v82, v82
    v_exp_f32 v83, v83
    s_setprio 0
    s_mov_b64 exec, s[46:47]
    ds_read_b128 v[24:27], v6 offset:11520
    ds_read_b128 v[36:39], v6 offset:12160
    s_mov_b64 exec, s[94:95]
    ds_read_b64 v[14:15], v5 offset:10496
    s_mov_b64 exec, -1
    ds_read_b128 v[16:19], v4 offset:11264
    buffer_load_dwordx4 v[212:215], v0, s[28:31], s51 offen sc1
    s_add_u32 s51, s51, 2048
    buffer_load_dwordx4 v[168:171], v0, s[28:31], s48 offen sc1
    v_exp_f32 v52, v52
    v_smfmac_f32_32x32x32_bf16 v[84:99], v[28:31], v[76:83], v7
    s_setprio 1
    s_waitcnt vmcnt(14) lgkmcnt(0)
    v_exp_f32 v53, v53
    v_exp_f32 v54, v54
    v_exp_f32 v55, v55
    v_mfma_f32_32x32x16_bf16 v[68:83], v[16:19], v[8:11], 0
    s_setprio 2
    v_exp_f32 v56, v56
    v_exp_f32 v57, v57
    v_exp_f32 v58, v58
    v_mfma_f32_32x32x16_bf16 v[136:151], v[172:175], v[200:203], v[136:151]
    v_exp_f32 v59, v59
    v_exp_f32 v60, v60
    v_exp_f32 v61, v61
    v_smfmac_f32_32x32x32_bf16 v[84:99], v[20:23], v[52:59], v7
    v_exp_f32 v62, v62
    v_exp_f32 v63, v63
    v_exp_f32 v64, v64
    v_mfma_f32_32x32x8_bf16 v[68:83], v[14:15], v[12:13], v[68:83]
    v_exp_f32 v65, v65
    v_exp_f32 v66, v66
    v_exp_f32 v67, v67
    s_setprio 0
    s_mov_b64 exec, s[46:47]
    ds_read_b128 v[20:23], v6 offset:12800
    ds_read_b128 v[28:31], v6 offset:13440
    s_mov_b64 exec, s[94:95]
    ds_read_b64 v[14:15], v5 offset:10752
    s_mov_b64 exec, -1
    ds_read_b128 v[16:19], v4 offset:12288
    buffer_load_dwordx4 v[172:175], v0, s[28:31], s48 offen offset:1024 sc1
    s_add_u32 s48, s48, 40960
    buffer_load_dwordx4 v[112:115], v0, s[28:31], s54 offen sc1
    s_add_u32 s54, s54, 20480
    v_exp_f32 v68, v68
    v_smfmac_f32_32x32x32_bf16 v[84:99], v[32:35], v[60:67], v7
    s_setprio 1
    s_waitcnt vmcnt(14) lgkmcnt(0)
    v_exp_f32 v69, v69
    v_exp_f32 v70, v70
    v_exp_f32 v71, v71
    v_mfma_f32_32x32x16_bf16 v[52:67], v[16:19], v[8:11], 0
    s_setprio 2
    v_exp_f32 v72, v72
    v_exp_f32 v73, v73
    v_exp_f32 v74, v74
    v_mfma_f32_32x32x16_bf16 v[152:167], v[176:179], v[200:203], v[152:167]
    v_exp_f32 v75, v75
    v_exp_f32 v76, v76
    v_exp_f32 v77, v77
    v_smfmac_f32_32x32x32_bf16 v[84:99], v[24:27], v[68:75], v7
    v_exp_f32 v78, v78
    v_exp_f32 v79, v79
    v_exp_f32 v80, v80
    v_mfma_f32_32x32x8_bf16 v[52:67], v[14:15], v[12:13], v[52:67]
    v_exp_f32 v81, v81
    v_exp_f32 v82, v82
    v_exp_f32 v83, v83
    s_setprio 0
    s_mov_b64 exec, s[46:47]
    ds_read_b128 v[24:27], v6 offset:14080
    ds_read_b128 v[32:35], v6 offset:14720
    s_mov_b64 exec, s[94:95]
    ds_read_b64 v[14:15], v5 offset:11008
    s_mov_b64 exec, -1
    ds_read_b128 v[16:19], v4 offset:13312
    buffer_load_dwordx4 v[200:203], v0, s[28:31], s50 offen sc1
    s_add_u32 s50, s50, 2048
    buffer_load_dwordx4 v[176:179], v0, s[28:31], s49 offen sc1
    v_exp_f32 v52, v52
    v_smfmac_f32_32x32x32_bf16 v[84:99], v[36:39], v[76:83], v7
    s_setprio 1
    s_waitcnt vmcnt(14) lgkmcnt(0)
    v_exp_f32 v53, v53
    v_exp_f32 v54, v54
    v_exp_f32 v55, v55
    v_mfma_f32_32x32x16_bf16 v[68:83], v[16:19], v[8:11], 0
    s_setprio 2
    v_exp_f32 v56, v56
    v_exp_f32 v57, v57
    v_exp_f32 v58, v58
    v_mfma_f32_32x32x16_bf16 v[120:135], v[180:183], v[204:207], v[120:135]
    v_exp_f32 v59, v59
    v_exp_f32 v60, v60
    v_exp_f32 v61, v61
    v_smfmac_f32_32x32x32_bf16 v[84:99], v[20:23], v[52:59], v7
    v_exp_f32 v62, v62
    v_exp_f32 v63, v63
    v_exp_f32 v64, v64
    v_mfma_f32_32x32x8_bf16 v[68:83], v[14:15], v[12:13], v[68:83]
    v_exp_f32 v65, v65
    v_exp_f32 v66, v66
    v_exp_f32 v67, v67
    s_setprio 0
    s_cmp_eq_u32 s22, 0
    s_cbranch_scc1 L_ba55
    s_barrier
L_ba55:
    s_mov_b64 exec, s[46:47]
    ds_read_b128 v[20:23], v6 offset:20480
    ds_read_b128 v[36:39], v6 offset:21120
    s_mov_b64 exec, s[94:95]
    ds_read_b64 v[14:15], v5 offset:20480
    s_mov_b64 exec, -1
    ds_read_b128 v[16:19], v4 offset:20480
    buffer_load_dwordx4 v[180:183], v0, s[28:31], s49 offen offset:1024 sc1
    s_add_u32 s49, s49, 40960
    buffer_load_dwordx4 v[40:43], v0, s[28:31], s54 offen sc1
    s_add_u32 s54, s54, 20480
    s_cmp_eq_u32 s22, 1
    s_cbranch_scc1 L_bb55
    s_barrier
L_bb55:
    v_exp_f32 v68, v68
    v_smfmac_f32_32x32x32_bf16 v[84:99], v[28:31], v[60:67], v7
    s_setprio 1
    s_waitcnt vmcnt(14) lgkmcnt(0)
    v_exp_f32 v69, v69
    v_exp_f32 v70, v70
    v_exp_f32 v71, v71
    v_mfma_f32_32x32x16_bf16 v[52:67], v[16:19], v[8:11], 0
    s_setprio 2
    v_exp_f32 v72, v72
    v_exp_f32 v73, v73
    v_exp_f32 v74, v74
    v_mfma_f32_32x32x16_bf16 v[136:151], v[184:187], v[204:207], v[136:151]
    v_exp_f32 v75, v75
    v_exp_f32 v76, v76
    v_exp_f32 v77, v77
    v_smfmac_f32_32x32x32_bf16 v[84:99], v[24:27], v[68:75], v7
    v_exp_f32 v78, v78
    v_exp_f32 v79, v79
    v_exp_f32 v80, v80
    v_mfma_f32_32x32x8_bf16 v[52:67], v[14:15], v[12:13], v[52:67]
    v_exp_f32 v81, v81
    v_exp_f32 v82, v82
    v_exp_f32 v83, v83
    s_setprio 0
    s_mov_b64 exec, s[46:47]
    ds_read_b128 v[24:27], v6 offset:21760
    ds_read_b128 v[28:31], v6 offset:22400
    s_mov_b64 exec, s[94:95]
    ds_read_b64 v[14:15], v5 offset:20736
    s_mov_b64 exec, -1
    ds_read_b128 v[16:19], v4 offset:21504
    buffer_load_dwordx4 v[184:187], v0, s[28:31], s52 offen sc1
    s_add_u32 s52, s52, 40960
    v_exp_f32 v52, v52
    v_smfmac_f32_32x32x32_bf16 v[84:99], v[32:35], v[76:83], v7
    s_setprio 1
    s_waitcnt vmcnt(13) lgkmcnt(0)
    v_exp_f32 v53, v53
    v_exp_f32 v54, v54
    v_exp_f32 v55, v55
    v_mfma_f32_32x32x16_bf16 v[68:83], v[16:19], v[8:11], 0
    s_setprio 2
    v_exp_f32 v56, v56
    v_exp_f32 v57, v57
    v_exp_f32 v58, v58
    v_mfma_f32_32x32x16_bf16 v[120:135], v[188:191], v[208:211], v[120:135]
    v_exp_f32 v59, v59
    v_exp_f32 v60, v60
    v_exp_f32 v61, v61
    v_smfmac_f32_32x32x32_bf16 v[84:99], v[20:23], v[52:59], v7
    v_exp_f32 v62, v62
    v_exp_f32 v63, v63
    v_exp_f32 v64, v64
    v_mfma_f32_32x32x8_bf16 v[68:83], v[14:15], v[12:13], v[68:83]
    v_exp_f32 v65, v65
    v_exp_f32 v66, v66
    v_exp_f32 v67, v67
    s_setprio 0
    s_mov_b64 exec, s[46:47]
    ds_read_b128 v[20:23], v6 offset:23040
    ds_read_b128 v[32:35], v6 offset:23680
    s_mov_b64 exec, s[94:95]
    ds_read_b64 v[14:15], v5 offset:20992
    s_mov_b64 exec, -1
    ds_read_b128 v[16:19], v4 offset:22528
    buffer_load_dwordx4 v[204:207], v0, s[28:31], s51 offen sc1
    s_add_u32 s51, s51, 2048
    buffer_load_dwordx4 v[188:191], v0, s[28:31], s48 offen sc1
    buffer_load_dwordx4 v[44:47], v0, s[28:31], s54 offen sc1
    s_add_u32 s54, s54, 20480
    v_exp_f32 v68, v68
    v_smfmac_f32_32x32x32_bf16 v[84:99], v[36:39], v[60:67], v7
    s_setprio 1
    s_waitcnt vmcnt(14) lgkmcnt(0)
    v_exp_f32 v69, v69
    v_exp_f32 v70, v70
    v_exp_f32 v71, v71
    v_mfma_f32_32x32x16_bf16 v[52:67], v[16:19], v[8:11], 0
    s_setprio 2
    v_exp_f32 v72, v72
    v_exp_f32 v73, v73
    v_exp_f32 v74, v74
    v_mfma_f32_32x32x16_bf16 v[136:151], v[192:195], v[208:211], v[136:151]
    v_exp_f32 v75, v75
    v_exp_f32 v76, v76
    v_exp_f32 v77, v77
    v_smfmac_f32_32x32x32_bf16 v[84:99], v[24:27], v[68:75], v7
    v_exp_f32 v78, v78
    v_exp_f32 v79, v79
    v_exp_f32 v80, v80
    v_mfma_f32_32x32x8_bf16 v[52:67], v[14:15], v[12:13], v[52:67]
    v_exp_f32 v81, v81
    v_exp_f32 v82, v82
    v_exp_f32 v83, v83
    s_setprio 0
    s_mov_b64 exec, s[46:47]
    ds_read_b128 v[24:27], v6 offset:24320
    ds_read_b128 v[36:39], v6 offset:24960
    s_mov_b64 exec, s[94:95]
    ds_read_b64 v[14:15], v5 offset:21248
    s_mov_b64 exec, -1
    ds_read_b128 v[16:19], v4 offset:23552
    buffer_load_dwordx4 v[192:195], v0, s[28:31], s48 offen offset:1024 sc1
    s_add_u32 s48, s48, 40960
    v_exp_f32 v52, v52
    v_smfmac_f32_32x32x32_bf16 v[84:99], v[28:31], v[76:83], v7
    s_setprio 1
    s_waitcnt vmcnt(14) lgkmcnt(0)
    v_exp_f32 v53, v53
    v_exp_f32 v54, v54
    v_exp_f32 v55, v55
    v_mfma_f32_32x32x16_bf16 v[68:83], v[16:19], v[8:11], 0
    s_setprio 2
    v_exp_f32 v56, v56
    v_exp_f32 v57, v57
    v_exp_f32 v58, v58
    v_mfma_f32_32x32x16_bf16 v[152:167], v[196:199], v[208:211], v[152:167]
    v_exp_f32 v59, v59
    v_exp_f32 v60, v60
    v_exp_f32 v61, v61
    v_smfmac_f32_32x32x32_bf16 v[84:99], v[20:23], v[52:59], v7
    v_exp_f32 v62, v62
    v_exp_f32 v63, v63
    v_exp_f32 v64, v64
    v_mfma_f32_32x32x8_bf16 v[68:83], v[14:15], v[12:13], v[68:83]
    v_exp_f32 v65, v65
    v_exp_f32 v66, v66
    v_exp_f32 v67, v67
    s_setprio 0
    s_mov_b64 exec, s[46:47]
    ds_read_b128 v[20:23], v6 offset:30720
    ds_read_b128 v[28:31], v6 offset:31360
    s_mov_b64 exec, s[94:95]
    ds_read_b64 v[14:15], v5 offset:30720
    s_mov_b64 exec, -1
    ds_read_b128 v[16:19], v4 offset:30720
    buffer_load_dwordx4 v[208:211], v0, s[28:31], s50 offen sc1
    s_add_u32 s50, s50, 2048
    buffer_load_dwordx4 v[196:199], v0, s[28:31], s49 offen sc1
    buffer_load_dwordx4 v[48:51], v0, s[28:31], s54 offen sc1
    s_add_u32 s54, s54, 20480
    v_exp_f32 v68, v68
    v_smfmac_f32_32x32x32_bf16 v[84:99], v[32:35], v[60:67], v7
    s_setprio 1
    s_waitcnt vmcnt(14) lgkmcnt(0)
    v_exp_f32 v69, v69
    v_exp_f32 v70, v70
    v_exp_f32 v71, v71
    v_mfma_f32_32x32x16_bf16 v[52:67], v[16:19], v[8:11], 0
    s_setprio 2
    v_exp_f32 v72, v72
    v_exp_f32 v73, v73
    v_exp_f32 v74, v74
    v_mfma_f32_32x32x16_bf16 v[120:135], v[168:171], v[212:215], v[120:135]
    v_exp_f32 v75, v75
    v_exp_f32 v76, v76
    v_exp_f32 v77, v77
    v_smfmac_f32_32x32x32_bf16 v[84:99], v[24:27], v[68:75], v7
    v_exp_f32 v78, v78
    v_exp_f32 v79, v79
    v_exp_f32 v80, v80
    v_mfma_f32_32x32x8_bf16 v[52:67], v[14:15], v[12:13], v[52:67]
    v_exp_f32 v81, v81
    v_exp_f32 v82, v82
    v_exp_f32 v83, v83
    s_setprio 0
    s_mov_b64 exec, s[46:47]
    ds_read_b128 v[24:27], v6 offset:32000
    ds_read_b128 v[32:35], v6 offset:32640
    s_mov_b64 exec, s[94:95]
    ds_read_b64 v[14:15], v5 offset:30976
    s_mov_b64 exec, -1
    ds_read_b128 v[16:19], v4 offset:31744
    buffer_load_dwordx4 v[168:171], v0, s[28:31], s49 offen offset:1024 sc1
    s_add_u32 s49, s49, 40960
    v_exp_f32 v52, v52
    v_smfmac_f32_32x32x32_bf16 v[84:99], v[36:39], v[76:83], v7
    s_setprio 1
    s_waitcnt vmcnt(14) lgkmcnt(0)
    v_exp_f32 v53, v53
    v_exp_f32 v54, v54
    v_exp_f32 v55, v55
    v_mfma_f32_32x32x16_bf16 v[68:83], v[16:19], v[8:11], 0
    s_setprio 2
    v_exp_f32 v56, v56
    v_exp_f32 v57, v57
    v_exp_f32 v58, v58
    v_mfma_f32_32x32x16_bf16 v[136:151], v[172:175], v[212:215], v[136:151]
    v_exp_f32 v59, v59
    v_exp_f32 v60, v60
    v_exp_f32 v61, v61
    v_smfmac_f32_32x32x32_bf16 v[84:99], v[20:23], v[52:59], v7
    v_exp_f32 v62, v62
    v_exp_f32 v63, v63
    v_exp_f32 v64, v64
    v_mfma_f32_32x32x8_bf16 v[68:83], v[14:15], v[12:13], v[68:83]
    v_exp_f32 v65, v65
    v_exp_f32 v66, v66
    v_exp_f32 v67, v67
    s_setprio 0
    s_mov_b64 exec, s[46:47]
    ds_read_b128 v[20:23], v6 offset:33280
    ds_read_b128 v[36:39], v6 offset:33920
    s_mov_b64 exec, s[94:95]
    ds_read_b64 v[14:15], v5 offset:31232
    s_mov_b64 exec, -1
    ds_read_b128 v[16:19], v4 offset:32768
    buffer_load_dwordx4 v[172:175], v0, s[28:31], s52 offen sc1
    s_add_u32 s52, s52, 40960
    v_exp_f32 v68, v68
    v_smfmac_f32_32x32x32_bf16 v[84:99], v[28:31], v[60:67], v7
    s_setprio 1
    s_waitcnt vmcnt(12) lgkmcnt(0)
    v_exp_f32 v69, v69
    v_exp_f32 v70, v70
    v_exp_f32 v71, v71
    v_mfma_f32_32x32x16_bf16 v[52:67], v[16:19], v[8:11], 0
    s_setprio 2
    v_exp_f32 v72, v72
    v_exp_f32 v73, v73
    v_exp_f32 v74, v74
    v_mfma_f32_32x32x16_bf16 v[120:135], v[176:179], v[200:203], v[120:135]
    v_exp_f32 v75, v75
    v_exp_f32 v76, v76
    v_exp_f32 v77, v77
    v_smfmac_f32_32x32x32_bf16 v[84:99], v[24:27], v[68:75], v7
    v_exp_f32 v78, v78
    v_exp_f32 v79, v79
    v_exp_f32 v80, v80
    v_mfma_f32_32x32x8_bf16 v[52:67], v[14:15], v[12:13], v[52:67]
    v_exp_f32 v81, v81
    v_exp_f32 v82, v82
    v_exp_f32 v83, v83
    s_setprio 0
    s_mov_b64 exec, s[46:47]
    ds_read_b128 v[24:27], v6 offset:34560
    ds_read_b128 v[28:31], v6 offset:35200
    s_mov_b64 exec, s[94:95]
    ds_read_b64 v[14:15], v5 offset:31488
    s_mov_b64 exec, -1
    ds_read_b128 v[16:19], v4 offset:33792
    buffer_load_dwordx4 v[212:215], v0, s[28:31], s51 offen sc1
    s_add_u32 s51, s51, 2048
    buffer_load_dwordx4 v[176:179], v0, s[28:31], s48 offen sc1
    v_exp_f32 v52, v52
    v_smfmac_f32_32x32x32_bf16 v[84:99], v[32:35], v[76:83], v7
    s_setprio 1
    s_waitcnt vmcnt(13) lgkmcnt(0)
    v_exp_f32 v53, v53
    v_exp_f32 v54, v54
    v_exp_f32 v55, v55
    v_mfma_f32_32x32x16_bf16 v[68:83], v[16:19], v[8:11], 0
    s_setprio 2
    v_exp_f32 v56, v56
    v_exp_f32 v57, v57
    v_exp_f32 v58, v58
    v_mfma_f32_32x32x16_bf16 v[136:151], v[180:183], v[200:203], v[136:151]
    v_exp_f32 v59, v59
    v_exp_f32 v60, v60
    v_exp_f32 v61, v61
    v_smfmac_f32_32x32x32_bf16 v[84:99], v[20:23], v[52:59], v7
    v_exp_f32 v62, v62
    v_exp_f32 v63, v63
    v_exp_f32 v64, v64
    v_mfma_f32_32x32x8_bf16 v[68:83], v[14:15], v[12:13], v[68:83]
    v_exp_f32 v65, v65
    v_exp_f32 v66, v66
    v_exp_f32 v67, v67
    s_setprio 0
    s_nop 7
    buffer_load_dwordx4 v[180:183], v0, s[28:31], s48 offen offset:1024 sc1
    s_add_u32 s48, s48, 40960
    v_exp_f32 v68, v68
    v_smfmac_f32_32x32x32_bf16 v[84:99], v[36:39], v[60:67], v7
    s_setprio 1
    s_waitcnt vmcnt(12) lgkmcnt(0)
    v_exp_f32 v69, v69
    v_exp_f32 v70, v70
    v_exp_f32 v71, v71
    s_setprio 2
    v_exp_f32 v72, v72
    v_exp_f32 v73, v73
    v_exp_f32 v74, v74
    v_mfma_f32_32x32x16_bf16 v[152:167], v[184:187], v[200:203], v[152:167]
    v_exp_f32 v75, v75
    v_exp_f32 v76, v76
    v_exp_f32 v77, v77
    v_smfmac_f32_32x32x32_bf16 v[84:99], v[24:27], v[68:75], v7
    v_exp_f32 v78, v78
    v_exp_f32 v79, v79
    v_exp_f32 v80, v80
    v_exp_f32 v81, v81
    v_exp_f32 v82, v82
    v_exp_f32 v83, v83
    s_setprio 0
    s_nop 0
    v_smfmac_f32_32x32x32_bf16 v[84:99], v[28:31], v[76:83], v7
    s_lshl_b32 s42, s40, 5
    s_add_u32 s42, s42, s16
    s_lshl_b32 s43, s42, 8
    s_add_u32 s43, s43, 16252928
    s_lshl_b32 s44, s42, 7
    s_add_u32 s44, s44, 22192128
    s_lshl_b32 s42, s42, 10
    s_add_u32 s42, s42, 14155776
    s_mov_b32 s3, 0x53800000
    s_mul_i32 s45, s20, 12288
    v_add_u32 v4, s45, v0
    s_nop 0
    v_mov_b32 v116, v92
    v_mov_b32 v117, v92
    s_nop 1
    v_permlane32_swap_b32 v116, v117
    s_nop 1
    v_cmp_nlt_f32 vcc, v117, s3
    s_nop 4
    s_cbranch_vccnz LB_slow
LB_ok:
    v_rcp_f32 v116, v117
    v_lshlrev_b32 v5, 3, v2
    v_lshl_add_u32 v5, v3, 31, v5
    v_mul_f32 v84, v116, v84
    v_mul_f32 v85, v116, v85
    v_mul_f32 v86, v116, v86
    v_mul_f32 v87, v116, v87
    v_mul_f32 v88, v116, v88
    v_mul_f32 v89, v116, v89
    v_mul_f32 v90, v116, v90
    v_mul_f32 v91, v116, v91
    v_mul_f32 v92, v116, v92
    v_mul_f32 v93, v116, v93
    v_mul_f32 v94, v116, v94
    v_mul_f32 v95, v116, v95
    v_cvt_pk_bf16_f32 v84, v84, v85
    v_cvt_pk_bf16_f32 v85, v86, v87
    v_cvt_pk_bf16_f32 v86, v88, v89
    v_cvt_pk_bf16_f32 v87, v90, v91
    v_cvt_pk_bf16_f32 v88, v92, v93
    v_cvt_pk_bf16_f32 v89, v94, v95
    buffer_store_dwordx4 v[84:87], v0, s[28:31], s42 offen sc1
    buffer_store_dwordx2 v[88:89], v5, s[28:31], s43 offen sc1
    s_waitcnt vmcnt(2)
    v_mfma_f32_32x32x16_bf16 v[120:135], v[188:191], v[204:207], v[120:135]
    v_mfma_f32_32x32x16_bf16 v[136:151], v[192:195], v[204:207], v[136:151]
    v_mfma_f32_32x32x16_bf16 v[120:135], v[196:199], v[208:211], v[120:135]
    v_mfma_f32_32x32x16_bf16 v[136:151], v[168:171], v[208:211], v[136:151]
    v_mfma_f32_32x32x16_bf16 v[152:167], v[172:175], v[208:211], v[152:167]
    v_mfma_f32_32x32x16_bf16 v[120:135], v[176:179], v[212:215], v[120:135]
    v_mfma_f32_32x32x16_bf16 v[136:151], v[180:183], v[212:215], v[136:151]
    v_mov_b32 v6, s90
    v_mov_b32 v7, 0
    s_lshl_b32 s50, s18, 7
    s_lshl_b32 s51, s23, 5
    s_add_u32 s51, s51, s50
    s_lshl_b32 s51, s51, 5
    s_add_u32 s51, s51, 22192128
    v_and_b32 v118, 7, v1
    v_lshlrev_b32 v118, 7, v118
    s_nop 0
    s_mul_i32 s46, s18, 40960
    s_mul_i32 s45, s19, 320
    s_mov_b32 s49, 0xbfb8aa3b
    ds_write_b128 v4, v[152:155] offset:8192
    ds_write_b128 v4, v[156:159] offset:9216
    ds_write_b128 v4, v[160:163] offset:10240
    s_waitcnt vmcnt(0)
    s_mov_b64 exec, 1
    buffer_store_dword v6, v7, s[28:31], s44 offen sc1
    s_mov_b64 exec, -1
    s_cmp_eq_u32 s22, 1
    s_cbranch_scc1 LB_g1
    s_lshl_b32 s44, s23, 6
    s_add_u32 s45, s45, s44
    s_add_u32 s46, s46, s45
    s_add_u32 s47, s46, 20480
    v_lshlrev_b32 v5, 3, v3
    v_lshrrev_b32 v16, 2, v1
    v_and_b32 v17, 3, v1
    v_lshlrev_b32 v17, 4, v17
    v_mul_u32_u24 v18, 80, v16
    v_add_u32 v18, v18, v17
    v_mul_u32_u24 v16, 1280, v16
    v_add_u32 v16, v16, v17
    ds_write_b128 v4, v[164:167] offset:11264
    ds_write_b128 v4, v[120:123] offset:0
    ds_write_b128 v4, v[124:127] offset:1024
    ds_write_b128 v4, v[128:131] offset:2048
    ds_write_b128 v4, v[132:135] offset:3072
    ds_write_b128 v4, v[136:139] offset:4096
    ds_write_b128 v4, v[140:143] offset:5120
    ds_write_b128 v4, v[144:147] offset:6144
    ds_write_b128 v4, v[148:151] offset:7168
    buffer_load_dwordx2 v[84:85], v5, s[32:35], s45 offen offset:0
    buffer_load_dwordx2 v[86:87], v5, s[32:35], s45 offen offset:16
    buffer_load_dwordx2 v[88:89], v5, s[32:35], s45 offen offset:32
    buffer_load_dwordx2 v[90:91], v5, s[32:35], s45 offen offset:48
    buffer_load_dwordx4 v[8:11], v16, s[24:27], s46 offen
    buffer_load_dwordx4 v[12:15], v16, s[24:27], s47 offen
    s_mul_i32 s48, s23, 2560
    s_add_u32 s48, s48, 139264
    v_add_u32 v18, s48, v18
    v_mul_u32_u24 v19, 80, v2
    v_lshl_add_u32 v19, v3, 3, v19
    v_add_u32 v19, s48, v19
    s_lshr_b32 s42, s23, 1
    s_mul_i32 s42, s42, 49152
    s_and_b32 s43, s23, 1
    s_lshl_b32 s43, s43, 12
    s_add_u32 s42, s42, s43
    v_add_u32 v17, s42, v0
    s_waitcnt lgkmcnt(0)
    s_barrier
    ds_read_b128 v[168:171], v17 offset:0
    ds_read_b128 v[172:175], v17 offset:1024
    ds_read_b128 v[176:179], v17 offset:2048
    ds_read_b128 v[180:183], v17 offset:3072
    ds_read_b128 v[120:123], v17 offset:12288
    ds_read_b128 v[124:127], v17 offset:13312
    ds_read_b128 v[128:131], v17 offset:14336
    ds_read_b128 v[132:135], v17 offset:15360
    ds_read_b128 v[136:139], v17 offset:24576
    ds_read_b128 v[140:143], v17 offset:25600
    ds_read_b128 v[144:147], v17 offset:26624
    ds_read_b128 v[148:151], v17 offset:27648
    s_waitcnt lgkmcnt(8)
    ds_read_b128 v[152:155], v17 offset:36864
    ds_read_b128 v[156:159], v17 offset:37888
    ds_read_b128 v[160:163], v17 offset:38912
    ds_read_b128 v[164:167], v17 offset:39936
    s_waitcnt lgkmcnt(8)
    v_add_f32 v168, v168, v120
    v_add_f32 v169, v169, v121
    v_add_f32 v170, v170, v122
    v_add_f32 v171, v171, v123
    v_add_f32 v172, v172, v124
    v_add_f32 v173, v173, v125
    v_add_f32 v174, v174, v126
    v_add_f32 v175, v175, v127
    v_add_f32 v176, v176, v128
    v_add_f32 v177, v177, v129
    v_add_f32 v178, v178, v130
    v_add_f32 v179, v179, v131
    v_add_f32 v180, v180, v132
    v_add_f32 v181, v181, v133
    v_add_f32 v182, v182, v134
    v_add_f32 v183, v183, v135
    s_waitcnt lgkmcnt(4)
    v_add_f32 v168, v168, v136
    v_add_f32 v169, v169, v137
    v_add_f32 v170, v170, v138
    v_add_f32 v171, v171, v139
    v_add_f32 v172, v172, v140
    v_add_f32 v173, v173, v141
    v_add_f32 v174, v174, v142
    v_add_f32 v175, v175, v143
    v_add_f32 v176, v176, v144
    v_add_f32 v177, v177, v145
    v_add_f32 v178, v178, v146
    v_add_f32 v179, v179, v147
    v_add_f32 v180, v180, v148
    v_add_f32 v181, v181, v149
    v_add_f32 v182, v182, v150
    v_add_f32 v183, v183, v151
    s_waitcnt lgkmcnt(0)
    v_add_f32 v168, v168, v152
    v_add_f32 v169, v169, v153
    v_add_f32 v170, v170, v154
    v_add_f32 v171, v171, v155
    v_add_f32 v172, v172, v156
    v_add_f32 v173, v173, v157
    v_add_f32 v174, v174, v158
    v_add_f32 v175, v175, v159
    v_add_f32 v176, v176, v160
    v_add_f32 v177, v177, v161
    v_add_f32 v178, v178, v162
    v_add_f32 v179, v179, v163
    v_add_f32 v180, v180, v164
    v_add_f32 v181, v181, v165
    v_add_f32 v182, v182, v166
    v_add_f32 v183, v183, v167
    v_add_u32 v4, 98304, v0
    s_lshl_b32 s42, s23, 13
    v_add_u32 v17, s42, v0
    s_waitcnt vmcnt(2)
    v_lshlrev_b32 v116, 16, v84
    v_and_b32 v117, 0xffff0000, v84
    v_fma_f32 v168, v168, v119, v116
    v_fma_f32 v169, v169, v119, v117
    v_mul_f32 v116, s49, v168
    v_mul_f32 v117, s49, v169
    v_exp_f32 v116, v116
    v_exp_f32 v117, v117
    v_add_f32 v116, 1.0, v116
    s_nop 0
    v_add_f32 v117, 1.0, v117
    v_rcp_f32 v116, v116
    v_rcp_f32 v117, v117
    v_mul_f32 v168, v168, v116
    s_nop 0
    v_mul_f32 v169, v169, v117
    v_lshlrev_b32 v116, 16, v85
    v_and_b32 v117, 0xffff0000, v85
    v_fma_f32 v170, v170, v119, v116
    v_fma_f32 v171, v171, v119, v117
    v_mul_f32 v116, s49, v170
    v_mul_f32 v117, s49, v171
    v_exp_f32 v116, v116
    v_exp_f32 v117, v117
    v_add_f32 v116, 1.0, v116
    s_nop 0
    v_add_f32 v117, 1.0, v117
    v_rcp_f32 v116, v116
    v_rcp_f32 v117, v117
    v_mul_f32 v170, v170, v116
    s_nop 0
    v_mul_f32 v171, v171, v117
    v_lshlrev_b32 v116, 16, v86
    v_and_b32 v117, 0xffff0000, v86
    v_fma_f32 v172, v172, v119, v116
    v_fma_f32 v173, v173, v119, v117
    v_mul_f32 v116, s49, v172
    v_mul_f32 v117, s49, v173
    v_exp_f32 v116, v116
    v_exp_f32 v117, v117
    v_add_f32 v116, 1.0, v116
    s_nop 0
    v_add_f32 v117, 1.0, v117
    v_rcp_f32 v116, v116
    v_rcp_f32 v117, v117
    v_mul_f32 v172, v172, v116
    s_nop 0
    v_mul_f32 v173, v173, v117
    v_lshlrev_b32 v116, 16, v87
    v_and_b32 v117, 0xffff0000, v87
    v_fma_f32 v174, v174, v119, v116
    v_fma_f32 v175, v175, v119, v117
    v_mul_f32 v116, s49, v174
    v_mul_f32 v117, s49, v175
    v_exp_f32 v116, v116
    v_exp_f32 v117, v117
    v_add_f32 v116, 1.0, v116
    s_nop 0
    v_add_f32 v117, 1.0, v117
    v_rcp_f32 v116, v116
    v_rcp_f32 v117, v117
    v_mul_f32 v174, v174, v116
    s_nop 0
    v_mul_f32 v175, v175, v117
    v_lshlrev_b32 v116, 16, v88
    v_and_b32 v117, 0xffff0000, v88
    v_fma_f32 v176, v176, v119, v116
    v_fma_f32 v177, v177, v119, v117
    v_mul_f32 v116, s49, v176
    v_mul_f32 v117, s49, v177
    v_exp_f32 v116, v116
    v_exp_f32 v117, v117
    v_add_f32 v116, 1.0, v116
    s_nop 0
    v_add_f32 v117, 1.0, v117
    v_rcp_f32 v116, v116
    v_rcp_f32 v117, v117
    v_mul_f32 v176, v176, v116
    s_nop 0
    v_mul_f32 v177, v177, v117
    s_barrier
    s_waitcnt vmcnt(0)
    buffer_load_dwordx4 v[52:55], v0, s[28:31], s54 offen sc1
    s_add_u32 s54, s54, 20480
    buffer_load_dwordx4 v[56:59], v0, s[28:31], s54 offen sc1
    s_add_u32 s54, s54, 20480
    buffer_load_dwordx4 v[60:63], v0, s[28:31], s54 offen sc1
    s_add_u32 s54, s54, 20480
    v_lshlrev_b32 v116, 16, v89
    v_and_b32 v117, 0xffff0000, v89
    v_fma_f32 v178, v178, v119, v116
    v_fma_f32 v179, v179, v119, v117
    v_mul_f32 v116, s49, v178
    v_mul_f32 v117, s49, v179
    v_exp_f32 v116, v116
    v_exp_f32 v117, v117
    v_add_f32 v116, 1.0, v116
    s_nop 0
    v_add_f32 v117, 1.0, v117
    v_rcp_f32 v116, v116
    v_rcp_f32 v117, v117
    v_mul_f32 v178, v178, v116
    s_nop 0
    v_mul_f32 v179, v179, v117
    buffer_load_dwordx4 v[64:67], v0, s[28:31], s54 offen sc1
    s_add_u32 s54, s54, 20480
    buffer_load_dwordx4 v[68:71], v0, s[28:31], s54 offen sc1
    s_add_u32 s54, s54, 20480
    buffer_load_dwordx4 v[72:75], v0, s[28:31], s54 offen sc1
    s_add_u32 s54, s54, 20480
    v_lshlrev_b32 v116, 16, v90
    v_and_b32 v117, 0xffff0000, v90
    v_fma_f32 v180, v180, v119, v116
    v_fma_f32 v181, v181, v119, v117
    v_mul_f32 v116, s49, v180
    v_mul_f32 v117, s49, v181
    v_exp_f32 v116, v116
    v_exp_f32 v117, v117
    v_add_f32 v116, 1.0, v116
    s_nop 0
    v_add_f32 v117, 1.0, v117
    v_rcp_f32 v116, v116
    v_rcp_f32 v117, v117
    v_mul_f32 v180, v180, v116
    s_nop 0
    v_mul_f32 v181, v181, v117
    buffer_load_dwordx4 v[76:79], v0, s[28:31], s54 offen sc1
    s_add_u32 s54, s54, 20480
    buffer_load_dwordx4 v[80:83], v0, s[28:31], s54 offen sc1
    s_add_u32 s54, s54, 20480
    v_lshlrev_b32 v116, 16, v91
    v_and_b32 v117, 0xffff0000, v91
    v_fma_f32 v182, v182, v119, v116
    v_fma_f32 v183, v183, v119, v117
    v_mul_f32 v116, s49, v182
    v_mul_f32 v117, s49, v183
    v_exp_f32 v116, v116
    v_exp_f32 v117, v117
    v_add_f32 v116, 1.0, v116
    s_nop 0
    v_add_f32 v117, 1.0, v117
    v_rcp_f32 v116, v116
    v_rcp_f32 v117, v117
    v_mul_f32 v182, v182, v116
    s_nop 0
    v_mul_f32 v183, v183, v117
    ds_write_b128 v18, v[8:11]
    ds_write_b128 v18, v[12:15] offset:1280
    ds_read_b64 v[8:9], v19 offset:0
    ds_read_b64 v[10:11], v19 offset:16
    ds_read_b64 v[12:13], v19 offset:32
    ds_read_b64 v[14:15], v19 offset:48
    ds_read_b128 v[136:139], v4 offset:0
    ds_read_b128 v[140:143], v4 offset:1024
    ds_read_b128 v[144:147], v4 offset:2048
    ds_read_b128 v[148:151], v4 offset:3072
    ds_read_b128 v[152:155], v4 offset:4096
    ds_read_b128 v[156:159], v4 offset:5120
    ds_read_b128 v[160:163], v4 offset:6144
    ds_read_b128 v[164:167], v4 offset:7168
    ds_read_b128 v[92:95], v4 offset:8192
    s_waitcnt lgkmcnt(8)
    ds_read_b128 v[96:99], v4 offset:9216
    ds_read_b128 v[20:23], v4 offset:10240
    ds_read_b128 v[24:27], v4 offset:11264
    ds_read_b128 v[28:31], v4 offset:12288
    ds_read_b128 v[32:35], v4 offset:13312
    ds_read_b128 v[36:39], v4 offset:14336
    ds_read_b128 v[84:87], v4 offset:15360
    ds_read_b128 v[88:91], v4 offset:16384
    s_barrier
    v_mfma_f32_32x32x16_bf16 v[120:135], v[216:219], v[136:139], 0
    s_waitcnt lgkmcnt(15)
    v_mfma_f32_32x32x16_bf16 v[120:135], v[220:223], v[140:143], v[120:135]
    s_waitcnt lgkmcnt(14)
    v_mfma_f32_32x32x16_bf16 v[120:135], v[224:227], v[144:147], v[120:135]
    v_lshlrev_b32 v200, 16, v8
    v_and_b32 v201, 0xffff0000, v8
    s_waitcnt lgkmcnt(13)
    v_mfma_f32_32x32x16_bf16 v[120:135], v[228:231], v[148:151], v[120:135]
    v_lshlrev_b32 v202, 16, v9
    v_and_b32 v203, 0xffff0000, v9
    s_waitcnt lgkmcnt(12)
    v_mfma_f32_32x32x16_bf16 v[120:135], v[232:235], v[152:155], v[120:135]
    v_lshlrev_b32 v204, 16, v10
    v_and_b32 v205, 0xffff0000, v10
    s_waitcnt lgkmcnt(11)
    v_mfma_f32_32x32x16_bf16 v[120:135], v[236:239], v[156:159], v[120:135]
    v_lshlrev_b32 v206, 16, v11
    v_and_b32 v207, 0xffff0000, v11
    s_waitcnt lgkmcnt(10)
    v_mfma_f32_32x32x16_bf16 v[120:135], v[240:243], v[160:163], v[120:135]
    v_lshlrev_b32 v208, 16, v12
    v_and_b32 v209, 0xffff0000, v12
    s_waitcnt lgkmcnt(9)
    v_mfma_f32_32x32x16_bf16 v[120:135], v[244:247], v[164:167], v[120:135]
    v_lshlrev_b32 v210, 16, v13
    v_and_b32 v211, 0xffff0000, v13
    s_waitcnt lgkmcnt(8)
    v_mfma_f32_32x32x16_bf16 v[120:135], v[248:251], v[92:95], v[120:135]
    v_lshlrev_b32 v212, 16, v14
    v_and_b32 v213, 0xffff0000, v14
    s_waitcnt lgkmcnt(7)
    v_mfma_f32_32x32x16_bf16 v[120:135], v[252:255], v[96:99], v[120:135]
    v_lshlrev_b32 v214, 16, v15
    v_and_b32 v215, 0xffff0000, v15
    s_waitcnt lgkmcnt(6)
    v_mfma_f32_32x32x16_bf16 v[120:135], v[100:103], v[20:23], v[120:135]
    s_waitcnt lgkmcnt(5)
    v_mfma_f32_32x32x16_bf16 v[120:135], v[104:107], v[24:27], v[120:135]
    s_barrier
    ds_read_b128 v[136:139], v4 offset:17408
    ds_read_b128 v[140:143], v4 offset:18432
    s_waitcnt lgkmcnt(6)
    v_mfma_f32_32x32x16_bf16 v[120:135], v[108:111], v[28:31], v[120:135]
    ds_read_b128 v[144:147], v4 offset:19456
    ds_read_b128 v[148:151], v4 offset:20480
    s_waitcnt lgkmcnt(7)
    v_mfma_f32_32x32x16_bf16 v[120:135], v[112:115], v[32:35], v[120:135]
    ds_read_b128 v[152:155], v4 offset:21504
    ds_read_b128 v[156:159], v4 offset:22528
    s_waitcnt lgkmcnt(8)
    v_mfma_f32_32x32x16_bf16 v[120:135], v[40:43], v[36:39], v[120:135]
    ds_read_b128 v[160:163], v4 offset:23552
    ds_read_b128 v[164:167], v4 offset:24576
    s_waitcnt lgkmcnt(9)
    v_mfma_f32_32x32x16_bf16 v[120:135], v[44:47], v[84:87], v[120:135]
    ds_read_b128 v[184:187], v17 offset:0
    ds_read_b128 v[188:191], v17 offset:1024
    s_waitcnt lgkmcnt(10)
    v_mfma_f32_32x32x16_bf16 v[120:135], v[48:51], v[88:91], v[120:135]
    ds_read_b128 v[192:195], v17 offset:2048
    ds_read_b128 v[196:199], v17 offset:3072
    s_waitcnt lgkmcnt(11)
    s_waitcnt vmcnt(0)
    v_mfma_f32_32x32x16_bf16 v[120:135], v[52:55], v[136:139], v[120:135]
    s_waitcnt lgkmcnt(10)
    v_mfma_f32_32x32x16_bf16 v[120:135], v[56:59], v[140:143], v[120:135]
    s_waitcnt lgkmcnt(9)
    v_mfma_f32_32x32x16_bf16 v[120:135], v[60:63], v[144:147], v[120:135]
    s_waitcnt lgkmcnt(8)
    v_mfma_f32_32x32x16_bf16 v[120:135], v[64:67], v[148:151], v[120:135]
    s_waitcnt lgkmcnt(3)
    v_fma_f32 v200, v184, v168, v200
    v_fma_f32 v201, v185, v169, v201
    v_fma_f32 v202, v186, v170, v202
    v_fma_f32 v203, v187, v171, v203
    v_mfma_f32_32x32x16_bf16 v[120:135], v[68:71], v[152:155], v[120:135]
    s_waitcnt lgkmcnt(2)
    v_fma_f32 v204, v188, v172, v204
    v_fma_f32 v205, v189, v173, v205
    v_fma_f32 v206, v190, v174, v206
    v_fma_f32 v207, v191, v175, v207
    v_mfma_f32_32x32x16_bf16 v[120:135], v[72:75], v[156:159], v[120:135]
    s_waitcnt lgkmcnt(1)
    v_fma_f32 v208, v192, v176, v208
    v_fma_f32 v209, v193, v177, v209
    v_fma_f32 v210, v194, v178, v210
    v_fma_f32 v211, v195, v179, v211
    v_mfma_f32_32x32x16_bf16 v[120:135], v[76:79], v[160:163], v[120:135]
    s_waitcnt lgkmcnt(0)
    v_fma_f32 v212, v196, v180, v212
    v_fma_f32 v213, v197, v181, v213
    v_fma_f32 v214, v198, v182, v214
    v_fma_f32 v215, v199, v183, v215
    v_mfma_f32_32x32x16_bf16 v[120:135], v[80:83], v[164:167], v[120:135]
    s_nop 11
    v_fma_f32 v120, v120, v168, v200
    v_fma_f32 v121, v121, v169, v201
    v_fma_f32 v122, v122, v170, v202
    v_fma_f32 v123, v123, v171, v203
    v_cvt_pk_bf16_f32 v120, v120, v121
    v_cvt_pk_bf16_f32 v121, v122, v123
    ds_write_b64 v19, v[120:121] offset:0
    v_fma_f32 v124, v124, v172, v204
    v_fma_f32 v125, v125, v173, v205
    v_fma_f32 v126, v126, v174, v206
    v_fma_f32 v127, v127, v175, v207
    v_cvt_pk_bf16_f32 v122, v124, v125
    v_cvt_pk_bf16_f32 v123, v126, v127
    ds_write_b64 v19, v[122:123] offset:16
    v_fma_f32 v128, v128, v176, v208
    v_fma_f32 v129, v129, v177, v209
    v_fma_f32 v130, v130, v178, v210
    v_fma_f32 v131, v131, v179, v211
    v_cvt_pk_bf16_f32 v124, v128, v129
    v_cvt_pk_bf16_f32 v125, v130, v131
    ds_write_b64 v19, v[124:125] offset:32
    v_fma_f32 v132, v132, v180, v212
    v_fma_f32 v133, v133, v181, v213
    v_fma_f32 v134, v134, v182, v214
    v_fma_f32 v135, v135, v183, v215
    v_cvt_pk_bf16_f32 v126, v132, v133
    v_cvt_pk_bf16_f32 v127, v134, v135
    ds_write_b64 v19, v[126:127] offset:48
    ds_read_b128 v[184:187], v18
    ds_read_b128 v[188:191], v18 offset:1280
    s_waitcnt lgkmcnt(1)
    buffer_store_dwordx4 v[184:187], v16, s[36:39], s46 offen
    s_waitcnt lgkmcnt(0)
    buffer_store_dwordx4 v[188:191], v16, s[36:39], s47 offen
    s_endpgm
LB_g1:
    s_setprio 1
    s_lshl_b32 s44, s23, 4
    s_add_u32 s45, s45, s44
    s_add_u32 s45, s45, 256
    s_add_u32 s46, s46, s45
    v_lshlrev_b32 v5, 3, v3
    v_mul_u32_u24 v16, 1280, v2
    v_add_u32 v16, v16, v5
    s_lshl_b32 s42, s23, 10
    s_add_u32 s42, s42, 8192
    v_add_u32 v18, s42, v0
    v_add_u32 v17, 49152, v18
    s_mov_b32 s80, 0
    s_lshl_b32 s42, s18, 15
    s_lshl_b32 s43, s23, 13
    s_add_u32 s42, s42, s43
    s_add_u32 s42, s42, 14155776
    s_add_u32 m0, s43, 98304
    s_lshl_b32 s43, s18, 13
    s_lshl_b32 s44, s23, 11
    s_add_u32 s43, s43, s44
    s_add_u32 s43, s43, 16252928
    s_add_u32 s44, s44, 131072
    ds_write_b128 v4, v[164:167] offset:11264
    ds_write_b128 v4, v[120:123] offset:0
    ds_write_b128 v4, v[124:127] offset:1024
    ds_write_b128 v4, v[128:131] offset:2048
    ds_write_b128 v4, v[132:135] offset:3072
    ds_write_b128 v4, v[136:139] offset:4096
    buffer_load_dword v30, v118, s[28:31], s51 offen sc1
    ds_write_b128 v4, v[140:143] offset:5120
    ds_write_b128 v4, v[144:147] offset:6144
    ds_write_b128 v4, v[148:151] offset:7168
    s_waitcnt vmcnt(0)
    v_cmp_ne_u32 vcc, s90, v30
    s_nop 4
    s_cbranch_vccnz LB_late
    buffer_load_dwordx4 v0, s[28:31], s42 offen offset:0 sc1 lds
    buffer_load_dwordx4 v0, s[28:31], s42 offen offset:1024 sc1 lds
    buffer_load_dwordx4 v0, s[28:31], s42 offen offset:2048 sc1 lds
    buffer_load_dwordx4 v0, s[28:31], s42 offen offset:3072 sc1 lds
    s_add_u32 m0, m0, 4096
    s_add_u32 s42, s42, 4096
    buffer_load_dwordx4 v0, s[28:31], s42 offen offset:0 sc1 lds
    buffer_load_dwordx4 v0, s[28:31], s42 offen offset:1024 sc1 lds
    buffer_load_dwordx4 v0, s[28:31], s42 offen offset:2048 sc1 lds
    buffer_load_dwordx4 v0, s[28:31], s42 offen offset:3072 sc1 lds
    s_mov_b32 m0, s44
    s_nop 0
    buffer_load_dwordx4 v0, s[28:31], s43 offen offset:0 sc1 lds
    buffer_load_dwordx4 v0, s[28:31], s43 offen offset:1024 sc1 lds
    s_waitcnt lgkmcnt(0)
    s_barrier
    s_branch LB_staged
LB_late:
    s_waitcnt lgkmcnt(0)
    s_barrier
LB_poll:
    buffer_load_dword v30, v118, s[28:31], s51 offen sc1
    s_add_u32 s80, s80, 1
    s_waitcnt vmcnt(0)
    v_cmp_ne_u32 vcc, s90, v30
    s_cmp_gt_u32 s80, 100000
    s_cbranch_scc1 LB_go
    s_nop 2
    s_cbranch_vccnz LB_poll
LB_go:
    buffer_load_dwordx4 v0, s[28:31], s42 offen offset:0 sc1 lds
    buffer_load_dwordx4 v0, s[28:31], s42 offen offset:1024 sc1 lds
    buffer_load_dwordx4 v0, s[28:31], s42 offen offset:2048 sc1 lds
    buffer_load_dwordx4 v0, s[28:31], s42 offen offset:3072 sc1 lds
    s_add_u32 m0, m0, 4096
    s_add_u32 s42, s42, 4096
    buffer_load_dwordx4 v0, s[28:31], s42 offen offset:0 sc1 lds
    buffer_load_dwordx4 v0, s[28:31], s42 offen offset:1024 sc1 lds
    buffer_load_dwordx4 v0, s[28:31], s42 offen offset:2048 sc1 lds
    buffer_load_dwordx4 v0, s[28:31], s42 offen offset:3072 sc1 lds
    s_mov_b32 m0, s44
    s_nop 0
    buffer_load_dwordx4 v0, s[28:31], s43 offen offset:0 sc1 lds
    buffer_load_dwordx4 v0, s[28:31], s43 offen offset:1024 sc1 lds
LB_staged:
    buffer_load_dwordx4 v[52:55], v0, s[28:31], s54 offen sc1
    s_add_u32 s54, s54, 20480
    buffer_load_dwordx4 v[56:59], v0, s[28:31], s54 offen sc1
    s_add_u32 s54, s54, 20480
    buffer_load_dwordx4 v[60:63], v0, s[28:31], s54 offen sc1
    s_add_u32 s54, s54, 20480
    buffer_load_dwordx4 v[64:67], v0, s[28:31], s54 offen sc1
    s_add_u32 s54, s54, 20480
    buffer_load_dwordx4 v[68:71], v0, s[28:31], s54 offen sc1
    s_add_u32 s54, s54, 20480
    buffer_load_dwordx4 v[72:75], v0, s[28:31], s54 offen sc1
    s_add_u32 s54, s54, 20480
    buffer_load_dwordx4 v[76:79], v0, s[28:31], s54 offen sc1
    s_add_u32 s54, s54, 20480
    buffer_load_dwordx4 v[80:83], v0, s[28:31], s54 offen sc1
    s_add_u32 s54, s54, 20480
    buffer_load_dwordx2 v[84:85], v5, s[32:35], s45 offen
    buffer_load_dwordx2 v[8:9], v16, s[24:27], s46 offen
    ds_read_b128 v[168:171], v18 offset:0
    ds_read_b128 v[120:123], v18 offset:12288
    ds_read_b128 v[124:127], v18 offset:24576
    ds_read_b128 v[128:131], v18 offset:36864
    ds_read_b128 v[132:135], v17 offset:0
    ds_read_b128 v[136:139], v17 offset:12288
    ds_read_b128 v[140:143], v17 offset:24576
    ds_read_b128 v[144:147], v17 offset:36864
    s_waitcnt lgkmcnt(6)
    v_add_f32 v168, v168, v120
    v_add_f32 v169, v169, v121
    v_add_f32 v170, v170, v122
    v_add_f32 v171, v171, v123
    s_waitcnt lgkmcnt(5)
    v_add_f32 v168, v168, v124
    v_add_f32 v169, v169, v125
    v_add_f32 v170, v170, v126
    v_add_f32 v171, v171, v127
    s_waitcnt lgkmcnt(4)
    v_add_f32 v168, v168, v128
    v_add_f32 v169, v169, v129
    v_add_f32 v170, v170, v130
    v_add_f32 v171, v171, v131
    s_waitcnt lgkmcnt(3)
    v_add_f32 v168, v168, v132
    v_add_f32 v169, v169, v133
    v_add_f32 v170, v170, v134
    v_add_f32 v171, v171, v135
    s_waitcnt lgkmcnt(2)
    v_add_f32 v168, v168, v136
    v_add_f32 v169, v169, v137
    v_add_f32 v170, v170, v138
    v_add_f32 v171, v171, v139
    s_waitcnt lgkmcnt(1)
    v_add_f32 v168, v168, v140
    v_add_f32 v169, v169, v141
    v_add_f32 v170, v170, v142
    v_add_f32 v171, v171, v143
    s_waitcnt lgkmcnt(0)
    v_add_f32 v168, v168, v144
    v_add_f32 v169, v169, v145
    v_add_f32 v170, v170, v146
    v_add_f32 v171, v171, v147
    v_add_u32 v4, 98304, v0
    v_lshlrev_b32 v17, 3, v2
    v_lshl_add_u32 v17, v3, 9, v17
    v_add_u32 v17, 131072, v17
    v_add_u32 v18, 2048, v17
    v_add_u32 v19, 4096, v17
    v_add_u32 v12, 6144, v17
    s_mul_i32 s42, s23, 10240
    v_add_u32 v13, s42, v4
    s_lshl_b32 s42, s23, 13
    v_add_u32 v14, s42, v0
    s_lshl_b32 s42, s23, 10
    s_add_u32 s42, s42, 4096
    v_add_u32 v5, s42, v0
    s_cmp_eq_u32 s23, 3
    s_waitcnt vmcnt(10)
    s_barrier
    s_cbranch_scc1 LB_q3
    ds_read_b128 v[152:155], v13 offset:0
    ds_read_b128 v[156:159], v13 offset:1024
    ds_read_b128 v[160:163], v13 offset:2048
    ds_read_b128 v[164:167], v13 offset:3072
    ds_read_b128 v[92:95], v13 offset:4096
    ds_read_b128 v[96:99], v13 offset:5120
    ds_read_b128 v[20:23], v13 offset:6144
    ds_read_b128 v[24:27], v13 offset:7168
    ds_read_b128 v[32:35], v13 offset:8192
    ds_read_b128 v[36:39], v13 offset:9216
    ds_read_b128 v[88:91], v4 offset:25600
    ds_read_b128 v[184:187], v4 offset:26624
    ds_read_b128 v[188:191], v4 offset:27648
    s_waitcnt lgkmcnt(12)
    v_mfma_f32_32x32x16_bf16 v[136:151], v[216:219], v[152:155], 0
    s_setprio 0
    ds_read_b128 v[152:155], v4 offset:28672
    s_waitcnt lgkmcnt(12)
    v_mfma_f32_32x32x16_bf16 v[136:151], v[220:223], v[156:159], v[136:151]
    ds_read_b128 v[156:159], v4 offset:29696
    s_waitcnt lgkmcnt(12)
    v_mfma_f32_32x32x16_bf16 v[136:151], v[224:227], v[160:163], v[136:151]
    ds_read_b128 v[160:163], v4 offset:30720
    s_waitcnt lgkmcnt(12)
    v_mfma_f32_32x32x16_bf16 v[136:151], v[228:231], v[164:167], v[136:151]
    ds_read_b128 v[164:167], v4 offset:31744
    s_waitcnt lgkmcnt(12)
    v_mfma_f32_32x32x16_bf16 v[136:151], v[232:235], v[92:95], v[136:151]
    ds_read2_b64 v[92:95], v17 offset0:0 offset1:32
    s_waitcnt lgkmcnt(12)
    v_mfma_f32_32x32x16_bf16 v[136:151], v[236:239], v[96:99], v[136:151]
    ds_read2_b64 v[96:99], v17 offset0:128 offset1:160
    s_waitcnt lgkmcnt(12)
    v_mfma_f32_32x32x16_bf16 v[136:151], v[240:243], v[20:23], v[136:151]
    ds_read2_b64 v[20:23], v18 offset0:0 offset1:32
    s_waitcnt lgkmcnt(12)
    v_mfma_f32_32x32x16_bf16 v[136:151], v[244:247], v[24:27], v[136:151]
    ds_read2_b64 v[24:27], v18 offset0:128 offset1:160
    s_waitcnt lgkmcnt(12)
    v_mfma_f32_32x32x16_bf16 v[136:151], v[248:251], v[32:35], v[136:151]
    ds_read2_b64 v[32:35], v19 offset0:0 offset1:32
    s_waitcnt lgkmcnt(12)
    v_mfma_f32_32x32x16_bf16 v[136:151], v[252:255], v[36:39], v[136:151]
    ds_read2_b64 v[36:39], v19 offset0:128 offset1:160
    s_waitcnt lgkmcnt(12)
    v_mfma_f32_32x32x16_bf16 v[120:135], v[100:103], v[88:91], 0
    ds_read2_b64 v[88:91], v12 offset0:0 offset1:32
    s_waitcnt lgkmcnt(12)
    v_mfma_f32_32x32x16_bf16 v[120:135], v[104:107], v[184:187], v[120:135]
    ds_read2_b64 v[184:187], v12 offset0:128 offset1:160
    s_waitcnt lgkmcnt(12)
    v_mfma_f32_32x32x16_bf16 v[120:135], v[108:111], v[188:191], v[120:135]
    s_waitcnt lgkmcnt(11)
    v_mfma_f32_32x32x16_bf16 v[120:135], v[112:115], v[152:155], v[120:135]
    s_waitcnt lgkmcnt(10)
    v_mfma_f32_32x32x16_bf16 v[120:135], v[40:43], v[156:159], v[120:135]
    s_waitcnt lgkmcnt(9)
    v_mfma_f32_32x32x16_bf16 v[120:135], v[44:47], v[160:163], v[120:135]
    s_waitcnt lgkmcnt(8)
    s_waitcnt lgkmcnt(0)
    v_mfma_f32_32x32x16_bf16 v[120:135], v[48:51], v[164:167], v[120:135]
    ds_write_b128 v14, v[136:139] offset:4096
    s_waitcnt vmcnt(2)
    v_mfma_f32_32x32x16_bf16 v[120:135], v[52:55], v[92:95], v[120:135]
    v_mfma_f32_32x32x16_bf16 v[120:135], v[56:59], v[96:99], v[120:135]
    ds_write_b128 v14, v[140:143] offset:5120
    v_mfma_f32_32x32x16_bf16 v[120:135], v[60:63], v[20:23], v[120:135]
    v_mfma_f32_32x32x16_bf16 v[120:135], v[64:67], v[24:27], v[120:135]
    ds_write_b128 v14, v[144:147] offset:6144
    v_mfma_f32_32x32x16_bf16 v[120:135], v[68:71], v[32:35], v[120:135]
    v_mfma_f32_32x32x16_bf16 v[120:135], v[72:75], v[36:39], v[120:135]
    ds_write_b128 v14, v[148:151] offset:7168
    v_mfma_f32_32x32x16_bf16 v[120:135], v[76:79], v[88:91], v[120:135]
    v_mfma_f32_32x32x16_bf16 v[120:135], v[80:83], v[184:187], v[120:135]
    s_setprio 1
    s_barrier
    s_branch LB_q3d
LB_q3:
    ds_read_b128 v[152:155], v4 offset:30720
    ds_read_b128 v[156:159], v4 offset:31744
    ds_read2_b64 v[160:163], v17 offset0:0 offset1:32
    ds_read2_b64 v[164:167], v17 offset0:128 offset1:160
    ds_read2_b64 v[92:95], v18 offset0:0 offset1:32
    ds_read2_b64 v[96:99], v18 offset0:128 offset1:160
    ds_read2_b64 v[20:23], v19 offset0:0 offset1:32
    ds_read2_b64 v[24:27], v19 offset0:128 offset1:160
    ds_read2_b64 v[32:35], v12 offset0:0 offset1:32
    ds_read2_b64 v[36:39], v12 offset0:128 offset1:160
    ds_read_b128 v[88:91], v4 offset:25600
    ds_read_b128 v[184:187], v4 offset:26624
    ds_read_b128 v[188:191], v4 offset:27648
    s_waitcnt lgkmcnt(12)
    v_mfma_f32_32x32x16_bf16 v[136:151], v[216:219], v[152:155], 0
    s_setprio 0
    ds_read_b128 v[152:155], v4 offset:28672
    s_waitcnt lgkmcnt(12)
    v_mfma_f32_32x32x16_bf16 v[136:151], v[220:223], v[156:159], v[136:151]
    ds_read_b128 v[156:159], v4 offset:29696
    s_waitcnt lgkmcnt(12)
    v_mfma_f32_32x32x16_bf16 v[136:151], v[224:227], v[160:163], v[136:151]
    ds_read_b128 v[160:163], v4 offset:30720
    s_waitcnt lgkmcnt(12)
    v_mfma_f32_32x32x16_bf16 v[136:151], v[228:231], v[164:167], v[136:151]
    ds_read_b128 v[164:167], v4 offset:31744
    s_waitcnt lgkmcnt(12)
    v_mfma_f32_32x32x16_bf16 v[136:151], v[232:235], v[92:95], v[136:151]
    ds_read2_b64 v[92:95], v17 offset0:0 offset1:32
    s_waitcnt lgkmcnt(12)
    v_mfma_f32_32x32x16_bf16 v[136:151], v[236:239], v[96:99], v[136:151]
    ds_read2_b64 v[96:99], v17 offset0:128 offset1:160
    s_waitcnt lgkmcnt(12)
    v_mfma_f32_32x32x16_bf16 v[136:151], v[240:243], v[20:23], v[136:151]
    ds_read2_b64 v[20:23], v18 offset0:0 offset1:32
    s_waitcnt lgkmcnt(12)
    v_mfma_f32_32x32x16_bf16 v[136:151], v[244:247], v[24:27], v[136:151]
    ds_read2_b64 v[24:27], v18 offset0:128 offset1:160
    s_waitcnt lgkmcnt(12)
    v_mfma_f32_32x32x16_bf16 v[136:151], v[248:251], v[32:35], v[136:151]
    ds_read2_b64 v[32:35], v19 offset0:0 offset1:32
    s_waitcnt lgkmcnt(12)
    v_mfma_f32_32x32x16_bf16 v[136:151], v[252:255], v[36:39], v[136:151]
    ds_read2_b64 v[36:39], v19 offset0:128 offset1:160
    s_waitcnt lgkmcnt(12)
    v_mfma_f32_32x32x16_bf16 v[120:135], v[100:103], v[88:91], 0
    ds_read2_b64 v[88:91], v12 offset0:0 offset1:32
    s_waitcnt lgkmcnt(12)
    v_mfma_f32_32x32x16_bf16 v[120:135], v[104:107], v[184:187], v[120:135]
    ds_read2_b64 v[184:187], v12 offset0:128 offset1:160
    s_waitcnt lgkmcnt(12)
    v_mfma_f32_32x32x16_bf16 v[120:135], v[108:111], v[188:191], v[120:135]
    s_waitcnt lgkmcnt(11)
    v_mfma_f32_32x32x16_bf16 v[120:135], v[112:115], v[152:155], v[120:135]
    s_waitcnt lgkmcnt(10)
    v_mfma_f32_32x32x16_bf16 v[120:135], v[40:43], v[156:159], v[120:135]
    s_waitcnt lgkmcnt(9)
    v_mfma_f32_32x32x16_bf16 v[120:135], v[44:47], v[160:163], v[120:135]
    s_waitcnt lgkmcnt(8)
    s_waitcnt lgkmcnt(0)
    v_mfma_f32_32x32x16_bf16 v[120:135], v[48:51], v[164:167], v[120:135]
    ds_write_b128 v14, v[136:139] offset:4096
    s_waitcnt vmcnt(2)
    v_mfma_f32_32x32x16_bf16 v[120:135], v[52:55], v[92:95], v[120:135]
    v_mfma_f32_32x32x16_bf16 v[120:135], v[56:59], v[96:99], v[120:135]
    ds_write_b128 v14, v[140:143] offset:5120
    v_mfma_f32_32x32x16_bf16 v[120:135], v[60:63], v[20:23], v[120:135]
    v_mfma_f32_32x32x16_bf16 v[120:135], v[64:67], v[24:27], v[120:135]
    ds_write_b128 v14, v[144:147] offset:6144
    v_mfma_f32_32x32x16_bf16 v[120:135], v[68:71], v[32:35], v[120:135]
    v_mfma_f32_32x32x16_bf16 v[120:135], v[72:75], v[36:39], v[120:135]
    ds_write_b128 v14, v[148:151] offset:7168
    v_mfma_f32_32x32x16_bf16 v[120:135], v[76:79], v[88:91], v[120:135]
    v_mfma_f32_32x32x16_bf16 v[120:135], v[80:83], v[184:187], v[120:135]
    s_setprio 1
    s_barrier
LB_q3d:
    s_nop 10
    ds_write_b128 v14, v[120:123] offset:0
    ds_write_b128 v14, v[124:127] offset:1024
    ds_write_b128 v14, v[128:131] offset:2048
    ds_write_b128 v14, v[132:135] offset:3072
    s_waitcnt lgkmcnt(0)
    s_barrier
    ds_read_b128 v[184:187], v5 offset:0
    ds_read_b128 v[188:191], v5 offset:8192
    ds_read_b128 v[192:195], v5 offset:16384
    ds_read_b128 v[196:199], v5 offset:24576
    s_waitcnt vmcnt(0)
    v_lshlrev_b32 v116, 16, v84
    v_and_b32 v117, 0xffff0000, v84
    v_fma_f32 v168, v168, v119, v116
    v_fma_f32 v169, v169, v119, v117
    v_mul_f32 v116, s49, v168
    v_mul_f32 v117, s49, v169
    v_exp_f32 v116, v116
    v_exp_f32 v117, v117
    v_add_f32 v116, 1.0, v116
    s_nop 0
    v_add_f32 v117, 1.0, v117
    v_rcp_f32 v116, v116
    v_rcp_f32 v117, v117
    v_mul_f32 v168, v168, v116
    s_nop 0
    v_mul_f32 v169, v169, v117
    v_lshlrev_b32 v116, 16, v85
    v_and_b32 v117, 0xffff0000, v85
    v_fma_f32 v170, v170, v119, v116
    v_fma_f32 v171, v171, v119, v117
    v_mul_f32 v116, s49, v170
    v_mul_f32 v117, s49, v171
    v_exp_f32 v116, v116
    v_exp_f32 v117, v117
    v_add_f32 v116, 1.0, v116
    s_nop 0
    v_add_f32 v117, 1.0, v117
    v_rcp_f32 v116, v116
    v_rcp_f32 v117, v117
    v_mul_f32 v170, v170, v116
    s_nop 0
    v_mul_f32 v171, v171, v117
    v_lshlrev_b32 v200, 16, v8
    v_and_b32 v201, 0xffff0000, v8
    v_lshlrev_b32 v202, 16, v9
    v_and_b32 v203, 0xffff0000, v9
    s_waitcnt lgkmcnt(2)
    v_add_f32 v184, v184, v188
    v_add_f32 v185, v185, v189
    v_add_f32 v186, v186, v190
    v_add_f32 v187, v187, v191
    s_waitcnt lgkmcnt(1)
    v_add_f32 v184, v184, v192
    v_add_f32 v185, v185, v193
    v_add_f32 v186, v186, v194
    v_add_f32 v187, v187, v195
    s_waitcnt lgkmcnt(0)
    v_add_f32 v184, v184, v196
    v_add_f32 v185, v185, v197
    v_add_f32 v186, v186, v198
    v_add_f32 v187, v187, v199
    v_fma_f32 v184, v184, v168, v200
    v_fma_f32 v185, v185, v169, v201
    v_fma_f32 v186, v186, v170, v202
    v_fma_f32 v187, v187, v171, v203
    v_cvt_pk_bf16_f32 v184, v184, v185
    v_cvt_pk_bf16_f32 v185, v186, v187
    buffer_store_dwordx2 v[184:185], v16, s[36:39], s46 offen
    s_endpgm
LB_slow:
    v_and_b32 v116, 19, v2
    v_bfe_u32 v117, v2, 2, 1
    v_lshl_add_u32 v116, v117, 3, v116
    v_bfe_u32 v117, v2, 3, 1
    v_lshl_add_u32 v116, v117, 2, v116
    v_mul_u32_u24 v117, 20, v3
    v_add_u32 v117, v117, v2
    v_lshlrev_b32 v117, 4, v117
    v_lshlrev_b32 v5, 4, v116
    v_lshl_add_u32 v68, v3, 9, v5
    v_lshrrev_b32 v6, 4, v117
    v_mov_b32 v118, 0xff800000
    s_mov_b32 exec_lo, 0
    v_mov_b32 v12, 0
    v_mov_b32 v13, 0
    s_mov_b32 exec_lo, -1
    s_mov_b32 s81, s98
    s_mov_b32 s80, s99
    s_mov_b32 s82, 64
    v_mul_u32_u24 v69, 3277, v6
    v_lshrrev_b32 v69, 16, v69
    v_mul_u32_u24 v70, 20, v69
    v_sub_u32 v70, v6, v70
    s_mul_i32 s3, s16, 20
    v_add_u32 v70, s3, v70
    v_and_b32 v71, 31, v70
    v_lshrrev_b32 v70, 5, v70
    v_lshlrev_b32 v71, 4, v71
    v_lshl_add_u32 v71, v70, 11, v71
    v_and_b32 v70, 3, v69
    v_lshl_add_u32 v71, v70, 9, v71
    v_lshrrev_b32 v69, 2, v69
    v_mul_u32_u24 v69, 40960, v69
    v_add_u32 v6, v69, v71
LB_fb1:
    buffer_load_dwordx4 v[16:19], v68, s[28:31], s81 offen sc1
    s_mov_b32 exec_hi, 0
    buffer_load_dwordx2 v[14:15], v5, s[28:31], s80 offen sc1
    s_mov_b32 exec_hi, -1
    s_waitcnt vmcnt(0)
    v_mfma_f32_32x32x16_bf16 v[52:67], v[16:19], v[8:11], 0
    v_mfma_f32_32x32x8_bf16 v[52:67], v[14:15], v[12:13], v[52:67]
    s_nop 11
    v_max3_f32 v72, v52, v53, v54
    v_max3_f32 v72, v72, v55, v56
    v_max3_f32 v72, v72, v57, v58
    v_max3_f32 v72, v72, v59, v60
    v_max3_f32 v72, v72, v61, v62
    v_max3_f32 v72, v72, v63, v64
    v_max3_f32 v72, v72, v65, v66
    v_max_f32 v72, v72, v67
    v_max_f32 v118, v118, v72
    s_add_u32 s81, s81, 81920
    s_add_u32 s80, s80, 81920
    s_sub_u32 s82, s82, 1
    s_cmp_lg_u32 s82, 0
    s_cbranch_scc1 LB_fb1
    v_mov_b32 v72, v118
    v_mov_b32 v73, v72
    s_nop 1
    v_permlane32_swap_b32 v72, v73
    s_nop 1
    v_max_f32 v72, v72, v73
    v_sub_f32 v72, 0, v72
    v_and_b32 v73, 0xffff0000, v72
    v_sub_f32 v74, v72, v73
    v_and_b32 v75, 0xffff0000, v74
    v_sub_f32 v74, v74, v75
    s_mov_b32 exec_lo, 0
    v_cvt_pk_bf16_f32 v12, v73, v75
    v_cvt_pk_bf16_f32 v13, v74, 0
    s_mov_b32 exec_lo, -1
    v_mov_b32 v84, 0
    v_mov_b32 v85, 0
    v_mov_b32 v86, 0
    v_mov_b32 v87, 0
    v_mov_b32 v88, 0
    v_mov_b32 v89, 0
    v_mov_b32 v90, 0
    v_mov_b32 v91, 0
    v_mov_b32 v92, 0
    v_mov_b32 v93, 0
    v_mov_b32 v94, 0
    v_mov_b32 v95, 0
    v_mov_b32 v96, 0
    v_mov_b32 v97, 0
    v_mov_b32 v98, 0
    v_mov_b32 v99, 0
    s_mov_b32 s81, s98
    s_mov_b32 s80, s99
    s_mov_b32 s83, 5242880
    s_mov_b32 s82, 64
LB_fb2:
    buffer_load_dwordx4 v[16:19], v68, s[28:31], s81 offen sc1
    s_mov_b32 exec_hi, 0
    buffer_load_dwordx2 v[14:15], v5, s[28:31], s80 offen sc1
    s_mov_b32 exec_hi, -1
    s_mov_b64 exec, s[46:47]
    buffer_load_dwordx4 v[20:23], v6, s[28:31], s83 offen sc1
    buffer_load_dwordx4 v[28:31], v6, s[28:31], s83 offen offset:1024 sc1
    s_mov_b64 exec, -1
    s_waitcnt vmcnt(0)
    v_mfma_f32_32x32x16_bf16 v[52:67], v[16:19], v[8:11], 0
    v_mfma_f32_32x32x8_bf16 v[52:67], v[14:15], v[12:13], v[52:67]
    s_nop 11
    v_exp_f32 v52, v52
    v_exp_f32 v53, v53
    v_exp_f32 v54, v54
    v_exp_f32 v55, v55
    v_exp_f32 v56, v56
    v_exp_f32 v57, v57
    v_exp_f32 v58, v58
    v_exp_f32 v59, v59
    v_exp_f32 v60, v60
    v_exp_f32 v61, v61
    v_exp_f32 v62, v62
    v_exp_f32 v63, v63
    v_exp_f32 v64, v64
    v_exp_f32 v65, v65
    v_exp_f32 v66, v66
    v_exp_f32 v67, v67
    s_nop 1
    v_smfmac_f32_32x32x32_bf16 v[84:99], v[20:23], v[52:59], v7
    v_smfmac_f32_32x32x32_bf16 v[84:99], v[28:31], v[60:67], v7
    s_add_u32 s81, s81, 81920
    s_add_u32 s80, s80, 81920
    s_add_u32 s83, s83, 40960
    s_sub_u32 s82, s82, 1
    s_cmp_lg_u32 s82, 0
    s_cbranch_scc1 LB_fb2
    s_nop 11
    v_mov_b32 v116, v92
    v_mov_b32 v117, v92
    s_nop 1
    v_permlane32_swap_b32 v116, v117
    s_nop 1
    s_branch LB_ok
L_cs16:
    s_mov_b32 s83, 0
L_cw16:
    ds_read_b32 v18, v14 offset:16
    s_add_u32 s83, s83, 1
    s_waitcnt lgkmcnt(0)
    v_cmp_gt_u32 vcc, 4, v18
    s_cmp_gt_u32 s83, 1000000
    s_cbranch_scc1 L_cd16
    s_nop 2
    s_cbranch_vccnz L_cw16
    s_branch L_cd16
L_cs4:
    s_mov_b32 s83, 0
L_cw4:
    ds_read_b32 v18, v14 offset:4
    s_add_u32 s83, s83, 1
    s_waitcnt lgkmcnt(0)
    v_cmp_gt_u32 vcc, 4, v18
    s_cmp_gt_u32 s83, 1000000
    s_cbranch_scc1 L_cd4
    s_nop 2
    s_cbranch_vccnz L_cw4
    s_branch L_cd4
L_cs8:
    s_mov_b32 s83, 0
L_cw8:
    ds_read_b32 v18, v14 offset:8
    s_add_u32 s83, s83, 1
    s_waitcnt lgkmcnt(0)
    v_cmp_gt_u32 vcc, 4, v18
    s_cmp_gt_u32 s83, 1000000
    s_cbranch_scc1 L_cd8
    s_nop 2
    s_cbranch_vccnz L_cw8
    s_branch L_cd8
L_cs12:
    s_mov_b32 s83, 0
L_cw12:
    ds_read_b32 v18, v14 offset:12
    s_add_u32 s83, s83, 1
    s_waitcnt lgkmcnt(0)
    v_cmp_gt_u32 vcc, 4, v18
    s_cmp_gt_u32 s83, 1000000
    s_cbranch_scc1 L_cd12
    s_nop 2
    s_cbranch_vccnz L_cw12
    s_branch L_cd12
L_exit:
    s_endpgm
L_code_end:
.section .rodata,"a"
.p2align 6
.amdhsa_kernel recurrent_scan__softmax_full_mha__dense_activation_squared_relu__prompt_kernel
  .amdhsa_next_free_vgpr 256
  .amdhsa_next_free_sgpr 102
  .amdhsa_accum_offset 256
  .amdhsa_group_segment_fixed_size 0
  .amdhsa_kernarg_size 88
  .amdhsa_user_sgpr_count 2
  .amdhsa_user_sgpr_kernarg_segment_ptr 1
  .amdhsa_system_sgpr_workgroup_id_x 1
  .amdhsa_float_denorm_mode_32 3
.end_amdhsa_kernel
```
